```python
import torch

def _softmax(x, axis=-1):
    return torch.softmax(x, dim=axis)
def _gelu(x):
    return torch.nn.functional.gelu(x, approximate="tanh")
def _silu(x):
    return torch.nn.functional.silu(x)
def _sigmoid(x):
    return torch.sigmoid(x)
def _layernorm(x, axis=-1, eps=1e-5):
    m = x.mean(dim=axis, keepdim=True)
    v = x.var(dim=axis, keepdim=True, unbiased=False)
    return (x - m) / torch.sqrt(v + eps)
def _scatter_add(tgt, idx, src, axis=0):
    return tgt.clone().index_add_(axis, idx, src)
def _segment_sum(src, seg, n):
    out = torch.zeros((n,) + src.shape[1:], dtype=src.dtype)
    return out.index_add_(0, seg, src)
def _pad(x, pw):
    flat = tuple(v for pair in reversed(pw) for v in pair)
    return torch.nn.functional.pad(x, flat)

kernel_name = 'interleave_layers__grouped_kv_mqa__sliding_local_dilated__prompt'

def setup_inputs():

    _w = (lambda a: (lambda t: t.to(torch.bfloat16) if t.is_floating_point() else t)(torch.as_tensor(a)))
    def _A_setup():
        B, S, D, H = 1, 2048, 576, 32
        Dh = D // H
        return {
            "x": _w((lambda *s: torch.randn(*s, dtype=torch.bfloat16) * 0.05)(B, S, D)),
            "wq": _w((lambda *s: torch.randn(*s, dtype=torch.bfloat16) * 0.05)(D, H * Dh)),
            "wk": _w((lambda *s: torch.randn(*s, dtype=torch.bfloat16) * 0.05)(D, Dh)),
            "wv": _w((lambda *s: torch.randn(*s, dtype=torch.bfloat16) * 0.05)(D, Dh)),
            "wo": _w((lambda *s: torch.randn(*s, dtype=torch.bfloat16) * 0.05)(H * Dh, D)),
        }
    _A_in = _A_setup()

    def _B_setup():
        B, S, D = 1, 2048, 576
        return {
            "x": _w((lambda *s: torch.randn(*s, dtype=torch.bfloat16) * 0.05)(B, S, D)),
            "wqkv": _w((lambda *s: torch.randn(*s, dtype=torch.bfloat16) * 0.05)(D, 3 * D)),
            "wo": _w((lambda *s: torch.randn(*s, dtype=torch.bfloat16) * 0.05)(D, D)),
        }
    _B_in = _B_setup()

    return {
        "A_x": _A_in["x"],
        "A_wq": _A_in["wq"],
        "A_wk": _A_in["wk"],
        "A_wv": _A_in["wv"],
        "A_wo": _A_in["wo"],
        "B_x": _B_in["x"],
        "B_wqkv": _B_in["wqkv"],
        "B_wo": _B_in["wo"],
    }

def reference(A_x, A_wq, A_wk, A_wv, A_wo, B_x, B_wqkv, B_wo):
    def _A_ref(x, wq, wk, wv, wo):
        B, S, D = x.shape
        H = 32
        Dh = D // H
        q = (lambda x, *d: x.permute(*d))((x @ wq).reshape(B, S, H, Dh), 0, 2, 1, 3)
        k = x @ wk
        v = x @ wv
        scores = torch.einsum("bhqd,bkd->bhqk", q, k) * (Dh ** -0.5)
        p = _softmax(scores, axis=-1)
        o = torch.einsum("bhqk,bkd->bhqd", p, v)
        return (lambda x, *d: x.permute(*d))(o, 0, 2, 1, 3).reshape(B, S, H * Dh) @ wo

    def _B_ref(x, wqkv, wo):
        B, S, D = x.shape
        H = 32; Dh = D // H
        W, dil = 8, 2
        qkv = (lambda x, *d: x.permute(*d))((x @ wqkv).reshape(B, S, 3, H, Dh), 2, 0, 3, 1, 4)
        q, k, v = qkv[0], qkv[1], qkv[2]
        scale = Dh ** -0.5
        pos = torch.arange(S)
        off = torch.arange(W) * dil
        idx = pos[:, None] - off[None, :]
        mask = idx >= 0
        idx_c = torch.where(mask, idx, 0).reshape(-1)
        kg = k[:, :, idx_c, :].reshape(B, H, S, W, Dh)
        vg = v[:, :, idx_c, :].reshape(B, H, S, W, Dh)
        logits = torch.einsum("bhsd,bhswd->bhsw", q, kg) * scale
        logits = torch.where(mask[None, None, :, :], logits, -1e9)
        attn = _softmax(logits, axis=-1)
        o = torch.einsum("bhsw,bhswd->bhsd", attn, vg)
        return (lambda x, *d: x.permute(*d))(o, 0, 2, 1, 3).reshape(B, S, D) @ wo

    x = A_x
    x = x + _A_ref(_layernorm(x, axis=-1), A_wq, A_wk, A_wv, A_wo)
    x = x + _B_ref(_layernorm(x, axis=-1), B_wqkv, B_wo)
    x = x + _A_ref(_layernorm(x, axis=-1), A_wq, A_wk, A_wv, A_wo)
    x = x + _B_ref(_layernorm(x, axis=-1), B_wqkv, B_wo)
    return x
```

```asm
; @launch kernel=qkva1_kernel grid=(256,1,1) block=(256,1,1) lds=110592
; @launch kernel=attng_kernel grid=(256,1,1) block=(512,1,1) lds=163840
; @launch kernel=outa1_kernel grid=(199,1,1) block=(256,1,1) lds=110592
; @launch kernel=qkvb1_kernel grid=(256,1,1) block=(576,1,1) lds=129536
; @launch kernel=outb1_kernel grid=(192,1,1) block=(256,1,1) lds=110592
; @launch kernel=qkva2_kernel grid=(256,1,1) block=(256,1,1) lds=110592
; @launch kernel=attn_kernel grid=(256,1,1) block=(512,1,1) lds=163840
; @launch kernel=outa2_kernel grid=(192,1,1) block=(256,1,1) lds=110592
; @launch kernel=qkvb2_kernel grid=(256,1,1) block=(576,1,1) lds=129536
; @launch kernel=outb2_kernel grid=(192,1,1) block=(256,1,1) lds=110592
.amdgcn_target "amdgcn-amd-amdhsa--gfx950"
.text
.globl qkva1_kernel
.p2align 8
.type qkva1_kernel,@function
qkva1_kernel:
    s_cmp_ge_u32 s2, 256
    s_cbranch_scc1 .Lend_1
    s_load_dwordx2 s[40:41], s[0:1], 80
    s_load_dwordx2 s[4:5], s[0:1], 0
    s_load_dwordx2 s[6:7], s[0:1], 8
    s_load_dwordx4 s[8:11], s[0:1], 16
    s_load_dwordx2 s[32:33], s[0:1], 80
    s_and_b32 s3, s2, 7
    s_lshl_b32 s3, s3, 2
    s_lshr_b32 s28, s2, 6
    s_add_u32 s3, s3, s28
    s_bfe_u32 s28, s2, 0x30003
    v_and_b32 v1, 63, v0
    v_lshrrev_b32 v11, 6, v0
    s_nop 0
    v_readfirstlane_b32 s29, v11
    v_and_b32 v12, 15, v1
    v_lshrrev_b32 v13, 4, v1
    s_lshl_b32 s30, s3, 6
    s_lshl_b32 s31, s29, 4
    s_add_u32 s30, s30, s31
    v_add_u32 v14, s30, v12
    v_mul_u32_u24 v14, 1152, v14
    v_lshl_add_u32 v2, v13, 4, v14
    s_waitcnt lgkmcnt(0)
    s_mov_b32 s12, s4
    s_mov_b32 s13, s5
    s_mov_b32 s14, 0x240000
    s_mov_b32 s15, 0x00020000
    buffer_load_dwordx4 v[16:19], v2, s[12:15], 0 offen offset:0
    buffer_load_dwordx4 v[20:23], v2, s[12:15], 0 offen offset:64
    buffer_load_dwordx4 v[24:27], v2, s[12:15], 0 offen offset:128
    buffer_load_dwordx4 v[28:31], v2, s[12:15], 0 offen offset:192
    buffer_load_dwordx4 v[32:35], v2, s[12:15], 0 offen offset:256
    buffer_load_dwordx4 v[36:39], v2, s[12:15], 0 offen offset:320
    buffer_load_dwordx4 v[40:43], v2, s[12:15], 0 offen offset:384
    buffer_load_dwordx4 v[44:47], v2, s[12:15], 0 offen offset:448
    buffer_load_dwordx4 v[48:51], v2, s[12:15], 0 offen offset:512
    buffer_load_dwordx4 v[52:55], v2, s[12:15], 0 offen offset:576
    buffer_load_dwordx4 v[56:59], v2, s[12:15], 0 offen offset:640
    buffer_load_dwordx4 v[60:63], v2, s[12:15], 0 offen offset:704
    buffer_load_dwordx4 v[64:67], v2, s[12:15], 0 offen offset:768
    buffer_load_dwordx4 v[68:71], v2, s[12:15], 0 offen offset:832
    buffer_load_dwordx4 v[72:75], v2, s[12:15], 0 offen offset:896
    buffer_load_dwordx4 v[76:79], v2, s[12:15], 0 offen offset:960
    buffer_load_dwordx4 v[80:83], v2, s[12:15], 0 offen offset:1024
    buffer_load_dwordx4 v[84:87], v2, s[12:15], 0 offen offset:1088
    s_cmp_ge_u32 s28, 6
    s_cbranch_scc1 .Lkv_2
    s_mov_b32 s16, s6
    s_mov_b32 s17, s7
    s_mov_b32 s18, 0xa2000
    s_mov_b32 s19, 0x00020000
    v_add_u32 v15, 0, v0
    v_mul_u32_u24 v11, 43691, v15
    v_lshrrev_b32 v11, 19, v11
    v_mul_u32_u24 v7, 12, v11
    v_sub_u32 v15, v15, v7
    v_lshrrev_b32 v7, 3, v11
    v_and_b32 v7, 1, v7
    v_lshlrev_b32 v7, 1, v7
    v_xor_b32 v15, v15, v7
    v_lshlrev_b32 v15, 4, v15
    v_mul_u32_u24 v11, 1152, v11
    v_add_u32 v4, v11, v15
    v_add_u32 v15, 256, v0
    v_mul_u32_u24 v11, 43691, v15
    v_lshrrev_b32 v11, 19, v11
    v_mul_u32_u24 v7, 12, v11
    v_sub_u32 v15, v15, v7
    v_lshrrev_b32 v7, 3, v11
    v_and_b32 v7, 1, v7
    v_lshlrev_b32 v7, 1, v7
    v_xor_b32 v15, v15, v7
    v_lshlrev_b32 v15, 4, v15
    v_mul_u32_u24 v11, 1152, v11
    v_add_u32 v5, v11, v15
    v_add_u32 v15, 512, v0
    v_mul_u32_u24 v11, 43691, v15
    v_lshrrev_b32 v11, 19, v11
    v_mul_u32_u24 v7, 12, v11
    v_sub_u32 v15, v15, v7
    v_lshrrev_b32 v7, 3, v11
    v_and_b32 v7, 1, v7
    v_lshlrev_b32 v7, 1, v7
    v_xor_b32 v15, v15, v7
    v_lshlrev_b32 v15, 4, v15
    v_mul_u32_u24 v11, 1152, v11
    v_add_u32 v6, v11, v15
    s_mul_i32 s31, s28, 192
    s_lshl_b32 s34, s29, 10
    s_add_u32 m0, s34, 0
    s_add_u32 s35, s31, 0
    buffer_load_dwordx4 v4, s[16:19], s35 offen lds
    s_add_u32 m0, s34, 4096
    s_add_u32 s35, s31, 0
    buffer_load_dwordx4 v5, s[16:19], s35 offen lds
    s_add_u32 m0, s34, 8192
    s_add_u32 s35, s31, 0
    buffer_load_dwordx4 v6, s[16:19], s35 offen lds
    s_add_u32 m0, s34, 12288
    s_add_u32 s35, s31, 73728
    buffer_load_dwordx4 v4, s[16:19], s35 offen lds
    s_add_u32 m0, s34, 16384
    s_add_u32 s35, s31, 73728
    buffer_load_dwordx4 v5, s[16:19], s35 offen lds
    s_add_u32 m0, s34, 20480
    s_add_u32 s35, s31, 73728
    buffer_load_dwordx4 v6, s[16:19], s35 offen lds
    s_add_u32 m0, s34, 24576
    s_add_u32 s35, s31, 147456
    buffer_load_dwordx4 v4, s[16:19], s35 offen lds
    s_add_u32 m0, s34, 28672
    s_add_u32 s35, s31, 147456
    buffer_load_dwordx4 v5, s[16:19], s35 offen lds
    s_add_u32 m0, s34, 32768
    s_add_u32 s35, s31, 147456
    buffer_load_dwordx4 v6, s[16:19], s35 offen lds
    v_lshrrev_b32 v7, 2, v12
    v_and_b32 v8, 3, v12
    v_lshl_add_u32 v7, v13, 3, v7
    v_mul_u32_u24 v7, 192, v7
    v_lshl_add_u32 v7, v8, 3, v7
    v_and_b32 v8, 1, v13
    v_lshlrev_b32 v8, 5, v8
    v_sub_u32 v9, v7, v8
    v_add_u32 v7, v7, v8
    v_add_u32 v8, 55296, v7
    v_add_u32 v10, 55296, v9
    v_mov_b32 v136, 0
    v_mov_b32 v137, 0
    v_mov_b32 v138, 0
    v_mov_b32 v139, 0
    v_mov_b32 v140, 0
    v_mov_b32 v141, 0
    v_mov_b32 v142, 0
    v_mov_b32 v143, 0
    v_mov_b32 v144, 0
    v_mov_b32 v145, 0
    v_mov_b32 v146, 0
    v_mov_b32 v147, 0
    v_mov_b32 v148, 0
    v_mov_b32 v149, 0
    v_mov_b32 v150, 0
    v_mov_b32 v151, 0
    v_mov_b32 v152, 0
    v_mov_b32 v153, 0
    v_mov_b32 v154, 0
    v_mov_b32 v155, 0
    v_mov_b32 v156, 0
    v_mov_b32 v157, 0
    v_mov_b32 v158, 0
    v_mov_b32 v159, 0
    s_waitcnt vmcnt(9)
    s_mov_b32 s36, 0x3f803f80
    v_mov_b32 v160, 0
    v_mov_b32 v164, 0
    v_mov_b32 v161, 0
    v_mov_b32 v165, 0
    v_mov_b32 v162, 0
    v_mov_b32 v166, 0
    v_mov_b32 v163, 0
    v_mov_b32 v167, 0
    v_dot2_f32_bf16 v160, v16, s36, v160
    v_dot2_f32_bf16 v164, v16, v16, v164
    v_dot2_f32_bf16 v161, v17, s36, v161
    v_dot2_f32_bf16 v165, v17, v17, v165
    v_dot2_f32_bf16 v162, v18, s36, v162
    v_dot2_f32_bf16 v166, v18, v18, v166
    v_dot2_f32_bf16 v163, v19, s36, v163
    v_dot2_f32_bf16 v167, v19, v19, v167
    v_dot2_f32_bf16 v160, v20, s36, v160
    v_dot2_f32_bf16 v164, v20, v20, v164
    v_dot2_f32_bf16 v161, v21, s36, v161
    v_dot2_f32_bf16 v165, v21, v21, v165
    v_dot2_f32_bf16 v162, v22, s36, v162
    v_dot2_f32_bf16 v166, v22, v22, v166
    v_dot2_f32_bf16 v163, v23, s36, v163
    v_dot2_f32_bf16 v167, v23, v23, v167
    v_dot2_f32_bf16 v160, v24, s36, v160
    v_dot2_f32_bf16 v164, v24, v24, v164
    v_dot2_f32_bf16 v161, v25, s36, v161
    v_dot2_f32_bf16 v165, v25, v25, v165
    v_dot2_f32_bf16 v162, v26, s36, v162
    v_dot2_f32_bf16 v166, v26, v26, v166
    v_dot2_f32_bf16 v163, v27, s36, v163
    v_dot2_f32_bf16 v167, v27, v27, v167
    v_dot2_f32_bf16 v160, v28, s36, v160
    v_dot2_f32_bf16 v164, v28, v28, v164
    v_dot2_f32_bf16 v161, v29, s36, v161
    v_dot2_f32_bf16 v165, v29, v29, v165
    v_dot2_f32_bf16 v162, v30, s36, v162
    v_dot2_f32_bf16 v166, v30, v30, v166
    v_dot2_f32_bf16 v163, v31, s36, v163
    v_dot2_f32_bf16 v167, v31, v31, v167
    v_dot2_f32_bf16 v160, v32, s36, v160
    v_dot2_f32_bf16 v164, v32, v32, v164
    v_dot2_f32_bf16 v161, v33, s36, v161
    v_dot2_f32_bf16 v165, v33, v33, v165
    v_dot2_f32_bf16 v162, v34, s36, v162
    v_dot2_f32_bf16 v166, v34, v34, v166
    v_dot2_f32_bf16 v163, v35, s36, v163
    v_dot2_f32_bf16 v167, v35, v35, v167
    v_dot2_f32_bf16 v160, v36, s36, v160
    v_dot2_f32_bf16 v164, v36, v36, v164
    v_dot2_f32_bf16 v161, v37, s36, v161
    v_dot2_f32_bf16 v165, v37, v37, v165
    v_dot2_f32_bf16 v162, v38, s36, v162
    v_dot2_f32_bf16 v166, v38, v38, v166
    v_dot2_f32_bf16 v163, v39, s36, v163
    v_dot2_f32_bf16 v167, v39, v39, v167
    v_dot2_f32_bf16 v160, v40, s36, v160
    v_dot2_f32_bf16 v164, v40, v40, v164
    v_dot2_f32_bf16 v161, v41, s36, v161
    v_dot2_f32_bf16 v165, v41, v41, v165
    v_dot2_f32_bf16 v162, v42, s36, v162
    v_dot2_f32_bf16 v166, v42, v42, v166
    v_dot2_f32_bf16 v163, v43, s36, v163
    v_dot2_f32_bf16 v167, v43, v43, v167
    v_dot2_f32_bf16 v160, v44, s36, v160
    v_dot2_f32_bf16 v164, v44, v44, v164
    v_dot2_f32_bf16 v161, v45, s36, v161
    v_dot2_f32_bf16 v165, v45, v45, v165
    v_dot2_f32_bf16 v162, v46, s36, v162
    v_dot2_f32_bf16 v166, v46, v46, v166
    v_dot2_f32_bf16 v163, v47, s36, v163
    v_dot2_f32_bf16 v167, v47, v47, v167
    v_dot2_f32_bf16 v160, v48, s36, v160
    v_dot2_f32_bf16 v164, v48, v48, v164
    v_dot2_f32_bf16 v161, v49, s36, v161
    v_dot2_f32_bf16 v165, v49, v49, v165
    v_dot2_f32_bf16 v162, v50, s36, v162
    v_dot2_f32_bf16 v166, v50, v50, v166
    v_dot2_f32_bf16 v163, v51, s36, v163
    v_dot2_f32_bf16 v167, v51, v51, v167
    v_dot2_f32_bf16 v160, v52, s36, v160
    v_dot2_f32_bf16 v164, v52, v52, v164
    v_dot2_f32_bf16 v161, v53, s36, v161
    v_dot2_f32_bf16 v165, v53, v53, v165
    v_dot2_f32_bf16 v162, v54, s36, v162
    v_dot2_f32_bf16 v166, v54, v54, v166
    v_dot2_f32_bf16 v163, v55, s36, v163
    v_dot2_f32_bf16 v167, v55, v55, v167
    v_dot2_f32_bf16 v160, v56, s36, v160
    v_dot2_f32_bf16 v164, v56, v56, v164
    v_dot2_f32_bf16 v161, v57, s36, v161
    v_dot2_f32_bf16 v165, v57, v57, v165
    v_dot2_f32_bf16 v162, v58, s36, v162
    v_dot2_f32_bf16 v166, v58, v58, v166
    v_dot2_f32_bf16 v163, v59, s36, v163
    v_dot2_f32_bf16 v167, v59, v59, v167
    v_dot2_f32_bf16 v160, v60, s36, v160
    v_dot2_f32_bf16 v164, v60, v60, v164
    v_dot2_f32_bf16 v161, v61, s36, v161
    v_dot2_f32_bf16 v165, v61, v61, v165
    v_dot2_f32_bf16 v162, v62, s36, v162
    v_dot2_f32_bf16 v166, v62, v62, v166
    v_dot2_f32_bf16 v163, v63, s36, v163
    v_dot2_f32_bf16 v167, v63, v63, v167
    v_dot2_f32_bf16 v160, v64, s36, v160
    v_dot2_f32_bf16 v164, v64, v64, v164
    v_dot2_f32_bf16 v161, v65, s36, v161
    v_dot2_f32_bf16 v165, v65, v65, v165
    v_dot2_f32_bf16 v162, v66, s36, v162
    v_dot2_f32_bf16 v166, v66, v66, v166
    v_dot2_f32_bf16 v163, v67, s36, v163
    v_dot2_f32_bf16 v167, v67, v67, v167
    v_dot2_f32_bf16 v160, v68, s36, v160
    v_dot2_f32_bf16 v164, v68, v68, v164
    v_dot2_f32_bf16 v161, v69, s36, v161
    v_dot2_f32_bf16 v165, v69, v69, v165
    v_dot2_f32_bf16 v162, v70, s36, v162
    v_dot2_f32_bf16 v166, v70, v70, v166
    v_dot2_f32_bf16 v163, v71, s36, v163
    v_dot2_f32_bf16 v167, v71, v71, v167
    v_dot2_f32_bf16 v160, v72, s36, v160
    v_dot2_f32_bf16 v164, v72, v72, v164
    v_dot2_f32_bf16 v161, v73, s36, v161
    v_dot2_f32_bf16 v165, v73, v73, v165
    v_dot2_f32_bf16 v162, v74, s36, v162
    v_dot2_f32_bf16 v166, v74, v74, v166
    v_dot2_f32_bf16 v163, v75, s36, v163
    v_dot2_f32_bf16 v167, v75, v75, v167
    v_dot2_f32_bf16 v160, v76, s36, v160
    v_dot2_f32_bf16 v164, v76, v76, v164
    v_dot2_f32_bf16 v161, v77, s36, v161
    v_dot2_f32_bf16 v165, v77, v77, v165
    v_dot2_f32_bf16 v162, v78, s36, v162
    v_dot2_f32_bf16 v166, v78, v78, v166
    v_dot2_f32_bf16 v163, v79, s36, v163
    v_dot2_f32_bf16 v167, v79, v79, v167
    v_dot2_f32_bf16 v160, v80, s36, v160
    v_dot2_f32_bf16 v164, v80, v80, v164
    v_dot2_f32_bf16 v161, v81, s36, v161
    v_dot2_f32_bf16 v165, v81, v81, v165
    v_dot2_f32_bf16 v162, v82, s36, v162
    v_dot2_f32_bf16 v166, v82, v82, v166
    v_dot2_f32_bf16 v163, v83, s36, v163
    v_dot2_f32_bf16 v167, v83, v83, v167
    v_dot2_f32_bf16 v160, v84, s36, v160
    v_dot2_f32_bf16 v164, v84, v84, v164
    v_dot2_f32_bf16 v161, v85, s36, v161
    v_dot2_f32_bf16 v165, v85, v85, v165
    v_dot2_f32_bf16 v162, v86, s36, v162
    v_dot2_f32_bf16 v166, v86, v86, v166
    v_dot2_f32_bf16 v163, v87, s36, v163
    v_dot2_f32_bf16 v167, v87, v87, v167
    s_nop 3
    v_add_f32 v160, v160, v161
    v_add_f32 v162, v162, v163
    v_add_f32 v164, v164, v165
    v_add_f32 v166, v166, v167
    v_add_f32 v160, v160, v162
    v_add_f32 v164, v164, v166
    v_mov_b32 v161, v160
    v_mov_b32 v165, v164
    s_nop 1
    v_permlane32_swap_b32 v160, v161
    v_permlane32_swap_b32 v164, v165
    v_add_f32 v160, v160, v161
    v_add_f32 v164, v164, v165
    v_mov_b32 v161, v160
    v_mov_b32 v165, v164
    s_nop 1
    v_permlane16_swap_b32 v160, v161
    v_permlane16_swap_b32 v164, v165
    v_add_f32 v160, v160, v161
    v_add_f32 v164, v164, v165
    s_mov_b32 s36, 0x3ae38e39
    v_mul_f32 v160, s36, v160
    v_mul_f32 v164, s36, v164
    v_fma_f32 v164, -v160, v160, v164
    v_max_f32 v164, 0, v164
    v_cvt_pk_bf16_f32 v161, v160, v164
    v_lshlrev_b32 v160, 16, v161
    v_and_b32 v164, 0xffff0000, v161
    v_add_f32 v164, 0x3727c5ac, v164
    v_cvt_pk_bf16_f32 v164, v164, v164
    v_lshlrev_b32 v164, 16, v164
    v_sqrt_f32 v164, v164
    s_nop 0
    v_cvt_pk_bf16_f32 v164, v164, v164
    v_lshlrev_b32 v164, 16, v164
    v_rcp_f32 v164, v164
    s_nop 0
    v_mul_f32 v160, v160, v164
    s_mov_b32 s36, 0xffff0000
    s_add_u32 m0, s34, 36864
    s_add_u32 s35, s31, 221184
    buffer_load_dwordx4 v4, s[16:19], s35 offen lds
    v_lshlrev_b32 v168, 16, v16
    v_and_b32 v169, s36, v16
    v_fma_f32 v168, v168, v164, -v160
    v_fma_f32 v169, v169, v164, -v160
    v_cvt_pk_bf16_f32 v16, v168, v169
    v_lshlrev_b32 v170, 16, v17
    v_and_b32 v171, s36, v17
    v_fma_f32 v170, v170, v164, -v160
    v_fma_f32 v171, v171, v164, -v160
    v_cvt_pk_bf16_f32 v17, v170, v171
    v_lshlrev_b32 v168, 16, v18
    v_and_b32 v169, s36, v18
    v_fma_f32 v168, v168, v164, -v160
    v_fma_f32 v169, v169, v164, -v160
    v_cvt_pk_bf16_f32 v18, v168, v169
    v_lshlrev_b32 v170, 16, v19
    v_and_b32 v171, s36, v19
    v_fma_f32 v170, v170, v164, -v160
    v_fma_f32 v171, v171, v164, -v160
    v_cvt_pk_bf16_f32 v19, v170, v171
    s_add_u32 m0, s34, 40960
    s_add_u32 s35, s31, 221184
    buffer_load_dwordx4 v5, s[16:19], s35 offen lds
    v_lshlrev_b32 v168, 16, v20
    v_and_b32 v169, s36, v20
    v_fma_f32 v168, v168, v164, -v160
    v_fma_f32 v169, v169, v164, -v160
    v_cvt_pk_bf16_f32 v20, v168, v169
    v_lshlrev_b32 v170, 16, v21
    v_and_b32 v171, s36, v21
    v_fma_f32 v170, v170, v164, -v160
    v_fma_f32 v171, v171, v164, -v160
    v_cvt_pk_bf16_f32 v21, v170, v171
    v_lshlrev_b32 v168, 16, v22
    v_and_b32 v169, s36, v22
    v_fma_f32 v168, v168, v164, -v160
    v_fma_f32 v169, v169, v164, -v160
    v_cvt_pk_bf16_f32 v22, v168, v169
    v_lshlrev_b32 v170, 16, v23
    v_and_b32 v171, s36, v23
    v_fma_f32 v170, v170, v164, -v160
    v_fma_f32 v171, v171, v164, -v160
    v_cvt_pk_bf16_f32 v23, v170, v171
    s_add_u32 m0, s34, 45056
    s_add_u32 s35, s31, 221184
    buffer_load_dwordx4 v6, s[16:19], s35 offen lds
    v_lshlrev_b32 v168, 16, v24
    v_and_b32 v169, s36, v24
    v_fma_f32 v168, v168, v164, -v160
    v_fma_f32 v169, v169, v164, -v160
    v_cvt_pk_bf16_f32 v24, v168, v169
    v_lshlrev_b32 v170, 16, v25
    v_and_b32 v171, s36, v25
    v_fma_f32 v170, v170, v164, -v160
    v_fma_f32 v171, v171, v164, -v160
    v_cvt_pk_bf16_f32 v25, v170, v171
    v_lshlrev_b32 v168, 16, v26
    v_and_b32 v169, s36, v26
    v_fma_f32 v168, v168, v164, -v160
    v_fma_f32 v169, v169, v164, -v160
    v_cvt_pk_bf16_f32 v26, v168, v169
    v_lshlrev_b32 v170, 16, v27
    v_and_b32 v171, s36, v27
    v_fma_f32 v170, v170, v164, -v160
    v_fma_f32 v171, v171, v164, -v160
    v_cvt_pk_bf16_f32 v27, v170, v171
    s_add_u32 m0, s34, 49152
    s_add_u32 s35, s31, 294912
    buffer_load_dwordx4 v4, s[16:19], s35 offen lds
    v_lshlrev_b32 v168, 16, v28
    v_and_b32 v169, s36, v28
    v_fma_f32 v168, v168, v164, -v160
    v_fma_f32 v169, v169, v164, -v160
    v_cvt_pk_bf16_f32 v28, v168, v169
    v_lshlrev_b32 v170, 16, v29
    v_and_b32 v171, s36, v29
    v_fma_f32 v170, v170, v164, -v160
    v_fma_f32 v171, v171, v164, -v160
    v_cvt_pk_bf16_f32 v29, v170, v171
    v_lshlrev_b32 v168, 16, v30
    v_and_b32 v169, s36, v30
    v_fma_f32 v168, v168, v164, -v160
    v_fma_f32 v169, v169, v164, -v160
    v_cvt_pk_bf16_f32 v30, v168, v169
    v_lshlrev_b32 v170, 16, v31
    v_and_b32 v171, s36, v31
    v_fma_f32 v170, v170, v164, -v160
    v_fma_f32 v171, v171, v164, -v160
    v_cvt_pk_bf16_f32 v31, v170, v171
    s_add_u32 m0, s34, 53248
    s_add_u32 s35, s31, 294912
    buffer_load_dwordx4 v5, s[16:19], s35 offen lds
    v_lshlrev_b32 v168, 16, v32
    v_and_b32 v169, s36, v32
    v_fma_f32 v168, v168, v164, -v160
    v_fma_f32 v169, v169, v164, -v160
    v_cvt_pk_bf16_f32 v32, v168, v169
    v_lshlrev_b32 v170, 16, v33
    v_and_b32 v171, s36, v33
    v_fma_f32 v170, v170, v164, -v160
    v_fma_f32 v171, v171, v164, -v160
    v_cvt_pk_bf16_f32 v33, v170, v171
    v_lshlrev_b32 v168, 16, v34
    v_and_b32 v169, s36, v34
    v_fma_f32 v168, v168, v164, -v160
    v_fma_f32 v169, v169, v164, -v160
    v_cvt_pk_bf16_f32 v34, v168, v169
    v_lshlrev_b32 v170, 16, v35
    v_and_b32 v171, s36, v35
    v_fma_f32 v170, v170, v164, -v160
    v_fma_f32 v171, v171, v164, -v160
    v_cvt_pk_bf16_f32 v35, v170, v171
    s_add_u32 m0, s34, 57344
    s_add_u32 s35, s31, 294912
    buffer_load_dwordx4 v6, s[16:19], s35 offen lds
    v_lshlrev_b32 v168, 16, v36
    v_and_b32 v169, s36, v36
    v_fma_f32 v168, v168, v164, -v160
    v_fma_f32 v169, v169, v164, -v160
    v_cvt_pk_bf16_f32 v36, v168, v169
    v_lshlrev_b32 v170, 16, v37
    v_and_b32 v171, s36, v37
    v_fma_f32 v170, v170, v164, -v160
    v_fma_f32 v171, v171, v164, -v160
    v_cvt_pk_bf16_f32 v37, v170, v171
    v_lshlrev_b32 v168, 16, v38
    v_and_b32 v169, s36, v38
    v_fma_f32 v168, v168, v164, -v160
    v_fma_f32 v169, v169, v164, -v160
    v_cvt_pk_bf16_f32 v38, v168, v169
    v_lshlrev_b32 v170, 16, v39
    v_and_b32 v171, s36, v39
    v_fma_f32 v170, v170, v164, -v160
    v_fma_f32 v171, v171, v164, -v160
    v_cvt_pk_bf16_f32 v39, v170, v171
    s_add_u32 m0, s34, 61440
    s_add_u32 s35, s31, 368640
    buffer_load_dwordx4 v4, s[16:19], s35 offen lds
    v_lshlrev_b32 v168, 16, v40
    v_and_b32 v169, s36, v40
    v_fma_f32 v168, v168, v164, -v160
    v_fma_f32 v169, v169, v164, -v160
    v_cvt_pk_bf16_f32 v40, v168, v169
    v_lshlrev_b32 v170, 16, v41
    v_and_b32 v171, s36, v41
    v_fma_f32 v170, v170, v164, -v160
    v_fma_f32 v171, v171, v164, -v160
    v_cvt_pk_bf16_f32 v41, v170, v171
    v_lshlrev_b32 v168, 16, v42
    v_and_b32 v169, s36, v42
    v_fma_f32 v168, v168, v164, -v160
    v_fma_f32 v169, v169, v164, -v160
    v_cvt_pk_bf16_f32 v42, v168, v169
    v_lshlrev_b32 v170, 16, v43
    v_and_b32 v171, s36, v43
    v_fma_f32 v170, v170, v164, -v160
    v_fma_f32 v171, v171, v164, -v160
    v_cvt_pk_bf16_f32 v43, v170, v171
    s_add_u32 m0, s34, 65536
    s_add_u32 s35, s31, 368640
    buffer_load_dwordx4 v5, s[16:19], s35 offen lds
    v_lshlrev_b32 v168, 16, v44
    v_and_b32 v169, s36, v44
    v_fma_f32 v168, v168, v164, -v160
    v_fma_f32 v169, v169, v164, -v160
    v_cvt_pk_bf16_f32 v44, v168, v169
    v_lshlrev_b32 v170, 16, v45
    v_and_b32 v171, s36, v45
    v_fma_f32 v170, v170, v164, -v160
    v_fma_f32 v171, v171, v164, -v160
    v_cvt_pk_bf16_f32 v45, v170, v171
    v_lshlrev_b32 v168, 16, v46
    v_and_b32 v169, s36, v46
    v_fma_f32 v168, v168, v164, -v160
    v_fma_f32 v169, v169, v164, -v160
    v_cvt_pk_bf16_f32 v46, v168, v169
    v_lshlrev_b32 v170, 16, v47
    v_and_b32 v171, s36, v47
    v_fma_f32 v170, v170, v164, -v160
    v_fma_f32 v171, v171, v164, -v160
    v_cvt_pk_bf16_f32 v47, v170, v171
    s_add_u32 m0, s34, 69632
    s_add_u32 s35, s31, 368640
    buffer_load_dwordx4 v6, s[16:19], s35 offen lds
    v_lshlrev_b32 v168, 16, v48
    v_and_b32 v169, s36, v48
    v_fma_f32 v168, v168, v164, -v160
    v_fma_f32 v169, v169, v164, -v160
    v_cvt_pk_bf16_f32 v48, v168, v169
    v_lshlrev_b32 v170, 16, v49
    v_and_b32 v171, s36, v49
    v_fma_f32 v170, v170, v164, -v160
    v_fma_f32 v171, v171, v164, -v160
    v_cvt_pk_bf16_f32 v49, v170, v171
    v_lshlrev_b32 v168, 16, v50
    v_and_b32 v169, s36, v50
    v_fma_f32 v168, v168, v164, -v160
    v_fma_f32 v169, v169, v164, -v160
    v_cvt_pk_bf16_f32 v50, v168, v169
    v_lshlrev_b32 v170, 16, v51
    v_and_b32 v171, s36, v51
    v_fma_f32 v170, v170, v164, -v160
    v_fma_f32 v171, v171, v164, -v160
    v_cvt_pk_bf16_f32 v51, v170, v171
    s_add_u32 m0, s34, 73728
    s_add_u32 s35, s31, 442368
    buffer_load_dwordx4 v4, s[16:19], s35 offen lds
    v_lshlrev_b32 v168, 16, v52
    v_and_b32 v169, s36, v52
    v_fma_f32 v168, v168, v164, -v160
    v_fma_f32 v169, v169, v164, -v160
    v_cvt_pk_bf16_f32 v52, v168, v169
    v_lshlrev_b32 v170, 16, v53
    v_and_b32 v171, s36, v53
    v_fma_f32 v170, v170, v164, -v160
    v_fma_f32 v171, v171, v164, -v160
    v_cvt_pk_bf16_f32 v53, v170, v171
    v_lshlrev_b32 v168, 16, v54
    v_and_b32 v169, s36, v54
    v_fma_f32 v168, v168, v164, -v160
    v_fma_f32 v169, v169, v164, -v160
    v_cvt_pk_bf16_f32 v54, v168, v169
    v_lshlrev_b32 v170, 16, v55
    v_and_b32 v171, s36, v55
    v_fma_f32 v170, v170, v164, -v160
    v_fma_f32 v171, v171, v164, -v160
    v_cvt_pk_bf16_f32 v55, v170, v171
    s_add_u32 m0, s34, 77824
    s_add_u32 s35, s31, 442368
    buffer_load_dwordx4 v5, s[16:19], s35 offen lds
    v_lshlrev_b32 v168, 16, v56
    v_and_b32 v169, s36, v56
    v_fma_f32 v168, v168, v164, -v160
    v_fma_f32 v169, v169, v164, -v160
    v_cvt_pk_bf16_f32 v56, v168, v169
    v_lshlrev_b32 v170, 16, v57
    v_and_b32 v171, s36, v57
    v_fma_f32 v170, v170, v164, -v160
    v_fma_f32 v171, v171, v164, -v160
    v_cvt_pk_bf16_f32 v57, v170, v171
    v_lshlrev_b32 v168, 16, v58
    v_and_b32 v169, s36, v58
    v_fma_f32 v168, v168, v164, -v160
    v_fma_f32 v169, v169, v164, -v160
    v_cvt_pk_bf16_f32 v58, v168, v169
    v_lshlrev_b32 v170, 16, v59
    v_and_b32 v171, s36, v59
    v_fma_f32 v170, v170, v164, -v160
    v_fma_f32 v171, v171, v164, -v160
    v_cvt_pk_bf16_f32 v59, v170, v171
    s_add_u32 m0, s34, 81920
    s_add_u32 s35, s31, 442368
    buffer_load_dwordx4 v6, s[16:19], s35 offen lds
    v_lshlrev_b32 v168, 16, v60
    v_and_b32 v169, s36, v60
    v_fma_f32 v168, v168, v164, -v160
    v_fma_f32 v169, v169, v164, -v160
    v_cvt_pk_bf16_f32 v60, v168, v169
    v_lshlrev_b32 v170, 16, v61
    v_and_b32 v171, s36, v61
    v_fma_f32 v170, v170, v164, -v160
    v_fma_f32 v171, v171, v164, -v160
    v_cvt_pk_bf16_f32 v61, v170, v171
    v_lshlrev_b32 v168, 16, v62
    v_and_b32 v169, s36, v62
    v_fma_f32 v168, v168, v164, -v160
    v_fma_f32 v169, v169, v164, -v160
    v_cvt_pk_bf16_f32 v62, v168, v169
    v_lshlrev_b32 v170, 16, v63
    v_and_b32 v171, s36, v63
    v_fma_f32 v170, v170, v164, -v160
    v_fma_f32 v171, v171, v164, -v160
    v_cvt_pk_bf16_f32 v63, v170, v171
    s_add_u32 m0, s34, 86016
    s_add_u32 s35, s31, 516096
    buffer_load_dwordx4 v4, s[16:19], s35 offen lds
    v_lshlrev_b32 v168, 16, v64
    v_and_b32 v169, s36, v64
    v_fma_f32 v168, v168, v164, -v160
    v_fma_f32 v169, v169, v164, -v160
    v_cvt_pk_bf16_f32 v64, v168, v169
    v_lshlrev_b32 v170, 16, v65
    v_and_b32 v171, s36, v65
    v_fma_f32 v170, v170, v164, -v160
    v_fma_f32 v171, v171, v164, -v160
    v_cvt_pk_bf16_f32 v65, v170, v171
    v_lshlrev_b32 v168, 16, v66
    v_and_b32 v169, s36, v66
    v_fma_f32 v168, v168, v164, -v160
    v_fma_f32 v169, v169, v164, -v160
    v_cvt_pk_bf16_f32 v66, v168, v169
    v_lshlrev_b32 v170, 16, v67
    v_and_b32 v171, s36, v67
    v_fma_f32 v170, v170, v164, -v160
    v_fma_f32 v171, v171, v164, -v160
    v_cvt_pk_bf16_f32 v67, v170, v171
    s_add_u32 m0, s34, 90112
    s_add_u32 s35, s31, 516096
    buffer_load_dwordx4 v5, s[16:19], s35 offen lds
    v_lshlrev_b32 v168, 16, v68
    v_and_b32 v169, s36, v68
    v_fma_f32 v168, v168, v164, -v160
    v_fma_f32 v169, v169, v164, -v160
    v_cvt_pk_bf16_f32 v68, v168, v169
    v_lshlrev_b32 v170, 16, v69
    v_and_b32 v171, s36, v69
    v_fma_f32 v170, v170, v164, -v160
    v_fma_f32 v171, v171, v164, -v160
    v_cvt_pk_bf16_f32 v69, v170, v171
    v_lshlrev_b32 v168, 16, v70
    v_and_b32 v169, s36, v70
    v_fma_f32 v168, v168, v164, -v160
    v_fma_f32 v169, v169, v164, -v160
    v_cvt_pk_bf16_f32 v70, v168, v169
    v_lshlrev_b32 v170, 16, v71
    v_and_b32 v171, s36, v71
    v_fma_f32 v170, v170, v164, -v160
    v_fma_f32 v171, v171, v164, -v160
    v_cvt_pk_bf16_f32 v71, v170, v171
    s_add_u32 m0, s34, 94208
    s_add_u32 s35, s31, 516096
    buffer_load_dwordx4 v6, s[16:19], s35 offen lds
    v_lshlrev_b32 v168, 16, v72
    v_and_b32 v169, s36, v72
    v_fma_f32 v168, v168, v164, -v160
    v_fma_f32 v169, v169, v164, -v160
    v_cvt_pk_bf16_f32 v72, v168, v169
    v_lshlrev_b32 v170, 16, v73
    v_and_b32 v171, s36, v73
    v_fma_f32 v170, v170, v164, -v160
    v_fma_f32 v171, v171, v164, -v160
    v_cvt_pk_bf16_f32 v73, v170, v171
    v_lshlrev_b32 v168, 16, v74
    v_and_b32 v169, s36, v74
    v_fma_f32 v168, v168, v164, -v160
    v_fma_f32 v169, v169, v164, -v160
    v_cvt_pk_bf16_f32 v74, v168, v169
    v_lshlrev_b32 v170, 16, v75
    v_and_b32 v171, s36, v75
    v_fma_f32 v170, v170, v164, -v160
    v_fma_f32 v171, v171, v164, -v160
    v_cvt_pk_bf16_f32 v75, v170, v171
    s_add_u32 m0, s34, 98304
    s_add_u32 s35, s31, 589824
    buffer_load_dwordx4 v4, s[16:19], s35 offen lds
    v_lshlrev_b32 v168, 16, v76
    v_and_b32 v169, s36, v76
    v_fma_f32 v168, v168, v164, -v160
    v_fma_f32 v169, v169, v164, -v160
    v_cvt_pk_bf16_f32 v76, v168, v169
    v_lshlrev_b32 v170, 16, v77
    v_and_b32 v171, s36, v77
    v_fma_f32 v170, v170, v164, -v160
    v_fma_f32 v171, v171, v164, -v160
    v_cvt_pk_bf16_f32 v77, v170, v171
    v_lshlrev_b32 v168, 16, v78
    v_and_b32 v169, s36, v78
    v_fma_f32 v168, v168, v164, -v160
    v_fma_f32 v169, v169, v164, -v160
    v_cvt_pk_bf16_f32 v78, v168, v169
    v_lshlrev_b32 v170, 16, v79
    v_and_b32 v171, s36, v79
    v_fma_f32 v170, v170, v164, -v160
    v_fma_f32 v171, v171, v164, -v160
    v_cvt_pk_bf16_f32 v79, v170, v171
    s_add_u32 m0, s34, 102400
    s_add_u32 s35, s31, 589824
    buffer_load_dwordx4 v5, s[16:19], s35 offen lds
    v_lshlrev_b32 v168, 16, v80
    v_and_b32 v169, s36, v80
    v_fma_f32 v168, v168, v164, -v160
    v_fma_f32 v169, v169, v164, -v160
    v_cvt_pk_bf16_f32 v80, v168, v169
    v_lshlrev_b32 v170, 16, v81
    v_and_b32 v171, s36, v81
    v_fma_f32 v170, v170, v164, -v160
    v_fma_f32 v171, v171, v164, -v160
    v_cvt_pk_bf16_f32 v81, v170, v171
    v_lshlrev_b32 v168, 16, v82
    v_and_b32 v169, s36, v82
    v_fma_f32 v168, v168, v164, -v160
    v_fma_f32 v169, v169, v164, -v160
    v_cvt_pk_bf16_f32 v82, v168, v169
    v_lshlrev_b32 v170, 16, v83
    v_and_b32 v171, s36, v83
    v_fma_f32 v170, v170, v164, -v160
    v_fma_f32 v171, v171, v164, -v160
    v_cvt_pk_bf16_f32 v83, v170, v171
    s_add_u32 m0, s34, 106496
    s_add_u32 s35, s31, 589824
    buffer_load_dwordx4 v6, s[16:19], s35 offen lds
    v_lshlrev_b32 v168, 16, v84
    v_and_b32 v169, s36, v84
    v_fma_f32 v168, v168, v164, -v160
    v_fma_f32 v169, v169, v164, -v160
    v_cvt_pk_bf16_f32 v84, v168, v169
    v_lshlrev_b32 v170, 16, v85
    v_and_b32 v171, s36, v85
    v_fma_f32 v170, v170, v164, -v160
    v_fma_f32 v171, v171, v164, -v160
    v_cvt_pk_bf16_f32 v85, v170, v171
    v_lshlrev_b32 v168, 16, v86
    v_and_b32 v169, s36, v86
    v_fma_f32 v168, v168, v164, -v160
    v_fma_f32 v169, v169, v164, -v160
    v_cvt_pk_bf16_f32 v86, v168, v169
    v_lshlrev_b32 v170, 16, v87
    v_and_b32 v171, s36, v87
    v_fma_f32 v170, v170, v164, -v160
    v_fma_f32 v171, v171, v164, -v160
    v_cvt_pk_bf16_f32 v87, v170, v171
    s_waitcnt vmcnt(18)
    s_barrier
    ds_read_b64_tr_b16 v[88:89], v7 offset:0
    ds_read_b64_tr_b16 v[90:91], v7 offset:768
    ds_read_b64_tr_b16 v[92:93], v9 offset:32
    ds_read_b64_tr_b16 v[94:95], v9 offset:800
    ds_read_b64_tr_b16 v[96:97], v7 offset:64
    ds_read_b64_tr_b16 v[98:99], v7 offset:832
    ds_read_b64_tr_b16 v[100:101], v9 offset:96
    ds_read_b64_tr_b16 v[102:103], v9 offset:864
    ds_read_b64_tr_b16 v[104:105], v7 offset:128
    ds_read_b64_tr_b16 v[106:107], v7 offset:896
    ds_read_b64_tr_b16 v[108:109], v9 offset:160
    ds_read_b64_tr_b16 v[110:111], v9 offset:928
    ds_read_b64_tr_b16 v[112:113], v7 offset:6144
    ds_read_b64_tr_b16 v[114:115], v7 offset:6912
    ds_read_b64_tr_b16 v[116:117], v9 offset:6176
    ds_read_b64_tr_b16 v[118:119], v9 offset:6944
    ds_read_b64_tr_b16 v[120:121], v7 offset:6208
    ds_read_b64_tr_b16 v[122:123], v7 offset:6976
    ds_read_b64_tr_b16 v[124:125], v9 offset:6240
    ds_read_b64_tr_b16 v[126:127], v9 offset:7008
    ds_read_b64_tr_b16 v[128:129], v7 offset:6272
    ds_read_b64_tr_b16 v[130:131], v7 offset:7040
    ds_read_b64_tr_b16 v[132:133], v9 offset:6304
    ds_read_b64_tr_b16 v[134:135], v9 offset:7072
    s_waitcnt lgkmcnt(12)
    v_mfma_f32_16x16x32_bf16 v[136:139], v[88:91], v[16:19], v[136:139]
    v_mfma_f32_16x16x32_bf16 v[140:143], v[92:95], v[16:19], v[140:143]
    v_mfma_f32_16x16x32_bf16 v[144:147], v[96:99], v[16:19], v[144:147]
    v_mfma_f32_16x16x32_bf16 v[148:151], v[100:103], v[16:19], v[148:151]
    v_mfma_f32_16x16x32_bf16 v[152:155], v[104:107], v[16:19], v[152:155]
    v_mfma_f32_16x16x32_bf16 v[156:159], v[108:111], v[16:19], v[156:159]
    ds_read_b64_tr_b16 v[88:89], v7 offset:12288
    ds_read_b64_tr_b16 v[90:91], v7 offset:13056
    ds_read_b64_tr_b16 v[92:93], v9 offset:12320
    ds_read_b64_tr_b16 v[94:95], v9 offset:13088
    ds_read_b64_tr_b16 v[96:97], v7 offset:12352
    ds_read_b64_tr_b16 v[98:99], v7 offset:13120
    ds_read_b64_tr_b16 v[100:101], v9 offset:12384
    ds_read_b64_tr_b16 v[102:103], v9 offset:13152
    ds_read_b64_tr_b16 v[104:105], v7 offset:12416
    ds_read_b64_tr_b16 v[106:107], v7 offset:13184
    ds_read_b64_tr_b16 v[108:109], v9 offset:12448
    ds_read_b64_tr_b16 v[110:111], v9 offset:13216
    s_waitcnt lgkmcnt(12)
    v_mfma_f32_16x16x32_bf16 v[136:139], v[112:115], v[20:23], v[136:139]
    v_mfma_f32_16x16x32_bf16 v[140:143], v[116:119], v[20:23], v[140:143]
    v_mfma_f32_16x16x32_bf16 v[144:147], v[120:123], v[20:23], v[144:147]
    v_mfma_f32_16x16x32_bf16 v[148:151], v[124:127], v[20:23], v[148:151]
    v_mfma_f32_16x16x32_bf16 v[152:155], v[128:131], v[20:23], v[152:155]
    v_mfma_f32_16x16x32_bf16 v[156:159], v[132:135], v[20:23], v[156:159]
    ds_read_b64_tr_b16 v[112:113], v7 offset:18432
    ds_read_b64_tr_b16 v[114:115], v7 offset:19200
    ds_read_b64_tr_b16 v[116:117], v9 offset:18464
    ds_read_b64_tr_b16 v[118:119], v9 offset:19232
    ds_read_b64_tr_b16 v[120:121], v7 offset:18496
    ds_read_b64_tr_b16 v[122:123], v7 offset:19264
    ds_read_b64_tr_b16 v[124:125], v9 offset:18528
    ds_read_b64_tr_b16 v[126:127], v9 offset:19296
    ds_read_b64_tr_b16 v[128:129], v7 offset:18560
    ds_read_b64_tr_b16 v[130:131], v7 offset:19328
    ds_read_b64_tr_b16 v[132:133], v9 offset:18592
    ds_read_b64_tr_b16 v[134:135], v9 offset:19360
    s_waitcnt lgkmcnt(12)
    v_mfma_f32_16x16x32_bf16 v[136:139], v[88:91], v[24:27], v[136:139]
    v_mfma_f32_16x16x32_bf16 v[140:143], v[92:95], v[24:27], v[140:143]
    v_mfma_f32_16x16x32_bf16 v[144:147], v[96:99], v[24:27], v[144:147]
    v_mfma_f32_16x16x32_bf16 v[148:151], v[100:103], v[24:27], v[148:151]
    v_mfma_f32_16x16x32_bf16 v[152:155], v[104:107], v[24:27], v[152:155]
    v_mfma_f32_16x16x32_bf16 v[156:159], v[108:111], v[24:27], v[156:159]
    ds_read_b64_tr_b16 v[88:89], v7 offset:24576
    ds_read_b64_tr_b16 v[90:91], v7 offset:25344
    ds_read_b64_tr_b16 v[92:93], v9 offset:24608
    ds_read_b64_tr_b16 v[94:95], v9 offset:25376
    ds_read_b64_tr_b16 v[96:97], v7 offset:24640
    ds_read_b64_tr_b16 v[98:99], v7 offset:25408
    ds_read_b64_tr_b16 v[100:101], v9 offset:24672
    ds_read_b64_tr_b16 v[102:103], v9 offset:25440
    ds_read_b64_tr_b16 v[104:105], v7 offset:24704
    ds_read_b64_tr_b16 v[106:107], v7 offset:25472
    ds_read_b64_tr_b16 v[108:109], v9 offset:24736
    ds_read_b64_tr_b16 v[110:111], v9 offset:25504
    s_waitcnt lgkmcnt(12)
    v_mfma_f32_16x16x32_bf16 v[136:139], v[112:115], v[28:31], v[136:139]
    v_mfma_f32_16x16x32_bf16 v[140:143], v[116:119], v[28:31], v[140:143]
    v_mfma_f32_16x16x32_bf16 v[144:147], v[120:123], v[28:31], v[144:147]
    v_mfma_f32_16x16x32_bf16 v[148:151], v[124:127], v[28:31], v[148:151]
    v_mfma_f32_16x16x32_bf16 v[152:155], v[128:131], v[28:31], v[152:155]
    v_mfma_f32_16x16x32_bf16 v[156:159], v[132:135], v[28:31], v[156:159]
    ds_read_b64_tr_b16 v[112:113], v7 offset:30720
    ds_read_b64_tr_b16 v[114:115], v7 offset:31488
    ds_read_b64_tr_b16 v[116:117], v9 offset:30752
    ds_read_b64_tr_b16 v[118:119], v9 offset:31520
    ds_read_b64_tr_b16 v[120:121], v7 offset:30784
    ds_read_b64_tr_b16 v[122:123], v7 offset:31552
    ds_read_b64_tr_b16 v[124:125], v9 offset:30816
    ds_read_b64_tr_b16 v[126:127], v9 offset:31584
    ds_read_b64_tr_b16 v[128:129], v7 offset:30848
    ds_read_b64_tr_b16 v[130:131], v7 offset:31616
    ds_read_b64_tr_b16 v[132:133], v9 offset:30880
    ds_read_b64_tr_b16 v[134:135], v9 offset:31648
    s_waitcnt lgkmcnt(12)
    v_mfma_f32_16x16x32_bf16 v[136:139], v[88:91], v[32:35], v[136:139]
    v_mfma_f32_16x16x32_bf16 v[140:143], v[92:95], v[32:35], v[140:143]
    v_mfma_f32_16x16x32_bf16 v[144:147], v[96:99], v[32:35], v[144:147]
    v_mfma_f32_16x16x32_bf16 v[148:151], v[100:103], v[32:35], v[148:151]
    v_mfma_f32_16x16x32_bf16 v[152:155], v[104:107], v[32:35], v[152:155]
    v_mfma_f32_16x16x32_bf16 v[156:159], v[108:111], v[32:35], v[156:159]
    s_waitcnt vmcnt(9)
    s_barrier
    ds_read_b64_tr_b16 v[88:89], v7 offset:36864
    ds_read_b64_tr_b16 v[90:91], v7 offset:37632
    ds_read_b64_tr_b16 v[92:93], v9 offset:36896
    ds_read_b64_tr_b16 v[94:95], v9 offset:37664
    ds_read_b64_tr_b16 v[96:97], v7 offset:36928
    ds_read_b64_tr_b16 v[98:99], v7 offset:37696
    ds_read_b64_tr_b16 v[100:101], v9 offset:36960
    ds_read_b64_tr_b16 v[102:103], v9 offset:37728
    ds_read_b64_tr_b16 v[104:105], v7 offset:36992
    ds_read_b64_tr_b16 v[106:107], v7 offset:37760
    ds_read_b64_tr_b16 v[108:109], v9 offset:37024
    ds_read_b64_tr_b16 v[110:111], v9 offset:37792
    s_waitcnt lgkmcnt(12)
    v_mfma_f32_16x16x32_bf16 v[136:139], v[112:115], v[36:39], v[136:139]
    v_mfma_f32_16x16x32_bf16 v[140:143], v[116:119], v[36:39], v[140:143]
    v_mfma_f32_16x16x32_bf16 v[144:147], v[120:123], v[36:39], v[144:147]
    v_mfma_f32_16x16x32_bf16 v[148:151], v[124:127], v[36:39], v[148:151]
    v_mfma_f32_16x16x32_bf16 v[152:155], v[128:131], v[36:39], v[152:155]
    v_mfma_f32_16x16x32_bf16 v[156:159], v[132:135], v[36:39], v[156:159]
    ds_read_b64_tr_b16 v[112:113], v7 offset:43008
    ds_read_b64_tr_b16 v[114:115], v7 offset:43776
    ds_read_b64_tr_b16 v[116:117], v9 offset:43040
    ds_read_b64_tr_b16 v[118:119], v9 offset:43808
    ds_read_b64_tr_b16 v[120:121], v7 offset:43072
    ds_read_b64_tr_b16 v[122:123], v7 offset:43840
    ds_read_b64_tr_b16 v[124:125], v9 offset:43104
    ds_read_b64_tr_b16 v[126:127], v9 offset:43872
    ds_read_b64_tr_b16 v[128:129], v7 offset:43136
    ds_read_b64_tr_b16 v[130:131], v7 offset:43904
    ds_read_b64_tr_b16 v[132:133], v9 offset:43168
    ds_read_b64_tr_b16 v[134:135], v9 offset:43936
    s_waitcnt lgkmcnt(12)
    v_mfma_f32_16x16x32_bf16 v[136:139], v[88:91], v[40:43], v[136:139]
    v_mfma_f32_16x16x32_bf16 v[140:143], v[92:95], v[40:43], v[140:143]
    v_mfma_f32_16x16x32_bf16 v[144:147], v[96:99], v[40:43], v[144:147]
    v_mfma_f32_16x16x32_bf16 v[148:151], v[100:103], v[40:43], v[148:151]
    v_mfma_f32_16x16x32_bf16 v[152:155], v[104:107], v[40:43], v[152:155]
    v_mfma_f32_16x16x32_bf16 v[156:159], v[108:111], v[40:43], v[156:159]
    ds_read_b64_tr_b16 v[88:89], v7 offset:49152
    ds_read_b64_tr_b16 v[90:91], v7 offset:49920
    ds_read_b64_tr_b16 v[92:93], v9 offset:49184
    ds_read_b64_tr_b16 v[94:95], v9 offset:49952
    ds_read_b64_tr_b16 v[96:97], v7 offset:49216
    ds_read_b64_tr_b16 v[98:99], v7 offset:49984
    ds_read_b64_tr_b16 v[100:101], v9 offset:49248
    ds_read_b64_tr_b16 v[102:103], v9 offset:50016
    ds_read_b64_tr_b16 v[104:105], v7 offset:49280
    ds_read_b64_tr_b16 v[106:107], v7 offset:50048
    ds_read_b64_tr_b16 v[108:109], v9 offset:49312
    ds_read_b64_tr_b16 v[110:111], v9 offset:50080
    s_waitcnt lgkmcnt(12)
    v_mfma_f32_16x16x32_bf16 v[136:139], v[112:115], v[44:47], v[136:139]
    v_mfma_f32_16x16x32_bf16 v[140:143], v[116:119], v[44:47], v[140:143]
    v_mfma_f32_16x16x32_bf16 v[144:147], v[120:123], v[44:47], v[144:147]
    v_mfma_f32_16x16x32_bf16 v[148:151], v[124:127], v[44:47], v[148:151]
    v_mfma_f32_16x16x32_bf16 v[152:155], v[128:131], v[44:47], v[152:155]
    v_mfma_f32_16x16x32_bf16 v[156:159], v[132:135], v[44:47], v[156:159]
    ds_read_b64_tr_b16 v[112:113], v8 offset:0
    ds_read_b64_tr_b16 v[114:115], v8 offset:768
    ds_read_b64_tr_b16 v[116:117], v10 offset:32
    ds_read_b64_tr_b16 v[118:119], v10 offset:800
    ds_read_b64_tr_b16 v[120:121], v8 offset:64
    ds_read_b64_tr_b16 v[122:123], v8 offset:832
    ds_read_b64_tr_b16 v[124:125], v10 offset:96
    ds_read_b64_tr_b16 v[126:127], v10 offset:864
    ds_read_b64_tr_b16 v[128:129], v8 offset:128
    ds_read_b64_tr_b16 v[130:131], v8 offset:896
    ds_read_b64_tr_b16 v[132:133], v10 offset:160
    ds_read_b64_tr_b16 v[134:135], v10 offset:928
    s_waitcnt lgkmcnt(12)
    v_mfma_f32_16x16x32_bf16 v[136:139], v[88:91], v[48:51], v[136:139]
    v_mfma_f32_16x16x32_bf16 v[140:143], v[92:95], v[48:51], v[140:143]
    v_mfma_f32_16x16x32_bf16 v[144:147], v[96:99], v[48:51], v[144:147]
    v_mfma_f32_16x16x32_bf16 v[148:151], v[100:103], v[48:51], v[148:151]
    v_mfma_f32_16x16x32_bf16 v[152:155], v[104:107], v[48:51], v[152:155]
    v_mfma_f32_16x16x32_bf16 v[156:159], v[108:111], v[48:51], v[156:159]
    ds_read_b64_tr_b16 v[88:89], v8 offset:6144
    ds_read_b64_tr_b16 v[90:91], v8 offset:6912
    ds_read_b64_tr_b16 v[92:93], v10 offset:6176
    ds_read_b64_tr_b16 v[94:95], v10 offset:6944
    ds_read_b64_tr_b16 v[96:97], v8 offset:6208
    ds_read_b64_tr_b16 v[98:99], v8 offset:6976
    ds_read_b64_tr_b16 v[100:101], v10 offset:6240
    ds_read_b64_tr_b16 v[102:103], v10 offset:7008
    ds_read_b64_tr_b16 v[104:105], v8 offset:6272
    ds_read_b64_tr_b16 v[106:107], v8 offset:7040
    ds_read_b64_tr_b16 v[108:109], v10 offset:6304
    ds_read_b64_tr_b16 v[110:111], v10 offset:7072
    s_waitcnt lgkmcnt(12)
    v_mfma_f32_16x16x32_bf16 v[136:139], v[112:115], v[52:55], v[136:139]
    v_mfma_f32_16x16x32_bf16 v[140:143], v[116:119], v[52:55], v[140:143]
    v_mfma_f32_16x16x32_bf16 v[144:147], v[120:123], v[52:55], v[144:147]
    v_mfma_f32_16x16x32_bf16 v[148:151], v[124:127], v[52:55], v[148:151]
    v_mfma_f32_16x16x32_bf16 v[152:155], v[128:131], v[52:55], v[152:155]
    v_mfma_f32_16x16x32_bf16 v[156:159], v[132:135], v[52:55], v[156:159]
    ds_read_b64_tr_b16 v[112:113], v8 offset:12288
    ds_read_b64_tr_b16 v[114:115], v8 offset:13056
    ds_read_b64_tr_b16 v[116:117], v10 offset:12320
    ds_read_b64_tr_b16 v[118:119], v10 offset:13088
    ds_read_b64_tr_b16 v[120:121], v8 offset:12352
    ds_read_b64_tr_b16 v[122:123], v8 offset:13120
    ds_read_b64_tr_b16 v[124:125], v10 offset:12384
    ds_read_b64_tr_b16 v[126:127], v10 offset:13152
    ds_read_b64_tr_b16 v[128:129], v8 offset:12416
    ds_read_b64_tr_b16 v[130:131], v8 offset:13184
    ds_read_b64_tr_b16 v[132:133], v10 offset:12448
    ds_read_b64_tr_b16 v[134:135], v10 offset:13216
    s_waitcnt lgkmcnt(12)
    v_mfma_f32_16x16x32_bf16 v[136:139], v[88:91], v[56:59], v[136:139]
    v_mfma_f32_16x16x32_bf16 v[140:143], v[92:95], v[56:59], v[140:143]
    v_mfma_f32_16x16x32_bf16 v[144:147], v[96:99], v[56:59], v[144:147]
    v_mfma_f32_16x16x32_bf16 v[148:151], v[100:103], v[56:59], v[148:151]
    v_mfma_f32_16x16x32_bf16 v[152:155], v[104:107], v[56:59], v[152:155]
    v_mfma_f32_16x16x32_bf16 v[156:159], v[108:111], v[56:59], v[156:159]
    s_waitcnt vmcnt(0)
    s_barrier
    ds_read_b64_tr_b16 v[88:89], v8 offset:18432
    ds_read_b64_tr_b16 v[90:91], v8 offset:19200
    ds_read_b64_tr_b16 v[92:93], v10 offset:18464
    ds_read_b64_tr_b16 v[94:95], v10 offset:19232
    ds_read_b64_tr_b16 v[96:97], v8 offset:18496
    ds_read_b64_tr_b16 v[98:99], v8 offset:19264
    ds_read_b64_tr_b16 v[100:101], v10 offset:18528
    ds_read_b64_tr_b16 v[102:103], v10 offset:19296
    ds_read_b64_tr_b16 v[104:105], v8 offset:18560
    ds_read_b64_tr_b16 v[106:107], v8 offset:19328
    ds_read_b64_tr_b16 v[108:109], v10 offset:18592
    ds_read_b64_tr_b16 v[110:111], v10 offset:19360
    s_waitcnt lgkmcnt(12)
    v_mfma_f32_16x16x32_bf16 v[136:139], v[112:115], v[60:63], v[136:139]
    v_mfma_f32_16x16x32_bf16 v[140:143], v[116:119], v[60:63], v[140:143]
    v_mfma_f32_16x16x32_bf16 v[144:147], v[120:123], v[60:63], v[144:147]
    v_mfma_f32_16x16x32_bf16 v[148:151], v[124:127], v[60:63], v[148:151]
    v_mfma_f32_16x16x32_bf16 v[152:155], v[128:131], v[60:63], v[152:155]
    v_mfma_f32_16x16x32_bf16 v[156:159], v[132:135], v[60:63], v[156:159]
    ds_read_b64_tr_b16 v[112:113], v8 offset:24576
    ds_read_b64_tr_b16 v[114:115], v8 offset:25344
    ds_read_b64_tr_b16 v[116:117], v10 offset:24608
    ds_read_b64_tr_b16 v[118:119], v10 offset:25376
    ds_read_b64_tr_b16 v[120:121], v8 offset:24640
    ds_read_b64_tr_b16 v[122:123], v8 offset:25408
    ds_read_b64_tr_b16 v[124:125], v10 offset:24672
    ds_read_b64_tr_b16 v[126:127], v10 offset:25440
    ds_read_b64_tr_b16 v[128:129], v8 offset:24704
    ds_read_b64_tr_b16 v[130:131], v8 offset:25472
    ds_read_b64_tr_b16 v[132:133], v10 offset:24736
    ds_read_b64_tr_b16 v[134:135], v10 offset:25504
    s_waitcnt lgkmcnt(12)
    v_mfma_f32_16x16x32_bf16 v[136:139], v[88:91], v[64:67], v[136:139]
    v_mfma_f32_16x16x32_bf16 v[140:143], v[92:95], v[64:67], v[140:143]
    v_mfma_f32_16x16x32_bf16 v[144:147], v[96:99], v[64:67], v[144:147]
    v_mfma_f32_16x16x32_bf16 v[148:151], v[100:103], v[64:67], v[148:151]
    v_mfma_f32_16x16x32_bf16 v[152:155], v[104:107], v[64:67], v[152:155]
    v_mfma_f32_16x16x32_bf16 v[156:159], v[108:111], v[64:67], v[156:159]
    ds_read_b64_tr_b16 v[88:89], v8 offset:30720
    ds_read_b64_tr_b16 v[90:91], v8 offset:31488
    ds_read_b64_tr_b16 v[92:93], v10 offset:30752
    ds_read_b64_tr_b16 v[94:95], v10 offset:31520
    ds_read_b64_tr_b16 v[96:97], v8 offset:30784
    ds_read_b64_tr_b16 v[98:99], v8 offset:31552
    ds_read_b64_tr_b16 v[100:101], v10 offset:30816
    ds_read_b64_tr_b16 v[102:103], v10 offset:31584
    ds_read_b64_tr_b16 v[104:105], v8 offset:30848
    ds_read_b64_tr_b16 v[106:107], v8 offset:31616
    ds_read_b64_tr_b16 v[108:109], v10 offset:30880
    ds_read_b64_tr_b16 v[110:111], v10 offset:31648
    s_waitcnt lgkmcnt(12)
    v_mfma_f32_16x16x32_bf16 v[136:139], v[112:115], v[68:71], v[136:139]
    v_mfma_f32_16x16x32_bf16 v[140:143], v[116:119], v[68:71], v[140:143]
    v_mfma_f32_16x16x32_bf16 v[144:147], v[120:123], v[68:71], v[144:147]
    v_mfma_f32_16x16x32_bf16 v[148:151], v[124:127], v[68:71], v[148:151]
    v_mfma_f32_16x16x32_bf16 v[152:155], v[128:131], v[68:71], v[152:155]
    v_mfma_f32_16x16x32_bf16 v[156:159], v[132:135], v[68:71], v[156:159]
    ds_read_b64_tr_b16 v[112:113], v8 offset:36864
    ds_read_b64_tr_b16 v[114:115], v8 offset:37632
    ds_read_b64_tr_b16 v[116:117], v10 offset:36896
    ds_read_b64_tr_b16 v[118:119], v10 offset:37664
    ds_read_b64_tr_b16 v[120:121], v8 offset:36928
    ds_read_b64_tr_b16 v[122:123], v8 offset:37696
    ds_read_b64_tr_b16 v[124:125], v10 offset:36960
    ds_read_b64_tr_b16 v[126:127], v10 offset:37728
    ds_read_b64_tr_b16 v[128:129], v8 offset:36992
    ds_read_b64_tr_b16 v[130:131], v8 offset:37760
    ds_read_b64_tr_b16 v[132:133], v10 offset:37024
    ds_read_b64_tr_b16 v[134:135], v10 offset:37792
    s_waitcnt lgkmcnt(12)
    v_mfma_f32_16x16x32_bf16 v[136:139], v[88:91], v[72:75], v[136:139]
    v_mfma_f32_16x16x32_bf16 v[140:143], v[92:95], v[72:75], v[140:143]
    v_mfma_f32_16x16x32_bf16 v[144:147], v[96:99], v[72:75], v[144:147]
    v_mfma_f32_16x16x32_bf16 v[148:151], v[100:103], v[72:75], v[148:151]
    v_mfma_f32_16x16x32_bf16 v[152:155], v[104:107], v[72:75], v[152:155]
    v_mfma_f32_16x16x32_bf16 v[156:159], v[108:111], v[72:75], v[156:159]
    ds_read_b64_tr_b16 v[88:89], v8 offset:43008
    ds_read_b64_tr_b16 v[90:91], v8 offset:43776
    ds_read_b64_tr_b16 v[92:93], v10 offset:43040
    ds_read_b64_tr_b16 v[94:95], v10 offset:43808
    ds_read_b64_tr_b16 v[96:97], v8 offset:43072
    ds_read_b64_tr_b16 v[98:99], v8 offset:43840
    ds_read_b64_tr_b16 v[100:101], v10 offset:43104
    ds_read_b64_tr_b16 v[102:103], v10 offset:43872
    ds_read_b64_tr_b16 v[104:105], v8 offset:43136
    ds_read_b64_tr_b16 v[106:107], v8 offset:43904
    ds_read_b64_tr_b16 v[108:109], v10 offset:43168
    ds_read_b64_tr_b16 v[110:111], v10 offset:43936
    s_waitcnt lgkmcnt(12)
    v_mfma_f32_16x16x32_bf16 v[136:139], v[112:115], v[76:79], v[136:139]
    v_mfma_f32_16x16x32_bf16 v[140:143], v[116:119], v[76:79], v[140:143]
    v_mfma_f32_16x16x32_bf16 v[144:147], v[120:123], v[76:79], v[144:147]
    v_mfma_f32_16x16x32_bf16 v[148:151], v[124:127], v[76:79], v[148:151]
    v_mfma_f32_16x16x32_bf16 v[152:155], v[128:131], v[76:79], v[152:155]
    v_mfma_f32_16x16x32_bf16 v[156:159], v[132:135], v[76:79], v[156:159]
    ds_read_b64_tr_b16 v[112:113], v8 offset:49152
    ds_read_b64_tr_b16 v[114:115], v8 offset:49920
    ds_read_b64_tr_b16 v[116:117], v10 offset:49184
    ds_read_b64_tr_b16 v[118:119], v10 offset:49952
    ds_read_b64_tr_b16 v[120:121], v8 offset:49216
    ds_read_b64_tr_b16 v[122:123], v8 offset:49984
    ds_read_b64_tr_b16 v[124:125], v10 offset:49248
    ds_read_b64_tr_b16 v[126:127], v10 offset:50016
    ds_read_b64_tr_b16 v[128:129], v8 offset:49280
    ds_read_b64_tr_b16 v[130:131], v8 offset:50048
    ds_read_b64_tr_b16 v[132:133], v10 offset:49312
    ds_read_b64_tr_b16 v[134:135], v10 offset:50080
    s_waitcnt lgkmcnt(12)
    v_mfma_f32_16x16x32_bf16 v[136:139], v[88:91], v[80:83], v[136:139]
    v_mfma_f32_16x16x32_bf16 v[140:143], v[92:95], v[80:83], v[140:143]
    v_mfma_f32_16x16x32_bf16 v[144:147], v[96:99], v[80:83], v[144:147]
    v_mfma_f32_16x16x32_bf16 v[148:151], v[100:103], v[80:83], v[148:151]
    v_mfma_f32_16x16x32_bf16 v[152:155], v[104:107], v[80:83], v[152:155]
    v_mfma_f32_16x16x32_bf16 v[156:159], v[108:111], v[80:83], v[156:159]
    s_waitcnt lgkmcnt(0)
    v_mfma_f32_16x16x32_bf16 v[136:139], v[112:115], v[84:87], v[136:139]
    v_mfma_f32_16x16x32_bf16 v[140:143], v[116:119], v[84:87], v[140:143]
    v_mfma_f32_16x16x32_bf16 v[144:147], v[120:123], v[84:87], v[144:147]
    v_mfma_f32_16x16x32_bf16 v[148:151], v[124:127], v[84:87], v[148:151]
    v_mfma_f32_16x16x32_bf16 v[152:155], v[128:131], v[84:87], v[152:155]
    v_mfma_f32_16x16x32_bf16 v[156:159], v[132:135], v[84:87], v[156:159]
    s_nop 7
    s_add_u32 s24, s32, 0x6c0000
    s_addc_u32 s25, s33, 0
    s_mov_b32 s26, 0x240000
    s_mov_b32 s27, 0x00020000
    s_mul_i32 s31, s28, 192
    v_lshl_add_u32 v3, v13, 3, v14
    v_add_u32 v3, s31, v3
    s_mov_b32 s36, 0x3eae1a93
    v_mul_f32 v136, s36, v136
    v_mul_f32 v137, s36, v137
    v_mul_f32 v138, s36, v138
    v_mul_f32 v139, s36, v139
    v_cvt_pk_bf16_f32 v136, v136, v137
    v_cvt_pk_bf16_f32 v137, v138, v139
    buffer_store_dwordx2 v[136:137], v3, s[24:27], 0 offen offset:0
    v_mul_f32 v140, s36, v140
    v_mul_f32 v141, s36, v141
    v_mul_f32 v142, s36, v142
    v_mul_f32 v143, s36, v143
    v_cvt_pk_bf16_f32 v140, v140, v141
    v_cvt_pk_bf16_f32 v141, v142, v143
    buffer_store_dwordx2 v[140:141], v3, s[24:27], 0 offen offset:32
    v_mul_f32 v144, s36, v144
    v_mul_f32 v145, s36, v145
    v_mul_f32 v146, s36, v146
    v_mul_f32 v147, s36, v147
    v_cvt_pk_bf16_f32 v144, v144, v145
    v_cvt_pk_bf16_f32 v145, v146, v147
    buffer_store_dwordx2 v[144:145], v3, s[24:27], 0 offen offset:64
    v_mul_f32 v148, s36, v148
    v_mul_f32 v149, s36, v149
    v_mul_f32 v150, s36, v150
    v_mul_f32 v151, s36, v151
    v_cvt_pk_bf16_f32 v148, v148, v149
    v_cvt_pk_bf16_f32 v149, v150, v151
    buffer_store_dwordx2 v[148:149], v3, s[24:27], 0 offen offset:96
    v_mul_f32 v152, s36, v152
    v_mul_f32 v153, s36, v153
    v_mul_f32 v154, s36, v154
    v_mul_f32 v155, s36, v155
    v_cvt_pk_bf16_f32 v152, v152, v153
    v_cvt_pk_bf16_f32 v153, v154, v155
    buffer_store_dwordx2 v[152:153], v3, s[24:27], 0 offen offset:128
    v_mul_f32 v156, s36, v156
    v_mul_f32 v157, s36, v157
    v_mul_f32 v158, s36, v158
    v_mul_f32 v159, s36, v159
    v_cvt_pk_bf16_f32 v156, v156, v157
    v_cvt_pk_bf16_f32 v157, v158, v159
    buffer_store_dwordx2 v[156:157], v3, s[24:27], 0 offen offset:160
    s_waitcnt vmcnt(0)
    s_endpgm
.Lkv_2:
    s_cmp_eq_u32 s28, 6
    s_cselect_b32 s16, s8, s10
    s_cselect_b32 s17, s9, s11
    s_mov_b32 s18, 20736
    s_mov_b32 s19, 0x00020000
    v_lshrrev_b32 v11, 4, v0
    v_and_b32 v15, 15, v0
    v_lshrrev_b32 v7, 3, v11
    v_and_b32 v7, 1, v7
    v_lshlrev_b32 v7, 3, v7
    v_xor_b32 v15, v15, v7
    v_cmp_gt_u32 vcc, 9, v15
    s_nop 1
    v_cndmask_b32 v15, 0, v15, vcc
    v_lshlrev_b32 v15, 2, v15
    v_mul_u32_u24 v11, 36, v11
    v_add_u32 v4, v11, v15
    s_lshl_b32 s34, s29, 8
    s_add_u32 m0, s34, 0
    s_mov_b32 s35, 0
    buffer_load_dword v4, s[16:19], s35 offen lds
    s_add_u32 m0, s34, 1024
    s_mov_b32 s35, 576
    buffer_load_dword v4, s[16:19], s35 offen lds
    s_add_u32 m0, s34, 2048
    s_mov_b32 s35, 1152
    buffer_load_dword v4, s[16:19], s35 offen lds
    s_add_u32 m0, s34, 3072
    s_mov_b32 s35, 1728
    buffer_load_dword v4, s[16:19], s35 offen lds
    s_add_u32 m0, s34, 4096
    s_mov_b32 s35, 2304
    buffer_load_dword v4, s[16:19], s35 offen lds
    s_add_u32 m0, s34, 5120
    s_mov_b32 s35, 2880
    buffer_load_dword v4, s[16:19], s35 offen lds
    s_add_u32 m0, s34, 6144
    s_mov_b32 s35, 3456
    buffer_load_dword v4, s[16:19], s35 offen lds
    s_add_u32 m0, s34, 7168
    s_mov_b32 s35, 4032
    buffer_load_dword v4, s[16:19], s35 offen lds
    s_add_u32 m0, s34, 8192
    s_mov_b32 s35, 4608
    buffer_load_dword v4, s[16:19], s35 offen lds
    s_add_u32 m0, s34, 9216
    s_mov_b32 s35, 5184
    buffer_load_dword v4, s[16:19], s35 offen lds
    s_add_u32 m0, s34, 10240
    s_mov_b32 s35, 5760
    buffer_load_dword v4, s[16:19], s35 offen lds
    s_add_u32 m0, s34, 11264
    s_mov_b32 s35, 6336
    buffer_load_dword v4, s[16:19], s35 offen lds
    s_add_u32 m0, s34, 12288
    s_mov_b32 s35, 6912
    buffer_load_dword v4, s[16:19], s35 offen lds
    s_add_u32 m0, s34, 13312
    s_mov_b32 s35, 7488
    buffer_load_dword v4, s[16:19], s35 offen lds
    s_add_u32 m0, s34, 14336
    s_mov_b32 s35, 8064
    buffer_load_dword v4, s[16:19], s35 offen lds
    s_add_u32 m0, s34, 15360
    s_mov_b32 s35, 8640
    buffer_load_dword v4, s[16:19], s35 offen lds
    s_add_u32 m0, s34, 16384
    s_mov_b32 s35, 9216
    buffer_load_dword v4, s[16:19], s35 offen lds
    s_add_u32 m0, s34, 17408
    s_mov_b32 s35, 9792
    buffer_load_dword v4, s[16:19], s35 offen lds
    s_add_u32 m0, s34, 18432
    s_mov_b32 s35, 10368
    buffer_load_dword v4, s[16:19], s35 offen lds
    s_add_u32 m0, s34, 19456
    s_mov_b32 s35, 10944
    buffer_load_dword v4, s[16:19], s35 offen lds
    s_add_u32 m0, s34, 20480
    s_mov_b32 s35, 11520
    buffer_load_dword v4, s[16:19], s35 offen lds
    s_add_u32 m0, s34, 21504
    s_mov_b32 s35, 12096
    buffer_load_dword v4, s[16:19], s35 offen lds
    s_add_u32 m0, s34, 22528
    s_mov_b32 s35, 12672
    buffer_load_dword v4, s[16:19], s35 offen lds
    s_add_u32 m0, s34, 23552
    s_mov_b32 s35, 13248
    buffer_load_dword v4, s[16:19], s35 offen lds
    s_add_u32 m0, s34, 24576
    s_mov_b32 s35, 13824
    buffer_load_dword v4, s[16:19], s35 offen lds
    s_add_u32 m0, s34, 25600
    s_mov_b32 s35, 14400
    buffer_load_dword v4, s[16:19], s35 offen lds
    s_add_u32 m0, s34, 26624
    s_mov_b32 s35, 14976
    buffer_load_dword v4, s[16:19], s35 offen lds
    s_add_u32 m0, s34, 27648
    s_mov_b32 s35, 15552
    buffer_load_dword v4, s[16:19], s35 offen lds
    s_add_u32 m0, s34, 28672
    s_mov_b32 s35, 16128
    buffer_load_dword v4, s[16:19], s35 offen lds
    s_add_u32 m0, s34, 29696
    s_mov_b32 s35, 16704
    buffer_load_dword v4, s[16:19], s35 offen lds
    s_add_u32 m0, s34, 30720
    s_mov_b32 s35, 17280
    buffer_load_dword v4, s[16:19], s35 offen lds
    s_add_u32 m0, s34, 31744
    s_mov_b32 s35, 17856
    buffer_load_dword v4, s[16:19], s35 offen lds
    s_add_u32 m0, s34, 32768
    s_mov_b32 s35, 18432
    buffer_load_dword v4, s[16:19], s35 offen lds
    s_add_u32 m0, s34, 33792
    s_mov_b32 s35, 19008
    buffer_load_dword v4, s[16:19], s35 offen lds
    s_add_u32 m0, s34, 34816
    s_mov_b32 s35, 19584
    buffer_load_dword v4, s[16:19], s35 offen lds
    s_add_u32 m0, s34, 35840
    s_mov_b32 s35, 20160
    buffer_load_dword v4, s[16:19], s35 offen lds
    v_lshrrev_b32 v7, 2, v12
    v_and_b32 v8, 3, v12
    v_lshl_add_u32 v7, v13, 3, v7
    v_lshlrev_b32 v7, 6, v7
    v_lshl_add_u32 v7, v8, 3, v7
    v_and_b32 v8, 1, v13
    v_lshlrev_b32 v8, 5, v8
    v_sub_u32 v9, v7, v8
    v_add_u32 v7, v7, v8
    v_mov_b32 v136, 0
    v_mov_b32 v137, 0
    v_mov_b32 v138, 0
    v_mov_b32 v139, 0
    v_mov_b32 v140, 0
    v_mov_b32 v141, 0
    v_mov_b32 v142, 0
    v_mov_b32 v143, 0
    s_waitcnt vmcnt(36)
    s_mov_b32 s36, 0x3f803f80
    v_mov_b32 v160, 0
    v_mov_b32 v164, 0
    v_mov_b32 v161, 0
    v_mov_b32 v165, 0
    v_mov_b32 v162, 0
    v_mov_b32 v166, 0
    v_mov_b32 v163, 0
    v_mov_b32 v167, 0
    v_dot2_f32_bf16 v160, v16, s36, v160
    v_dot2_f32_bf16 v164, v16, v16, v164
    v_dot2_f32_bf16 v161, v17, s36, v161
    v_dot2_f32_bf16 v165, v17, v17, v165
    v_dot2_f32_bf16 v162, v18, s36, v162
    v_dot2_f32_bf16 v166, v18, v18, v166
    v_dot2_f32_bf16 v163, v19, s36, v163
    v_dot2_f32_bf16 v167, v19, v19, v167
    v_dot2_f32_bf16 v160, v20, s36, v160
    v_dot2_f32_bf16 v164, v20, v20, v164
    v_dot2_f32_bf16 v161, v21, s36, v161
    v_dot2_f32_bf16 v165, v21, v21, v165
    v_dot2_f32_bf16 v162, v22, s36, v162
    v_dot2_f32_bf16 v166, v22, v22, v166
    v_dot2_f32_bf16 v163, v23, s36, v163
    v_dot2_f32_bf16 v167, v23, v23, v167
    v_dot2_f32_bf16 v160, v24, s36, v160
    v_dot2_f32_bf16 v164, v24, v24, v164
    v_dot2_f32_bf16 v161, v25, s36, v161
    v_dot2_f32_bf16 v165, v25, v25, v165
    v_dot2_f32_bf16 v162, v26, s36, v162
    v_dot2_f32_bf16 v166, v26, v26, v166
    v_dot2_f32_bf16 v163, v27, s36, v163
    v_dot2_f32_bf16 v167, v27, v27, v167
    v_dot2_f32_bf16 v160, v28, s36, v160
    v_dot2_f32_bf16 v164, v28, v28, v164
    v_dot2_f32_bf16 v161, v29, s36, v161
    v_dot2_f32_bf16 v165, v29, v29, v165
    v_dot2_f32_bf16 v162, v30, s36, v162
    v_dot2_f32_bf16 v166, v30, v30, v166
    v_dot2_f32_bf16 v163, v31, s36, v163
    v_dot2_f32_bf16 v167, v31, v31, v167
    v_dot2_f32_bf16 v160, v32, s36, v160
    v_dot2_f32_bf16 v164, v32, v32, v164
    v_dot2_f32_bf16 v161, v33, s36, v161
    v_dot2_f32_bf16 v165, v33, v33, v165
    v_dot2_f32_bf16 v162, v34, s36, v162
    v_dot2_f32_bf16 v166, v34, v34, v166
    v_dot2_f32_bf16 v163, v35, s36, v163
    v_dot2_f32_bf16 v167, v35, v35, v167
    v_dot2_f32_bf16 v160, v36, s36, v160
    v_dot2_f32_bf16 v164, v36, v36, v164
    v_dot2_f32_bf16 v161, v37, s36, v161
    v_dot2_f32_bf16 v165, v37, v37, v165
    v_dot2_f32_bf16 v162, v38, s36, v162
    v_dot2_f32_bf16 v166, v38, v38, v166
    v_dot2_f32_bf16 v163, v39, s36, v163
    v_dot2_f32_bf16 v167, v39, v39, v167
    v_dot2_f32_bf16 v160, v40, s36, v160
    v_dot2_f32_bf16 v164, v40, v40, v164
    v_dot2_f32_bf16 v161, v41, s36, v161
    v_dot2_f32_bf16 v165, v41, v41, v165
    v_dot2_f32_bf16 v162, v42, s36, v162
    v_dot2_f32_bf16 v166, v42, v42, v166
    v_dot2_f32_bf16 v163, v43, s36, v163
    v_dot2_f32_bf16 v167, v43, v43, v167
    v_dot2_f32_bf16 v160, v44, s36, v160
    v_dot2_f32_bf16 v164, v44, v44, v164
    v_dot2_f32_bf16 v161, v45, s36, v161
    v_dot2_f32_bf16 v165, v45, v45, v165
    v_dot2_f32_bf16 v162, v46, s36, v162
    v_dot2_f32_bf16 v166, v46, v46, v166
    v_dot2_f32_bf16 v163, v47, s36, v163
    v_dot2_f32_bf16 v167, v47, v47, v167
    v_dot2_f32_bf16 v160, v48, s36, v160
    v_dot2_f32_bf16 v164, v48, v48, v164
    v_dot2_f32_bf16 v161, v49, s36, v161
    v_dot2_f32_bf16 v165, v49, v49, v165
    v_dot2_f32_bf16 v162, v50, s36, v162
    v_dot2_f32_bf16 v166, v50, v50, v166
    v_dot2_f32_bf16 v163, v51, s36, v163
    v_dot2_f32_bf16 v167, v51, v51, v167
    v_dot2_f32_bf16 v160, v52, s36, v160
    v_dot2_f32_bf16 v164, v52, v52, v164
    v_dot2_f32_bf16 v161, v53, s36, v161
    v_dot2_f32_bf16 v165, v53, v53, v165
    v_dot2_f32_bf16 v162, v54, s36, v162
    v_dot2_f32_bf16 v166, v54, v54, v166
    v_dot2_f32_bf16 v163, v55, s36, v163
    v_dot2_f32_bf16 v167, v55, v55, v167
    v_dot2_f32_bf16 v160, v56, s36, v160
    v_dot2_f32_bf16 v164, v56, v56, v164
    v_dot2_f32_bf16 v161, v57, s36, v161
    v_dot2_f32_bf16 v165, v57, v57, v165
    v_dot2_f32_bf16 v162, v58, s36, v162
    v_dot2_f32_bf16 v166, v58, v58, v166
    v_dot2_f32_bf16 v163, v59, s36, v163
    v_dot2_f32_bf16 v167, v59, v59, v167
    v_dot2_f32_bf16 v160, v60, s36, v160
    v_dot2_f32_bf16 v164, v60, v60, v164
    v_dot2_f32_bf16 v161, v61, s36, v161
    v_dot2_f32_bf16 v165, v61, v61, v165
    v_dot2_f32_bf16 v162, v62, s36, v162
    v_dot2_f32_bf16 v166, v62, v62, v166
    v_dot2_f32_bf16 v163, v63, s36, v163
    v_dot2_f32_bf16 v167, v63, v63, v167
    v_dot2_f32_bf16 v160, v64, s36, v160
    v_dot2_f32_bf16 v164, v64, v64, v164
    v_dot2_f32_bf16 v161, v65, s36, v161
    v_dot2_f32_bf16 v165, v65, v65, v165
    v_dot2_f32_bf16 v162, v66, s36, v162
    v_dot2_f32_bf16 v166, v66, v66, v166
    v_dot2_f32_bf16 v163, v67, s36, v163
    v_dot2_f32_bf16 v167, v67, v67, v167
    v_dot2_f32_bf16 v160, v68, s36, v160
    v_dot2_f32_bf16 v164, v68, v68, v164
    v_dot2_f32_bf16 v161, v69, s36, v161
    v_dot2_f32_bf16 v165, v69, v69, v165
    v_dot2_f32_bf16 v162, v70, s36, v162
    v_dot2_f32_bf16 v166, v70, v70, v166
    v_dot2_f32_bf16 v163, v71, s36, v163
    v_dot2_f32_bf16 v167, v71, v71, v167
    v_dot2_f32_bf16 v160, v72, s36, v160
    v_dot2_f32_bf16 v164, v72, v72, v164
    v_dot2_f32_bf16 v161, v73, s36, v161
    v_dot2_f32_bf16 v165, v73, v73, v165
    v_dot2_f32_bf16 v162, v74, s36, v162
    v_dot2_f32_bf16 v166, v74, v74, v166
    v_dot2_f32_bf16 v163, v75, s36, v163
    v_dot2_f32_bf16 v167, v75, v75, v167
    v_dot2_f32_bf16 v160, v76, s36, v160
    v_dot2_f32_bf16 v164, v76, v76, v164
    v_dot2_f32_bf16 v161, v77, s36, v161
    v_dot2_f32_bf16 v165, v77, v77, v165
    v_dot2_f32_bf16 v162, v78, s36, v162
    v_dot2_f32_bf16 v166, v78, v78, v166
    v_dot2_f32_bf16 v163, v79, s36, v163
    v_dot2_f32_bf16 v167, v79, v79, v167
    v_dot2_f32_bf16 v160, v80, s36, v160
    v_dot2_f32_bf16 v164, v80, v80, v164
    v_dot2_f32_bf16 v161, v81, s36, v161
    v_dot2_f32_bf16 v165, v81, v81, v165
    v_dot2_f32_bf16 v162, v82, s36, v162
    v_dot2_f32_bf16 v166, v82, v82, v166
    v_dot2_f32_bf16 v163, v83, s36, v163
    v_dot2_f32_bf16 v167, v83, v83, v167
    v_dot2_f32_bf16 v160, v84, s36, v160
    v_dot2_f32_bf16 v164, v84, v84, v164
    v_dot2_f32_bf16 v161, v85, s36, v161
    v_dot2_f32_bf16 v165, v85, v85, v165
    v_dot2_f32_bf16 v162, v86, s36, v162
    v_dot2_f32_bf16 v166, v86, v86, v166
    v_dot2_f32_bf16 v163, v87, s36, v163
    v_dot2_f32_bf16 v167, v87, v87, v167
    s_nop 3
    v_add_f32 v160, v160, v161
    v_add_f32 v162, v162, v163
    v_add_f32 v164, v164, v165
    v_add_f32 v166, v166, v167
    v_add_f32 v160, v160, v162
    v_add_f32 v164, v164, v166
    v_mov_b32 v161, v160
    v_mov_b32 v165, v164
    s_nop 1
    v_permlane32_swap_b32 v160, v161
    v_permlane32_swap_b32 v164, v165
    v_add_f32 v160, v160, v161
    v_add_f32 v164, v164, v165
    v_mov_b32 v161, v160
    v_mov_b32 v165, v164
    s_nop 1
    v_permlane16_swap_b32 v160, v161
    v_permlane16_swap_b32 v164, v165
    v_add_f32 v160, v160, v161
    v_add_f32 v164, v164, v165
    s_mov_b32 s36, 0x3ae38e39
    v_mul_f32 v160, s36, v160
    v_mul_f32 v164, s36, v164
    v_fma_f32 v164, -v160, v160, v164
    v_max_f32 v164, 0, v164
    v_cvt_pk_bf16_f32 v161, v160, v164
    v_lshlrev_b32 v160, 16, v161
    v_and_b32 v164, 0xffff0000, v161
    v_add_f32 v164, 0x3727c5ac, v164
    v_cvt_pk_bf16_f32 v164, v164, v164
    v_lshlrev_b32 v164, 16, v164
    v_sqrt_f32 v164, v164
    s_nop 0
    v_cvt_pk_bf16_f32 v164, v164, v164
    v_lshlrev_b32 v164, 16, v164
    v_rcp_f32 v164, v164
    s_nop 0
    v_mul_f32 v160, v160, v164
    s_mov_b32 s36, 0xffff0000
    v_lshlrev_b32 v168, 16, v16
    v_and_b32 v169, s36, v16
    v_fma_f32 v168, v168, v164, -v160
    v_fma_f32 v169, v169, v164, -v160
    v_cvt_pk_bf16_f32 v16, v168, v169
    v_lshlrev_b32 v170, 16, v17
    v_and_b32 v171, s36, v17
    v_fma_f32 v170, v170, v164, -v160
    v_fma_f32 v171, v171, v164, -v160
    v_cvt_pk_bf16_f32 v17, v170, v171
    v_lshlrev_b32 v168, 16, v18
    v_and_b32 v169, s36, v18
    v_fma_f32 v168, v168, v164, -v160
    v_fma_f32 v169, v169, v164, -v160
    v_cvt_pk_bf16_f32 v18, v168, v169
    v_lshlrev_b32 v170, 16, v19
    v_and_b32 v171, s36, v19
    v_fma_f32 v170, v170, v164, -v160
    v_fma_f32 v171, v171, v164, -v160
    v_cvt_pk_bf16_f32 v19, v170, v171
    v_lshlrev_b32 v168, 16, v20
    v_and_b32 v169, s36, v20
    v_fma_f32 v168, v168, v164, -v160
    v_fma_f32 v169, v169, v164, -v160
    v_cvt_pk_bf16_f32 v20, v168, v169
    v_lshlrev_b32 v170, 16, v21
    v_and_b32 v171, s36, v21
    v_fma_f32 v170, v170, v164, -v160
    v_fma_f32 v171, v171, v164, -v160
    v_cvt_pk_bf16_f32 v21, v170, v171
    v_lshlrev_b32 v168, 16, v22
    v_and_b32 v169, s36, v22
    v_fma_f32 v168, v168, v164, -v160
    v_fma_f32 v169, v169, v164, -v160
    v_cvt_pk_bf16_f32 v22, v168, v169
    v_lshlrev_b32 v170, 16, v23
    v_and_b32 v171, s36, v23
    v_fma_f32 v170, v170, v164, -v160
    v_fma_f32 v171, v171, v164, -v160
    v_cvt_pk_bf16_f32 v23, v170, v171
    v_lshlrev_b32 v168, 16, v24
    v_and_b32 v169, s36, v24
    v_fma_f32 v168, v168, v164, -v160
    v_fma_f32 v169, v169, v164, -v160
    v_cvt_pk_bf16_f32 v24, v168, v169
    v_lshlrev_b32 v170, 16, v25
    v_and_b32 v171, s36, v25
    v_fma_f32 v170, v170, v164, -v160
    v_fma_f32 v171, v171, v164, -v160
    v_cvt_pk_bf16_f32 v25, v170, v171
    v_lshlrev_b32 v168, 16, v26
    v_and_b32 v169, s36, v26
    v_fma_f32 v168, v168, v164, -v160
    v_fma_f32 v169, v169, v164, -v160
    v_cvt_pk_bf16_f32 v26, v168, v169
    v_lshlrev_b32 v170, 16, v27
    v_and_b32 v171, s36, v27
    v_fma_f32 v170, v170, v164, -v160
    v_fma_f32 v171, v171, v164, -v160
    v_cvt_pk_bf16_f32 v27, v170, v171
    v_lshlrev_b32 v168, 16, v28
    v_and_b32 v169, s36, v28
    v_fma_f32 v168, v168, v164, -v160
    v_fma_f32 v169, v169, v164, -v160
    v_cvt_pk_bf16_f32 v28, v168, v169
    v_lshlrev_b32 v170, 16, v29
    v_and_b32 v171, s36, v29
    v_fma_f32 v170, v170, v164, -v160
    v_fma_f32 v171, v171, v164, -v160
    v_cvt_pk_bf16_f32 v29, v170, v171
    v_lshlrev_b32 v168, 16, v30
    v_and_b32 v169, s36, v30
    v_fma_f32 v168, v168, v164, -v160
    v_fma_f32 v169, v169, v164, -v160
    v_cvt_pk_bf16_f32 v30, v168, v169
    v_lshlrev_b32 v170, 16, v31
    v_and_b32 v171, s36, v31
    v_fma_f32 v170, v170, v164, -v160
    v_fma_f32 v171, v171, v164, -v160
    v_cvt_pk_bf16_f32 v31, v170, v171
    v_lshlrev_b32 v168, 16, v32
    v_and_b32 v169, s36, v32
    v_fma_f32 v168, v168, v164, -v160
    v_fma_f32 v169, v169, v164, -v160
    v_cvt_pk_bf16_f32 v32, v168, v169
    v_lshlrev_b32 v170, 16, v33
    v_and_b32 v171, s36, v33
    v_fma_f32 v170, v170, v164, -v160
    v_fma_f32 v171, v171, v164, -v160
    v_cvt_pk_bf16_f32 v33, v170, v171
    v_lshlrev_b32 v168, 16, v34
    v_and_b32 v169, s36, v34
    v_fma_f32 v168, v168, v164, -v160
    v_fma_f32 v169, v169, v164, -v160
    v_cvt_pk_bf16_f32 v34, v168, v169
    v_lshlrev_b32 v170, 16, v35
    v_and_b32 v171, s36, v35
    v_fma_f32 v170, v170, v164, -v160
    v_fma_f32 v171, v171, v164, -v160
    v_cvt_pk_bf16_f32 v35, v170, v171
    v_lshlrev_b32 v168, 16, v36
    v_and_b32 v169, s36, v36
    v_fma_f32 v168, v168, v164, -v160
    v_fma_f32 v169, v169, v164, -v160
    v_cvt_pk_bf16_f32 v36, v168, v169
    v_lshlrev_b32 v170, 16, v37
    v_and_b32 v171, s36, v37
    v_fma_f32 v170, v170, v164, -v160
    v_fma_f32 v171, v171, v164, -v160
    v_cvt_pk_bf16_f32 v37, v170, v171
    v_lshlrev_b32 v168, 16, v38
    v_and_b32 v169, s36, v38
    v_fma_f32 v168, v168, v164, -v160
    v_fma_f32 v169, v169, v164, -v160
    v_cvt_pk_bf16_f32 v38, v168, v169
    v_lshlrev_b32 v170, 16, v39
    v_and_b32 v171, s36, v39
    v_fma_f32 v170, v170, v164, -v160
    v_fma_f32 v171, v171, v164, -v160
    v_cvt_pk_bf16_f32 v39, v170, v171
    v_lshlrev_b32 v168, 16, v40
    v_and_b32 v169, s36, v40
    v_fma_f32 v168, v168, v164, -v160
    v_fma_f32 v169, v169, v164, -v160
    v_cvt_pk_bf16_f32 v40, v168, v169
    v_lshlrev_b32 v170, 16, v41
    v_and_b32 v171, s36, v41
    v_fma_f32 v170, v170, v164, -v160
    v_fma_f32 v171, v171, v164, -v160
    v_cvt_pk_bf16_f32 v41, v170, v171
    v_lshlrev_b32 v168, 16, v42
    v_and_b32 v169, s36, v42
    v_fma_f32 v168, v168, v164, -v160
    v_fma_f32 v169, v169, v164, -v160
    v_cvt_pk_bf16_f32 v42, v168, v169
    v_lshlrev_b32 v170, 16, v43
    v_and_b32 v171, s36, v43
    v_fma_f32 v170, v170, v164, -v160
    v_fma_f32 v171, v171, v164, -v160
    v_cvt_pk_bf16_f32 v43, v170, v171
    v_lshlrev_b32 v168, 16, v44
    v_and_b32 v169, s36, v44
    v_fma_f32 v168, v168, v164, -v160
    v_fma_f32 v169, v169, v164, -v160
    v_cvt_pk_bf16_f32 v44, v168, v169
    v_lshlrev_b32 v170, 16, v45
    v_and_b32 v171, s36, v45
    v_fma_f32 v170, v170, v164, -v160
    v_fma_f32 v171, v171, v164, -v160
    v_cvt_pk_bf16_f32 v45, v170, v171
    v_lshlrev_b32 v168, 16, v46
    v_and_b32 v169, s36, v46
    v_fma_f32 v168, v168, v164, -v160
    v_fma_f32 v169, v169, v164, -v160
    v_cvt_pk_bf16_f32 v46, v168, v169
    v_lshlrev_b32 v170, 16, v47
    v_and_b32 v171, s36, v47
    v_fma_f32 v170, v170, v164, -v160
    v_fma_f32 v171, v171, v164, -v160
    v_cvt_pk_bf16_f32 v47, v170, v171
    v_lshlrev_b32 v168, 16, v48
    v_and_b32 v169, s36, v48
    v_fma_f32 v168, v168, v164, -v160
    v_fma_f32 v169, v169, v164, -v160
    v_cvt_pk_bf16_f32 v48, v168, v169
    v_lshlrev_b32 v170, 16, v49
    v_and_b32 v171, s36, v49
    v_fma_f32 v170, v170, v164, -v160
    v_fma_f32 v171, v171, v164, -v160
    v_cvt_pk_bf16_f32 v49, v170, v171
    v_lshlrev_b32 v168, 16, v50
    v_and_b32 v169, s36, v50
    v_fma_f32 v168, v168, v164, -v160
    v_fma_f32 v169, v169, v164, -v160
    v_cvt_pk_bf16_f32 v50, v168, v169
    v_lshlrev_b32 v170, 16, v51
    v_and_b32 v171, s36, v51
    v_fma_f32 v170, v170, v164, -v160
    v_fma_f32 v171, v171, v164, -v160
    v_cvt_pk_bf16_f32 v51, v170, v171
    v_lshlrev_b32 v168, 16, v52
    v_and_b32 v169, s36, v52
    v_fma_f32 v168, v168, v164, -v160
    v_fma_f32 v169, v169, v164, -v160
    v_cvt_pk_bf16_f32 v52, v168, v169
    v_lshlrev_b32 v170, 16, v53
    v_and_b32 v171, s36, v53
    v_fma_f32 v170, v170, v164, -v160
    v_fma_f32 v171, v171, v164, -v160
    v_cvt_pk_bf16_f32 v53, v170, v171
    v_lshlrev_b32 v168, 16, v54
    v_and_b32 v169, s36, v54
    v_fma_f32 v168, v168, v164, -v160
    v_fma_f32 v169, v169, v164, -v160
    v_cvt_pk_bf16_f32 v54, v168, v169
    v_lshlrev_b32 v170, 16, v55
    v_and_b32 v171, s36, v55
    v_fma_f32 v170, v170, v164, -v160
    v_fma_f32 v171, v171, v164, -v160
    v_cvt_pk_bf16_f32 v55, v170, v171
    v_lshlrev_b32 v168, 16, v56
    v_and_b32 v169, s36, v56
    v_fma_f32 v168, v168, v164, -v160
    v_fma_f32 v169, v169, v164, -v160
    v_cvt_pk_bf16_f32 v56, v168, v169
    v_lshlrev_b32 v170, 16, v57
    v_and_b32 v171, s36, v57
    v_fma_f32 v170, v170, v164, -v160
    v_fma_f32 v171, v171, v164, -v160
    v_cvt_pk_bf16_f32 v57, v170, v171
    v_lshlrev_b32 v168, 16, v58
    v_and_b32 v169, s36, v58
    v_fma_f32 v168, v168, v164, -v160
    v_fma_f32 v169, v169, v164, -v160
    v_cvt_pk_bf16_f32 v58, v168, v169
    v_lshlrev_b32 v170, 16, v59
    v_and_b32 v171, s36, v59
    v_fma_f32 v170, v170, v164, -v160
    v_fma_f32 v171, v171, v164, -v160
    v_cvt_pk_bf16_f32 v59, v170, v171
    v_lshlrev_b32 v168, 16, v60
    v_and_b32 v169, s36, v60
    v_fma_f32 v168, v168, v164, -v160
    v_fma_f32 v169, v169, v164, -v160
    v_cvt_pk_bf16_f32 v60, v168, v169
    v_lshlrev_b32 v170, 16, v61
    v_and_b32 v171, s36, v61
    v_fma_f32 v170, v170, v164, -v160
    v_fma_f32 v171, v171, v164, -v160
    v_cvt_pk_bf16_f32 v61, v170, v171
    v_lshlrev_b32 v168, 16, v62
    v_and_b32 v169, s36, v62
    v_fma_f32 v168, v168, v164, -v160
    v_fma_f32 v169, v169, v164, -v160
    v_cvt_pk_bf16_f32 v62, v168, v169
    v_lshlrev_b32 v170, 16, v63
    v_and_b32 v171, s36, v63
    v_fma_f32 v170, v170, v164, -v160
    v_fma_f32 v171, v171, v164, -v160
    v_cvt_pk_bf16_f32 v63, v170, v171
    v_lshlrev_b32 v168, 16, v64
    v_and_b32 v169, s36, v64
    v_fma_f32 v168, v168, v164, -v160
    v_fma_f32 v169, v169, v164, -v160
    v_cvt_pk_bf16_f32 v64, v168, v169
    v_lshlrev_b32 v170, 16, v65
    v_and_b32 v171, s36, v65
    v_fma_f32 v170, v170, v164, -v160
    v_fma_f32 v171, v171, v164, -v160
    v_cvt_pk_bf16_f32 v65, v170, v171
    v_lshlrev_b32 v168, 16, v66
    v_and_b32 v169, s36, v66
    v_fma_f32 v168, v168, v164, -v160
    v_fma_f32 v169, v169, v164, -v160
    v_cvt_pk_bf16_f32 v66, v168, v169
    v_lshlrev_b32 v170, 16, v67
    v_and_b32 v171, s36, v67
    v_fma_f32 v170, v170, v164, -v160
    v_fma_f32 v171, v171, v164, -v160
    v_cvt_pk_bf16_f32 v67, v170, v171
    v_lshlrev_b32 v168, 16, v68
    v_and_b32 v169, s36, v68
    v_fma_f32 v168, v168, v164, -v160
    v_fma_f32 v169, v169, v164, -v160
    v_cvt_pk_bf16_f32 v68, v168, v169
    v_lshlrev_b32 v170, 16, v69
    v_and_b32 v171, s36, v69
    v_fma_f32 v170, v170, v164, -v160
    v_fma_f32 v171, v171, v164, -v160
    v_cvt_pk_bf16_f32 v69, v170, v171
    v_lshlrev_b32 v168, 16, v70
    v_and_b32 v169, s36, v70
    v_fma_f32 v168, v168, v164, -v160
    v_fma_f32 v169, v169, v164, -v160
    v_cvt_pk_bf16_f32 v70, v168, v169
    v_lshlrev_b32 v170, 16, v71
    v_and_b32 v171, s36, v71
    v_fma_f32 v170, v170, v164, -v160
    v_fma_f32 v171, v171, v164, -v160
    v_cvt_pk_bf16_f32 v71, v170, v171
    v_lshlrev_b32 v168, 16, v72
    v_and_b32 v169, s36, v72
    v_fma_f32 v168, v168, v164, -v160
    v_fma_f32 v169, v169, v164, -v160
    v_cvt_pk_bf16_f32 v72, v168, v169
    v_lshlrev_b32 v170, 16, v73
    v_and_b32 v171, s36, v73
    v_fma_f32 v170, v170, v164, -v160
    v_fma_f32 v171, v171, v164, -v160
    v_cvt_pk_bf16_f32 v73, v170, v171
    v_lshlrev_b32 v168, 16, v74
    v_and_b32 v169, s36, v74
    v_fma_f32 v168, v168, v164, -v160
    v_fma_f32 v169, v169, v164, -v160
    v_cvt_pk_bf16_f32 v74, v168, v169
    v_lshlrev_b32 v170, 16, v75
    v_and_b32 v171, s36, v75
    v_fma_f32 v170, v170, v164, -v160
    v_fma_f32 v171, v171, v164, -v160
    v_cvt_pk_bf16_f32 v75, v170, v171
    v_lshlrev_b32 v168, 16, v76
    v_and_b32 v169, s36, v76
    v_fma_f32 v168, v168, v164, -v160
    v_fma_f32 v169, v169, v164, -v160
    v_cvt_pk_bf16_f32 v76, v168, v169
    v_lshlrev_b32 v170, 16, v77
    v_and_b32 v171, s36, v77
    v_fma_f32 v170, v170, v164, -v160
    v_fma_f32 v171, v171, v164, -v160
    v_cvt_pk_bf16_f32 v77, v170, v171
    v_lshlrev_b32 v168, 16, v78
    v_and_b32 v169, s36, v78
    v_fma_f32 v168, v168, v164, -v160
    v_fma_f32 v169, v169, v164, -v160
    v_cvt_pk_bf16_f32 v78, v168, v169
    v_lshlrev_b32 v170, 16, v79
    v_and_b32 v171, s36, v79
    v_fma_f32 v170, v170, v164, -v160
    v_fma_f32 v171, v171, v164, -v160
    v_cvt_pk_bf16_f32 v79, v170, v171
    v_lshlrev_b32 v168, 16, v80
    v_and_b32 v169, s36, v80
    v_fma_f32 v168, v168, v164, -v160
    v_fma_f32 v169, v169, v164, -v160
    v_cvt_pk_bf16_f32 v80, v168, v169
    v_lshlrev_b32 v170, 16, v81
    v_and_b32 v171, s36, v81
    v_fma_f32 v170, v170, v164, -v160
    v_fma_f32 v171, v171, v164, -v160
    v_cvt_pk_bf16_f32 v81, v170, v171
    v_lshlrev_b32 v168, 16, v82
    v_and_b32 v169, s36, v82
    v_fma_f32 v168, v168, v164, -v160
    v_fma_f32 v169, v169, v164, -v160
    v_cvt_pk_bf16_f32 v82, v168, v169
    v_lshlrev_b32 v170, 16, v83
    v_and_b32 v171, s36, v83
    v_fma_f32 v170, v170, v164, -v160
    v_fma_f32 v171, v171, v164, -v160
    v_cvt_pk_bf16_f32 v83, v170, v171
    v_lshlrev_b32 v168, 16, v84
    v_and_b32 v169, s36, v84
    v_fma_f32 v168, v168, v164, -v160
    v_fma_f32 v169, v169, v164, -v160
    v_cvt_pk_bf16_f32 v84, v168, v169
    v_lshlrev_b32 v170, 16, v85
    v_and_b32 v171, s36, v85
    v_fma_f32 v170, v170, v164, -v160
    v_fma_f32 v171, v171, v164, -v160
    v_cvt_pk_bf16_f32 v85, v170, v171
    v_lshlrev_b32 v168, 16, v86
    v_and_b32 v169, s36, v86
    v_fma_f32 v168, v168, v164, -v160
    v_fma_f32 v169, v169, v164, -v160
    v_cvt_pk_bf16_f32 v86, v168, v169
    v_lshlrev_b32 v170, 16, v87
    v_and_b32 v171, s36, v87
    v_fma_f32 v170, v170, v164, -v160
    v_fma_f32 v171, v171, v164, -v160
    v_cvt_pk_bf16_f32 v87, v170, v171
    s_waitcnt vmcnt(0)
    s_barrier
    ds_read_b64_tr_b16 v[88:89], v7 offset:0
    ds_read_b64_tr_b16 v[90:91], v7 offset:256
    ds_read_b64_tr_b16 v[92:93], v9 offset:32
    ds_read_b64_tr_b16 v[94:95], v9 offset:288
    ds_read_b64_tr_b16 v[96:97], v7 offset:2048
    ds_read_b64_tr_b16 v[98:99], v7 offset:2304
    ds_read_b64_tr_b16 v[100:101], v9 offset:2080
    ds_read_b64_tr_b16 v[102:103], v9 offset:2336
    ds_read_b64_tr_b16 v[104:105], v7 offset:4096
    ds_read_b64_tr_b16 v[106:107], v7 offset:4352
    ds_read_b64_tr_b16 v[108:109], v9 offset:4128
    ds_read_b64_tr_b16 v[110:111], v9 offset:4384
    s_waitcnt lgkmcnt(0)
    v_mfma_f32_16x16x32_bf16 v[136:139], v[88:91], v[16:19], v[136:139]
    v_mfma_f32_16x16x32_bf16 v[140:143], v[92:95], v[16:19], v[140:143]
    v_mfma_f32_16x16x32_bf16 v[136:139], v[96:99], v[20:23], v[136:139]
    v_mfma_f32_16x16x32_bf16 v[140:143], v[100:103], v[20:23], v[140:143]
    v_mfma_f32_16x16x32_bf16 v[136:139], v[104:107], v[24:27], v[136:139]
    v_mfma_f32_16x16x32_bf16 v[140:143], v[108:111], v[24:27], v[140:143]
    ds_read_b64_tr_b16 v[112:113], v7 offset:6144
    ds_read_b64_tr_b16 v[114:115], v7 offset:6400
    ds_read_b64_tr_b16 v[116:117], v9 offset:6176
    ds_read_b64_tr_b16 v[118:119], v9 offset:6432
    ds_read_b64_tr_b16 v[120:121], v7 offset:8192
    ds_read_b64_tr_b16 v[122:123], v7 offset:8448
    ds_read_b64_tr_b16 v[124:125], v9 offset:8224
    ds_read_b64_tr_b16 v[126:127], v9 offset:8480
    ds_read_b64_tr_b16 v[128:129], v7 offset:10240
    ds_read_b64_tr_b16 v[130:131], v7 offset:10496
    ds_read_b64_tr_b16 v[132:133], v9 offset:10272
    ds_read_b64_tr_b16 v[134:135], v9 offset:10528
    s_waitcnt lgkmcnt(0)
    v_mfma_f32_16x16x32_bf16 v[136:139], v[112:115], v[28:31], v[136:139]
    v_mfma_f32_16x16x32_bf16 v[140:143], v[116:119], v[28:31], v[140:143]
    v_mfma_f32_16x16x32_bf16 v[136:139], v[120:123], v[32:35], v[136:139]
    v_mfma_f32_16x16x32_bf16 v[140:143], v[124:127], v[32:35], v[140:143]
    v_mfma_f32_16x16x32_bf16 v[136:139], v[128:131], v[36:39], v[136:139]
    v_mfma_f32_16x16x32_bf16 v[140:143], v[132:135], v[36:39], v[140:143]
    ds_read_b64_tr_b16 v[88:89], v7 offset:12288
    ds_read_b64_tr_b16 v[90:91], v7 offset:12544
    ds_read_b64_tr_b16 v[92:93], v9 offset:12320
    ds_read_b64_tr_b16 v[94:95], v9 offset:12576
    ds_read_b64_tr_b16 v[96:97], v7 offset:14336
    ds_read_b64_tr_b16 v[98:99], v7 offset:14592
    ds_read_b64_tr_b16 v[100:101], v9 offset:14368
    ds_read_b64_tr_b16 v[102:103], v9 offset:14624
    ds_read_b64_tr_b16 v[104:105], v7 offset:16384
    ds_read_b64_tr_b16 v[106:107], v7 offset:16640
    ds_read_b64_tr_b16 v[108:109], v9 offset:16416
    ds_read_b64_tr_b16 v[110:111], v9 offset:16672
    s_waitcnt lgkmcnt(0)
    v_mfma_f32_16x16x32_bf16 v[136:139], v[88:91], v[40:43], v[136:139]
    v_mfma_f32_16x16x32_bf16 v[140:143], v[92:95], v[40:43], v[140:143]
    v_mfma_f32_16x16x32_bf16 v[136:139], v[96:99], v[44:47], v[136:139]
    v_mfma_f32_16x16x32_bf16 v[140:143], v[100:103], v[44:47], v[140:143]
    v_mfma_f32_16x16x32_bf16 v[136:139], v[104:107], v[48:51], v[136:139]
    v_mfma_f32_16x16x32_bf16 v[140:143], v[108:111], v[48:51], v[140:143]
    ds_read_b64_tr_b16 v[112:113], v7 offset:18432
    ds_read_b64_tr_b16 v[114:115], v7 offset:18688
    ds_read_b64_tr_b16 v[116:117], v9 offset:18464
    ds_read_b64_tr_b16 v[118:119], v9 offset:18720
    ds_read_b64_tr_b16 v[120:121], v7 offset:20480
    ds_read_b64_tr_b16 v[122:123], v7 offset:20736
    ds_read_b64_tr_b16 v[124:125], v9 offset:20512
    ds_read_b64_tr_b16 v[126:127], v9 offset:20768
    ds_read_b64_tr_b16 v[128:129], v7 offset:22528
    ds_read_b64_tr_b16 v[130:131], v7 offset:22784
    ds_read_b64_tr_b16 v[132:133], v9 offset:22560
    ds_read_b64_tr_b16 v[134:135], v9 offset:22816
    s_waitcnt lgkmcnt(0)
    v_mfma_f32_16x16x32_bf16 v[136:139], v[112:115], v[52:55], v[136:139]
    v_mfma_f32_16x16x32_bf16 v[140:143], v[116:119], v[52:55], v[140:143]
    v_mfma_f32_16x16x32_bf16 v[136:139], v[120:123], v[56:59], v[136:139]
    v_mfma_f32_16x16x32_bf16 v[140:143], v[124:127], v[56:59], v[140:143]
    v_mfma_f32_16x16x32_bf16 v[136:139], v[128:131], v[60:63], v[136:139]
    v_mfma_f32_16x16x32_bf16 v[140:143], v[132:135], v[60:63], v[140:143]
    ds_read_b64_tr_b16 v[88:89], v7 offset:24576
    ds_read_b64_tr_b16 v[90:91], v7 offset:24832
    ds_read_b64_tr_b16 v[92:93], v9 offset:24608
    ds_read_b64_tr_b16 v[94:95], v9 offset:24864
    ds_read_b64_tr_b16 v[96:97], v7 offset:26624
    ds_read_b64_tr_b16 v[98:99], v7 offset:26880
    ds_read_b64_tr_b16 v[100:101], v9 offset:26656
    ds_read_b64_tr_b16 v[102:103], v9 offset:26912
    ds_read_b64_tr_b16 v[104:105], v7 offset:28672
    ds_read_b64_tr_b16 v[106:107], v7 offset:28928
    ds_read_b64_tr_b16 v[108:109], v9 offset:28704
    ds_read_b64_tr_b16 v[110:111], v9 offset:28960
    s_waitcnt lgkmcnt(0)
    v_mfma_f32_16x16x32_bf16 v[136:139], v[88:91], v[64:67], v[136:139]
    v_mfma_f32_16x16x32_bf16 v[140:143], v[92:95], v[64:67], v[140:143]
    v_mfma_f32_16x16x32_bf16 v[136:139], v[96:99], v[68:71], v[136:139]
    v_mfma_f32_16x16x32_bf16 v[140:143], v[100:103], v[68:71], v[140:143]
    v_mfma_f32_16x16x32_bf16 v[136:139], v[104:107], v[72:75], v[136:139]
    v_mfma_f32_16x16x32_bf16 v[140:143], v[108:111], v[72:75], v[140:143]
    ds_read_b64_tr_b16 v[112:113], v7 offset:30720
    ds_read_b64_tr_b16 v[114:115], v7 offset:30976
    ds_read_b64_tr_b16 v[116:117], v9 offset:30752
    ds_read_b64_tr_b16 v[118:119], v9 offset:31008
    ds_read_b64_tr_b16 v[120:121], v7 offset:32768
    ds_read_b64_tr_b16 v[122:123], v7 offset:33024
    ds_read_b64_tr_b16 v[124:125], v9 offset:32800
    ds_read_b64_tr_b16 v[126:127], v9 offset:33056
    ds_read_b64_tr_b16 v[128:129], v7 offset:34816
    ds_read_b64_tr_b16 v[130:131], v7 offset:35072
    ds_read_b64_tr_b16 v[132:133], v9 offset:34848
    ds_read_b64_tr_b16 v[134:135], v9 offset:35104
    s_waitcnt lgkmcnt(0)
    v_mfma_f32_16x16x32_bf16 v[136:139], v[112:115], v[76:79], v[136:139]
    v_mfma_f32_16x16x32_bf16 v[140:143], v[116:119], v[76:79], v[140:143]
    v_mfma_f32_16x16x32_bf16 v[136:139], v[120:123], v[80:83], v[136:139]
    v_mfma_f32_16x16x32_bf16 v[140:143], v[124:127], v[80:83], v[140:143]
    v_mfma_f32_16x16x32_bf16 v[136:139], v[128:131], v[84:87], v[136:139]
    v_mfma_f32_16x16x32_bf16 v[140:143], v[132:135], v[84:87], v[140:143]
    s_nop 7
    s_add_u32 s24, s32, 0xb40000
    s_addc_u32 s25, s33, 0
    s_mov_b32 s26, 0x28000
    s_mov_b32 s27, 0x00020000
    v_add_u32 v11, s30, v12
    v_lshrrev_b32 v15, 8, v11
    v_mul_u32_u24 v15, 20480, v15
    v_and_b32 v11, 255, v11
    s_cmp_eq_u32 s28, 7
    s_cbranch_scc1 .Lvp_3
    v_cvt_pk_bf16_f32 v136, v136, v137
    v_cvt_pk_bf16_f32 v137, v138, v139
    v_lshl_add_u32 v3, v11, 5, v15
    v_lshl_add_u32 v3, v13, 3, v3
    buffer_store_dwordx2 v[136:137], v3, s[24:27], 0 offen
    v_cvt_pk_bf16_f32 v140, v140, v141
    v_mov_b32 v141, 0x3f80
    v_lshl_add_u32 v3, v11, 3, v15
    v_cmp_eq_u32 vcc, 0, v13
    s_mov_b32 s37, 8192
    s_and_saveexec_b64 s[38:39], vcc
    buffer_store_dwordx2 v[140:141], v3, s[24:27], s37 offen
    s_endpgm
.Lvp_3:
    v_lshrrev_b32 v3, 4, v11
    v_mul_u32_u24 v3, 640, v3
    v_add_u32 v3, v3, v15
    v_add_u32 v3, 10240, v3
    v_bfe_u32 v7, v11, 2, 1
    v_lshl_add_u32 v3, v7, 4, v3
    v_and_b32 v7, 3, v11
    v_lshl_add_u32 v3, v7, 1, v3
    v_bfe_u32 v7, v11, 3, 1
    v_lshl_add_u32 v3, v7, 3, v3
    v_lshl_add_u32 v8, v13, 7, v3
    v_cvt_pk_bf16_f32 v136, v136, v137
    v_cvt_pk_bf16_f32 v137, v138, v139
    v_cvt_pk_bf16_f32 v140, v140, v141
    v_mov_b32 v141, 0x3f80
    buffer_store_short v136, v8, s[24:27], 0 offen offset:0
    buffer_store_short_d16_hi v136, v8, s[24:27], 0 offen offset:32
    buffer_store_short v137, v8, s[24:27], 0 offen offset:64
    buffer_store_short_d16_hi v137, v8, s[24:27], 0 offen offset:96
    v_cmp_eq_u32 vcc, 0, v13
    s_and_saveexec_b64 s[38:39], vcc
    buffer_store_short v140, v3, s[24:27], 0 offen offset:512
    buffer_store_short_d16_hi v140, v3, s[24:27], 0 offen offset:544
    buffer_store_short v141, v3, s[24:27], 0 offen offset:576
    buffer_store_short_d16_hi v141, v3, s[24:27], 0 offen offset:608
    s_endpgm
.Lend_1:
    s_endpgm
.section .rodata,"a"
.p2align 6
.amdhsa_kernel qkva1_kernel
  .amdhsa_next_free_vgpr 176
  .amdhsa_next_free_sgpr 100
  .amdhsa_accum_offset 176
  .amdhsa_group_segment_fixed_size 0
  .amdhsa_kernarg_size 88
  .amdhsa_user_sgpr_count 2
  .amdhsa_user_sgpr_kernarg_segment_ptr 1
  .amdhsa_system_sgpr_workgroup_id_x 1
.end_amdhsa_kernel
.text
.globl attng_kernel
.p2align 8
.type attng_kernel,@function
attng_kernel:
    s_cmp_ge_u32 s2, 256
    s_cbranch_scc1 .Lend_4
    s_load_dwordx2 s[4:5], s[0:1], 80
    s_load_dwordx16 s[48:63], s[0:1], 0
    v_and_b32 v1, 63, v0
    v_lshrrev_b32 v2, 6, v0
    s_nop 0
    v_readfirstlane_b32 s20, v2
    v_and_b32 v2, 31, v1
    v_lshrrev_b32 v3, 5, v1
    s_lshl_b32 s21, s2, 3
    s_add_u32 s21, s21, s20
    s_mul_i32 s22, s21, 1152
    v_mul_u32_u24 v4, 36, v2
    v_add_u32 v4, s22, v4
    v_lshl_add_u32 v5, v3, 4, v4
    v_lshlrev_b32 v6, 4, v1
    s_waitcnt lgkmcnt(0)
    s_add_u32 s8, s4, 0x6c0000
    s_addc_u32 s9, s5, 0
    s_mov_b32 s10, 0x240000
    s_mov_b32 s11, 0x00020000
    s_add_u32 s12, s4, 0xb40000
    s_addc_u32 s13, s5, 0
    s_mov_b32 s14, 0x28000
    s_mov_b32 s15, 0x00020000
    s_add_u32 s16, s4, 0x900000
    s_addc_u32 s17, s5, 0
    s_mov_b32 s18, 0x240000
    s_mov_b32 s19, 0x00020000
    buffer_load_dwordx4 v[8:11], v5, s[8:11], 0 offen
    buffer_load_dword v12, v4, s[8:11], 0 offen offset:32
    s_lshl_b32 s23, s20, 10
    s_add_u32 s24, s23, 0
    s_mov_b32 m0, s24
    s_nop 0
    buffer_load_dwordx4 v6, s[12:15], s24 offen lds
    s_add_u32 s24, s23, 8192
    s_mov_b32 m0, s24
    s_nop 0
    buffer_load_dwordx4 v6, s[12:15], s24 offen lds
    s_add_u32 s24, s23, 16384
    s_mov_b32 m0, s24
    s_nop 0
    buffer_load_dwordx4 v6, s[12:15], s24 offen lds
    s_add_u32 s24, s24, 8192
    s_add_u32 s25, s23, 163840
    v_and_b32 v113, 15, v1
    v_lshrrev_b32 v114, 4, v1
    s_add_u32 s44, s21, 0
    s_mov_b32 s79, 0x00020000
    s_cmp_ge_u32 s44, 1944
    s_cbranch_scc1 .Lgkv_5
    s_cmp_ge_u32 s44, 648
    s_cselect_b32 s76, s56, s50
    s_cselect_b32 s77, s57, s51
    s_cselect_b32 s82, 648, 0
    s_cmp_ge_u32 s44, 1296
    s_cselect_b32 s76, s62, s76
    s_cselect_b32 s77, s63, s77
    s_cselect_b32 s82, 1296, s82
    s_mov_b32 s78, 663552
    s_lshl_b32 s81, s44, 10
    s_add_u32 s81, s81, 16777216
    s_sub_u32 s82, s44, s82
    s_mul_i32 s83, s82, 607
    s_lshr_b32 s83, s83, 16
    s_mul_i32 s84, s83, 108
    s_sub_u32 s84, s82, s84
    s_mul_i32 s85, s84, 10923
    s_lshr_b32 s85, s85, 16
    s_mul_i32 s86, s85, 6
    s_sub_u32 s86, s84, s86
    s_mul_i32 s83, s83, 96
    s_lshl_b32 s86, s86, 4
    s_add_u32 s83, s83, s86
    v_add_u32 v115, s83, v113
    v_lshlrev_b32 v115, 1, v115
    s_movk_i32 s80, 1152
    s_branch .Lgd_7
.Lgkv_5:
    s_cmp_ge_u32 s44, 2016
    s_cbranch_scc1 .Lgq_6
    s_sub_u32 s82, s44, 1944
    s_lshl_b32 s81, s82, 10
    s_add_u32 s81, s81, 18767872
    s_cmp_ge_u32 s82, 36
    s_cselect_b32 s76, s54, s52
    s_cselect_b32 s77, s55, s53
    s_cselect_b32 s83, 36, 0
    s_mov_b32 s78, 20736
    s_sub_u32 s82, s82, s83
    s_lshr_b32 s85, s82, 1
    s_and_b32 s86, s82, 1
    s_lshl_b32 s86, s86, 4
    v_add_u32 v115, s86, v113
    v_cmp_gt_u32 vcc, 18, v115
    v_lshlrev_b32 v115, 1, v115
    v_mov_b32 v116, 0x7f000000
    v_cndmask_b32 v115, v116, v115, vcc
    s_movk_i32 s80, 36
    s_branch .Lgd_7
.Lgq_6:
    s_mov_b32 s76, s60
    s_mov_b32 s77, s61
    s_mov_b32 s78, 1990656
    s_sub_u32 s82, s44, 2016
    s_lshl_b32 s81, s82, 10
    s_add_u32 s81, s81, 18874368
    s_cmp_ge_u32 s44, 4032
    s_cselect_b32 s81, 0x7f000000, s81
    s_cselect_b32 s82, 0, s82
    s_cselect_b32 s87, 0, 108
    s_mul_i32 s83, s82, 2081
    s_lshr_b32 s83, s83, 18
    s_mul_i32 s84, s83, 126
    s_sub_u32 s84, s82, s84
    s_mul_i32 s85, s84, 9363
    s_lshr_b32 s85, s85, 16
    s_mul_i32 s86, s85, 7
    s_sub_u32 s86, s84, s86
    s_lshl_b32 s86, s86, 4
    v_add_u32 v115, s86, v113
    v_mul_u32_u24 v116, 57, v115
    v_lshrrev_b32 v116, 11, v116
    v_mul_u32_u24 v116, 540, v116
    v_add_u32 v116, v116, v115
    s_mul_i32 s83, s83, 36
    v_add_u32 v116, s83, v116
    v_cmp_gt_u32 vcc, s87, v115
    v_lshlrev_b32 v115, 1, v116
    v_mov_b32 v116, 0x7f000000
    v_cndmask_b32 v115, v116, v115, vcc
    s_movk_i32 s80, 3456
.Lgd_7:
    s_lshl_b32 s85, s85, 5
    v_lshl_add_u32 v116, v114, 3, s85
    v_mul_lo_u32 v116, v116, s80
    v_add_u32 v115, v115, v116
    v_mov_b32 v118, v115
    s_add_u32 s44, s21, 2048
    s_mov_b32 s91, 0x00020000
    s_cmp_ge_u32 s44, 1944
    s_cbranch_scc1 .Lgkv_8
    s_cmp_ge_u32 s44, 648
    s_cselect_b32 s88, s56, s50
    s_cselect_b32 s89, s57, s51
    s_cselect_b32 s94, 648, 0
    s_cmp_ge_u32 s44, 1296
    s_cselect_b32 s88, s62, s88
    s_cselect_b32 s89, s63, s89
    s_cselect_b32 s94, 1296, s94
    s_mov_b32 s90, 663552
    s_lshl_b32 s93, s44, 10
    s_add_u32 s93, s93, 16777216
    s_sub_u32 s94, s44, s94
    s_mul_i32 s95, s94, 607
    s_lshr_b32 s95, s95, 16
    s_mul_i32 s96, s95, 108
    s_sub_u32 s96, s94, s96
    s_mul_i32 s97, s96, 10923
    s_lshr_b32 s97, s97, 16
    s_mul_i32 s98, s97, 6
    s_sub_u32 s98, s96, s98
    s_mul_i32 s95, s95, 96
    s_lshl_b32 s98, s98, 4
    s_add_u32 s95, s95, s98
    v_add_u32 v115, s95, v113
    v_lshlrev_b32 v115, 1, v115
    s_movk_i32 s92, 1152
    s_branch .Lgd_10
.Lgkv_8:
    s_cmp_ge_u32 s44, 2016
    s_cbranch_scc1 .Lgq_9
    s_sub_u32 s94, s44, 1944
    s_lshl_b32 s93, s94, 10
    s_add_u32 s93, s93, 18767872
    s_cmp_ge_u32 s94, 36
    s_cselect_b32 s88, s54, s52
    s_cselect_b32 s89, s55, s53
    s_cselect_b32 s95, 36, 0
    s_mov_b32 s90, 20736
    s_sub_u32 s94, s94, s95
    s_lshr_b32 s97, s94, 1
    s_and_b32 s98, s94, 1
    s_lshl_b32 s98, s98, 4
    v_add_u32 v115, s98, v113
    v_cmp_gt_u32 vcc, 18, v115
    v_lshlrev_b32 v115, 1, v115
    v_mov_b32 v116, 0x7f000000
    v_cndmask_b32 v115, v116, v115, vcc
    s_movk_i32 s92, 36
    s_branch .Lgd_10
.Lgq_9:
    s_mov_b32 s88, s60
    s_mov_b32 s89, s61
    s_mov_b32 s90, 1990656
    s_sub_u32 s94, s44, 2016
    s_lshl_b32 s93, s94, 10
    s_add_u32 s93, s93, 18874368
    s_cmp_ge_u32 s44, 4032
    s_cselect_b32 s93, 0x7f000000, s93
    s_cselect_b32 s94, 0, s94
    s_cselect_b32 s99, 0, 108
    s_mul_i32 s95, s94, 2081
    s_lshr_b32 s95, s95, 18
    s_mul_i32 s96, s95, 126
    s_sub_u32 s96, s94, s96
    s_mul_i32 s97, s96, 9363
    s_lshr_b32 s97, s97, 16
    s_mul_i32 s98, s97, 7
    s_sub_u32 s98, s96, s98
    s_lshl_b32 s98, s98, 4
    v_add_u32 v115, s98, v113
    v_mul_u32_u24 v116, 57, v115
    v_lshrrev_b32 v116, 11, v116
    v_mul_u32_u24 v116, 540, v116
    v_add_u32 v116, v116, v115
    s_mul_i32 s95, s95, 36
    v_add_u32 v116, s95, v116
    v_cmp_gt_u32 vcc, s99, v115
    v_lshlrev_b32 v115, 1, v116
    v_mov_b32 v116, 0x7f000000
    v_cndmask_b32 v115, v116, v115, vcc
    s_movk_i32 s92, 3456
.Lgd_10:
    s_lshl_b32 s97, s97, 5
    v_lshl_add_u32 v116, v114, 3, s97
    v_mul_lo_u32 v116, v116, s92
    v_add_u32 v115, v115, v116
    v_mov_b32 v119, v115
    v_lshlrev_b32 v110, 5, v2
    v_lshl_add_u32 v110, v3, 4, v110
    v_add_u32 v112, 10240, v110
    v_lshlrev_b32 v111, 3, v2
    v_add_u32 v111, 8192, v111
    v_mov_b32 v26, 0
    v_mov_b32 v27, 0
    v_mov_b32 v30, 0
    v_mov_b32 v31, 0
    v_mov_b32 v13, 0
    v_mov_b32 v14, 0
    v_mov_b32 v15, 0
    v_cmp_eq_u32 s[26:27], 0, v3
    s_mov_b32 s28, 1
    s_waitcnt vmcnt(0)
    v_cndmask_b32 v12, 0, v12, s[26:27]
    s_barrier
    ds_read_b128 v[16:19], v110
    ds_read_b64 v[24:25], v111
    s_waitcnt lgkmcnt(0)
    v_mfma_f32_32x32x16_bf16 v[48:63], v[16:19], v[8:11], 0
    v_mfma_f32_32x32x16_bf16 v[48:63], v[24:27], v[12:15], v[48:63]
    s_nop 15
    v_max3_f32 v113, v48, v49, v50
    v_max3_f32 v113, v113, v51, v52
    v_max3_f32 v113, v113, v53, v54
    v_max3_f32 v113, v113, v55, v56
    v_max3_f32 v113, v113, v57, v58
    v_max3_f32 v113, v113, v59, v60
    v_max3_f32 v113, v113, v61, v62
    v_max_f32 v113, v113, v63
.Lsetm_11:
    v_mov_b32 v114, v113
    s_nop 1
    v_permlane32_swap_b32 v113, v114
    v_max_f32 v113, v113, v114
    v_cvt_pk_bf16_f32 v113, v113, v113
    v_and_b32 v113, 0xffff, v113
    v_xor_b32 v113, 0x8000, v113
    v_cndmask_b32 v13, 0, v113, s[26:27]
    v_mov_b32 v88, 0
    v_mov_b32 v89, 0
    v_mov_b32 v90, 0
    v_mov_b32 v91, 0
    v_mov_b32 v92, 0
    v_mov_b32 v93, 0
    v_mov_b32 v94, 0
    v_mov_b32 v95, 0
    v_mov_b32 v96, 0
    v_mov_b32 v97, 0
    v_mov_b32 v98, 0
    v_mov_b32 v99, 0
    v_mov_b32 v100, 0
    v_mov_b32 v101, 0
    v_mov_b32 v102, 0
    v_mov_b32 v103, 0
    v_mov_b32 v84, 0
    v_mov_b32 v44, 0
    v_mov_b32 v85, 0
    v_mov_b32 v45, 0
    v_mov_b32 v86, 0
    v_mov_b32 v46, 0
    v_mov_b32 v87, 0
    v_mov_b32 v47, 0
    v_mov_b32 v104, v110
    v_add_u32 v107, 20480, v110
    v_mov_b32 v105, v111
    v_add_u32 v108, 20480, v111
    v_mov_b32 v106, v112
    v_add_u32 v109, 20480, v112
    ds_read_b128 v[16:19], v110
    ds_read_b64 v[24:25], v111
    ds_read_b128 v[20:23], v110 offset:1024
    ds_read_b64 v[28:29], v111 offset:256
    ds_read_b128 v[32:35], v112
    ds_read_b128 v[36:39], v112 offset:640
    s_mov_b32 s29, 0
    s_waitcnt lgkmcnt(4)
    v_mfma_f32_32x32x16_bf16 v[48:63], v[16:19], v[8:11], 0
    v_mfma_f32_32x32x16_bf16 v[48:63], v[24:27], v[12:15], v[48:63]
    s_nop 7
.Lloop_12:
    ds_read_b128 v[16:19], v104 offset:2048
    ds_read_b64 v[24:25], v105 offset:512
    v_mfma_f32_32x32x16_bf16 v[88:103], v[44:47], v[84:87], v[88:103]
    ds_read_b128 v[40:43], v106 offset:1280
    ds_read_b128 v[44:47], v106 offset:1920
    s_waitcnt lgkmcnt(4)
    v_mfma_f32_32x32x16_bf16 v[64:79], v[20:23], v[8:11], 0
    v_exp_f32 v48, v48
    v_exp_f32 v49, v49
    v_exp_f32 v50, v50
    v_exp_f32 v51, v51
    v_mfma_f32_32x32x16_bf16 v[64:79], v[28:31], v[12:15], v[64:79]
    v_exp_f32 v52, v52
    v_exp_f32 v53, v53
    v_exp_f32 v54, v54
    v_exp_f32 v55, v55
    v_cvt_pk_bf16_f32 v80, v48, v49
    v_cvt_pk_bf16_f32 v81, v50, v51
    v_cvt_pk_bf16_f32 v82, v52, v53
    v_cvt_pk_bf16_f32 v83, v54, v55
    v_exp_f32 v56, v56
    v_exp_f32 v57, v57
    v_exp_f32 v58, v58
    v_exp_f32 v59, v59
    v_mfma_f32_32x32x16_bf16 v[88:103], v[32:35], v[80:83], v[88:103]
    v_exp_f32 v60, v60
    v_exp_f32 v61, v61
    v_exp_f32 v62, v62
    v_exp_f32 v63, v63
    v_cvt_pk_bf16_f32 v84, v56, v57
    v_cvt_pk_bf16_f32 v85, v58, v59
    v_cvt_pk_bf16_f32 v86, v60, v61
    v_cvt_pk_bf16_f32 v87, v62, v63
    s_cmp_ge_u32 s24, s25
    s_cbranch_scc1 .Lnodma_13
    s_mov_b32 m0, s24
    s_nop 0
    buffer_load_dwordx4 v6, s[12:15], s24 offen lds
    s_add_u32 s24, s24, 8192
.Lnodma_13:
    s_cmp_lg_u32 s29, 4
    s_cbranch_scc1 .Lnog_14
    s_cmp_eq_u32 s28, 0
    s_cbranch_scc1 .Lnog_14
    s_mul_i32 s45, s80, 0
    buffer_load_ushort v120, v118, s[76:79], s45 offen
    s_mul_i32 s45, s80, 1
    buffer_load_ushort v121, v118, s[76:79], s45 offen
    s_mul_i32 s45, s80, 2
    buffer_load_ushort v122, v118, s[76:79], s45 offen
    s_mul_i32 s45, s80, 3
    buffer_load_ushort v123, v118, s[76:79], s45 offen
    s_mul_i32 s45, s80, 4
    buffer_load_ushort v124, v118, s[76:79], s45 offen
    s_mul_i32 s45, s80, 5
    buffer_load_ushort v125, v118, s[76:79], s45 offen
    s_mul_i32 s45, s80, 6
    buffer_load_ushort v126, v118, s[76:79], s45 offen
    s_mul_i32 s45, s80, 7
    buffer_load_ushort v127, v118, s[76:79], s45 offen
    s_mul_i32 s45, s92, 0
    buffer_load_ushort v128, v119, s[88:91], s45 offen
    s_mul_i32 s45, s92, 1
    buffer_load_ushort v129, v119, s[88:91], s45 offen
    s_mul_i32 s45, s92, 2
    buffer_load_ushort v130, v119, s[88:91], s45 offen
    s_mul_i32 s45, s92, 3
    buffer_load_ushort v131, v119, s[88:91], s45 offen
    s_mul_i32 s45, s92, 4
    buffer_load_ushort v132, v119, s[88:91], s45 offen
    s_mul_i32 s45, s92, 5
    buffer_load_ushort v133, v119, s[88:91], s45 offen
    s_mul_i32 s45, s92, 6
    buffer_load_ushort v134, v119, s[88:91], s45 offen
    s_mul_i32 s45, s92, 7
    buffer_load_ushort v135, v119, s[88:91], s45 offen
.Lnog_14:
    ds_read_b128 v[20:23], v104 offset:3072
    ds_read_b64 v[28:29], v105 offset:768
    v_mfma_f32_32x32x16_bf16 v[88:103], v[36:39], v[84:87], v[88:103]
    ds_read_b128 v[32:35], v106 offset:2560
    ds_read_b128 v[36:39], v106 offset:3200
    s_waitcnt lgkmcnt(4)
    v_mfma_f32_32x32x16_bf16 v[48:63], v[16:19], v[8:11], 0
    v_exp_f32 v64, v64
    v_exp_f32 v65, v65
    v_exp_f32 v66, v66
    v_exp_f32 v67, v67
    v_mfma_f32_32x32x16_bf16 v[48:63], v[24:27], v[12:15], v[48:63]
    v_exp_f32 v68, v68
    v_exp_f32 v69, v69
    v_exp_f32 v70, v70
    v_exp_f32 v71, v71
    v_cvt_pk_bf16_f32 v80, v64, v65
    v_cvt_pk_bf16_f32 v81, v66, v67
    v_cvt_pk_bf16_f32 v82, v68, v69
    v_cvt_pk_bf16_f32 v83, v70, v71
    v_exp_f32 v72, v72
    v_exp_f32 v73, v73
    v_exp_f32 v74, v74
    v_exp_f32 v75, v75
    v_mfma_f32_32x32x16_bf16 v[88:103], v[40:43], v[80:83], v[88:103]
    v_exp_f32 v76, v76
    v_exp_f32 v77, v77
    v_exp_f32 v78, v78
    v_exp_f32 v79, v79
    v_cvt_pk_bf16_f32 v84, v72, v73
    v_cvt_pk_bf16_f32 v85, v74, v75
    v_cvt_pk_bf16_f32 v86, v76, v77
    v_cvt_pk_bf16_f32 v87, v78, v79
    s_cmp_ge_u32 s24, s25
    s_cbranch_scc1 .Lnodma_15
    s_mov_b32 m0, s24
    s_nop 0
    buffer_load_dwordx4 v6, s[12:15], s24 offen lds
    s_add_u32 s24, s24, 8192
.Lnodma_15:
    ds_read_b128 v[16:19], v104 offset:4096
    ds_read_b64 v[24:25], v105 offset:1024
    v_mfma_f32_32x32x16_bf16 v[88:103], v[44:47], v[84:87], v[88:103]
    ds_read_b128 v[40:43], v106 offset:3840
    ds_read_b128 v[44:47], v106 offset:4480
    s_waitcnt lgkmcnt(4)
    v_mfma_f32_32x32x16_bf16 v[64:79], v[20:23], v[8:11], 0
    v_exp_f32 v48, v48
    v_exp_f32 v49, v49
    v_exp_f32 v50, v50
    v_exp_f32 v51, v51
    v_mfma_f32_32x32x16_bf16 v[64:79], v[28:31], v[12:15], v[64:79]
    v_exp_f32 v52, v52
    v_exp_f32 v53, v53
    v_exp_f32 v54, v54
    v_exp_f32 v55, v55
    v_cvt_pk_bf16_f32 v80, v48, v49
    v_cvt_pk_bf16_f32 v81, v50, v51
    v_cvt_pk_bf16_f32 v82, v52, v53
    v_cvt_pk_bf16_f32 v83, v54, v55
    v_exp_f32 v56, v56
    v_exp_f32 v57, v57
    v_exp_f32 v58, v58
    v_exp_f32 v59, v59
    v_mfma_f32_32x32x16_bf16 v[88:103], v[32:35], v[80:83], v[88:103]
    v_exp_f32 v60, v60
    v_exp_f32 v61, v61
    v_exp_f32 v62, v62
    v_exp_f32 v63, v63
    v_cvt_pk_bf16_f32 v84, v56, v57
    v_cvt_pk_bf16_f32 v85, v58, v59
    v_cvt_pk_bf16_f32 v86, v60, v61
    v_cvt_pk_bf16_f32 v87, v62, v63
    s_cmp_ge_u32 s24, s25
    s_cbranch_scc1 .Lnodma_16
    s_mov_b32 m0, s24
    s_nop 0
    buffer_load_dwordx4 v6, s[12:15], s24 offen lds
    s_add_u32 s24, s24, 8192
.Lnodma_16:
    ds_read_b128 v[20:23], v104 offset:5120
    ds_read_b64 v[28:29], v105 offset:1280
    v_mfma_f32_32x32x16_bf16 v[88:103], v[36:39], v[84:87], v[88:103]
    ds_read_b128 v[32:35], v106 offset:5120
    ds_read_b128 v[36:39], v106 offset:5760
    s_waitcnt lgkmcnt(4)
    v_mfma_f32_32x32x16_bf16 v[48:63], v[16:19], v[8:11], 0
    v_exp_f32 v64, v64
    v_exp_f32 v65, v65
    v_exp_f32 v66, v66
    v_exp_f32 v67, v67
    v_mfma_f32_32x32x16_bf16 v[48:63], v[24:27], v[12:15], v[48:63]
    v_exp_f32 v68, v68
    v_exp_f32 v69, v69
    v_exp_f32 v70, v70
    v_exp_f32 v71, v71
    v_cvt_pk_bf16_f32 v80, v64, v65
    v_cvt_pk_bf16_f32 v81, v66, v67
    v_cvt_pk_bf16_f32 v82, v68, v69
    v_cvt_pk_bf16_f32 v83, v70, v71
    v_exp_f32 v72, v72
    v_exp_f32 v73, v73
    v_exp_f32 v74, v74
    v_exp_f32 v75, v75
    v_mfma_f32_32x32x16_bf16 v[88:103], v[40:43], v[80:83], v[88:103]
    v_exp_f32 v76, v76
    v_exp_f32 v77, v77
    v_exp_f32 v78, v78
    v_exp_f32 v79, v79
    v_cvt_pk_bf16_f32 v84, v72, v73
    v_cvt_pk_bf16_f32 v85, v74, v75
    v_cvt_pk_bf16_f32 v86, v76, v77
    v_cvt_pk_bf16_f32 v87, v78, v79
    s_cmp_ge_u32 s24, s25
    s_cbranch_scc1 .Lnodma_17
    s_mov_b32 m0, s24
    s_nop 0
    buffer_load_dwordx4 v6, s[12:15], s24 offen lds
    s_add_u32 s24, s24, 8192
.Lnodma_17:
    ds_read_b128 v[16:19], v104 offset:6144
    ds_read_b64 v[24:25], v105 offset:1536
    v_mfma_f32_32x32x16_bf16 v[88:103], v[44:47], v[84:87], v[88:103]
    ds_read_b128 v[40:43], v106 offset:6400
    ds_read_b128 v[44:47], v106 offset:7040
    s_waitcnt lgkmcnt(4)
    v_mfma_f32_32x32x16_bf16 v[64:79], v[20:23], v[8:11], 0
    v_exp_f32 v48, v48
    v_exp_f32 v49, v49
    v_exp_f32 v50, v50
    v_exp_f32 v51, v51
    v_mfma_f32_32x32x16_bf16 v[64:79], v[28:31], v[12:15], v[64:79]
    v_exp_f32 v52, v52
    v_exp_f32 v53, v53
    v_exp_f32 v54, v54
    v_exp_f32 v55, v55
    v_cvt_pk_bf16_f32 v80, v48, v49
    v_cvt_pk_bf16_f32 v81, v50, v51
    v_cvt_pk_bf16_f32 v82, v52, v53
    v_cvt_pk_bf16_f32 v83, v54, v55
    v_exp_f32 v56, v56
    v_exp_f32 v57, v57
    v_exp_f32 v58, v58
    v_exp_f32 v59, v59
    v_mfma_f32_32x32x16_bf16 v[88:103], v[32:35], v[80:83], v[88:103]
    v_exp_f32 v60, v60
    v_exp_f32 v61, v61
    v_exp_f32 v62, v62
    v_exp_f32 v63, v63
    v_cvt_pk_bf16_f32 v84, v56, v57
    v_cvt_pk_bf16_f32 v85, v58, v59
    v_cvt_pk_bf16_f32 v86, v60, v61
    v_cvt_pk_bf16_f32 v87, v62, v63
    s_cmp_ge_u32 s24, s25
    s_cbranch_scc1 .Lnodma_18
    s_mov_b32 m0, s24
    s_nop 0
    buffer_load_dwordx4 v6, s[12:15], s24 offen lds
    s_add_u32 s24, s24, 8192
.Lnodma_18:
    ds_read_b128 v[20:23], v104 offset:7168
    ds_read_b64 v[28:29], v105 offset:1792
    v_mfma_f32_32x32x16_bf16 v[88:103], v[36:39], v[84:87], v[88:103]
    ds_read_b128 v[32:35], v106 offset:7680
    ds_read_b128 v[36:39], v106 offset:8320
    s_waitcnt lgkmcnt(4)
    v_mfma_f32_32x32x16_bf16 v[48:63], v[16:19], v[8:11], 0
    v_exp_f32 v64, v64
    v_exp_f32 v65, v65
    v_exp_f32 v66, v66
    v_exp_f32 v67, v67
    v_mfma_f32_32x32x16_bf16 v[48:63], v[24:27], v[12:15], v[48:63]
    v_exp_f32 v68, v68
    v_exp_f32 v69, v69
    v_exp_f32 v70, v70
    v_exp_f32 v71, v71
    v_cvt_pk_bf16_f32 v80, v64, v65
    v_cvt_pk_bf16_f32 v81, v66, v67
    v_cvt_pk_bf16_f32 v82, v68, v69
    v_cvt_pk_bf16_f32 v83, v70, v71
    v_exp_f32 v72, v72
    v_exp_f32 v73, v73
    v_exp_f32 v74, v74
    v_exp_f32 v75, v75
    v_mfma_f32_32x32x16_bf16 v[88:103], v[40:43], v[80:83], v[88:103]
    v_exp_f32 v76, v76
    v_exp_f32 v77, v77
    v_exp_f32 v78, v78
    v_exp_f32 v79, v79
    v_cvt_pk_bf16_f32 v84, v72, v73
    v_cvt_pk_bf16_f32 v85, v74, v75
    v_cvt_pk_bf16_f32 v86, v76, v77
    v_cvt_pk_bf16_f32 v87, v78, v79
    s_cmp_ge_u32 s24, s25
    s_cbranch_scc1 .Lnodma_19
    s_mov_b32 m0, s24
    s_nop 0
    buffer_load_dwordx4 v6, s[12:15], s24 offen lds
    s_add_u32 s24, s24, 8192
.Lnodma_19:
    s_cmp_eq_u32 s28, 0
    s_cbranch_scc1 .Lnosync_20
    s_cmp_eq_u32 s29, 1
    s_cbranch_scc1 .Ll5_21
    s_cmp_eq_u32 s29, 3
    s_cbranch_scc1 .Ll0_22
    s_cmp_lg_u32 s29, 0
    s_cbranch_scc1 .Lnosync_20
    s_waitcnt vmcnt(4)
    s_branch .Llb_23
.Ll5_21:
    s_waitcnt vmcnt(7)
    s_branch .Llb_23
.Ll0_22:
    s_waitcnt vmcnt(0)
.Llb_23:
    s_barrier
.Lnosync_20:
    ds_read_b128 v[16:19], v107 offset:0
    ds_read_b64 v[24:25], v108 offset:0
    v_mfma_f32_32x32x16_bf16 v[88:103], v[44:47], v[84:87], v[88:103]
    ds_read_b128 v[40:43], v106 offset:8960
    ds_read_b128 v[44:47], v106 offset:9600
    s_waitcnt lgkmcnt(4)
    v_mfma_f32_32x32x16_bf16 v[64:79], v[20:23], v[8:11], 0
    v_exp_f32 v48, v48
    v_exp_f32 v49, v49
    v_exp_f32 v50, v50
    v_exp_f32 v51, v51
    v_mfma_f32_32x32x16_bf16 v[64:79], v[28:31], v[12:15], v[64:79]
    v_exp_f32 v52, v52
    v_exp_f32 v53, v53
    v_exp_f32 v54, v54
    v_exp_f32 v55, v55
    v_cvt_pk_bf16_f32 v80, v48, v49
    v_cvt_pk_bf16_f32 v81, v50, v51
    v_cvt_pk_bf16_f32 v82, v52, v53
    v_cvt_pk_bf16_f32 v83, v54, v55
    v_exp_f32 v56, v56
    v_exp_f32 v57, v57
    v_exp_f32 v58, v58
    v_exp_f32 v59, v59
    v_mfma_f32_32x32x16_bf16 v[88:103], v[32:35], v[80:83], v[88:103]
    v_exp_f32 v60, v60
    v_exp_f32 v61, v61
    v_exp_f32 v62, v62
    v_exp_f32 v63, v63
    v_cvt_pk_bf16_f32 v84, v56, v57
    v_cvt_pk_bf16_f32 v85, v58, v59
    v_cvt_pk_bf16_f32 v86, v60, v61
    v_cvt_pk_bf16_f32 v87, v62, v63
    s_cmp_ge_u32 s24, s25
    s_cbranch_scc1 .Lnodma_24
    s_mov_b32 m0, s24
    s_nop 0
    buffer_load_dwordx4 v6, s[12:15], s24 offen lds
    s_add_u32 s24, s24, 8192
.Lnodma_24:
    ds_read_b128 v[20:23], v107 offset:1024
    ds_read_b64 v[28:29], v108 offset:256
    v_mfma_f32_32x32x16_bf16 v[88:103], v[36:39], v[84:87], v[88:103]
    ds_read_b128 v[32:35], v109 offset:0
    ds_read_b128 v[36:39], v109 offset:640
    s_waitcnt lgkmcnt(4)
    v_mfma_f32_32x32x16_bf16 v[48:63], v[16:19], v[8:11], 0
    v_exp_f32 v64, v64
    v_exp_f32 v65, v65
    v_exp_f32 v66, v66
    v_exp_f32 v67, v67
    v_mfma_f32_32x32x16_bf16 v[48:63], v[24:27], v[12:15], v[48:63]
    v_exp_f32 v68, v68
    v_exp_f32 v69, v69
    v_exp_f32 v70, v70
    v_exp_f32 v71, v71
    v_cvt_pk_bf16_f32 v80, v64, v65
    v_cvt_pk_bf16_f32 v81, v66, v67
    v_cvt_pk_bf16_f32 v82, v68, v69
    v_cvt_pk_bf16_f32 v83, v70, v71
    v_exp_f32 v72, v72
    v_exp_f32 v73, v73
    v_exp_f32 v74, v74
    v_exp_f32 v75, v75
    v_mfma_f32_32x32x16_bf16 v[88:103], v[40:43], v[80:83], v[88:103]
    v_exp_f32 v76, v76
    v_exp_f32 v77, v77
    v_exp_f32 v78, v78
    v_exp_f32 v79, v79
    v_cvt_pk_bf16_f32 v84, v72, v73
    v_cvt_pk_bf16_f32 v85, v74, v75
    v_cvt_pk_bf16_f32 v86, v76, v77
    v_cvt_pk_bf16_f32 v87, v78, v79
    s_cmp_ge_u32 s24, s25
    s_cbranch_scc1 .Lnodma_25
    s_mov_b32 m0, s24
    s_nop 0
    buffer_load_dwordx4 v6, s[12:15], s24 offen lds
    s_add_u32 s24, s24, 8192
.Lnodma_25:
    s_add_u32 s29, s29, 1
    s_add_u32 s30, s29, 1
    s_and_b32 s30, s30, 7
    s_mul_i32 s30, s30, 20480
    v_mov_b32 v104, v107
    v_add_u32 v107, s30, v110
    v_mov_b32 v105, v108
    v_add_u32 v108, s30, v111
    v_mov_b32 v106, v109
    v_add_u32 v109, s30, v112
    s_cmp_lt_u32 s29, 8
    s_cbranch_scc1 .Lloop_12
    v_mfma_f32_32x32x16_bf16 v[88:103], v[44:47], v[84:87], v[88:103]
    s_waitcnt lgkmcnt(0)
    s_nop 15
    s_nop 3
    s_mov_b32 s31, 0x71800000
    s_mov_b64 s[32:33], 0
    v_cmp_nlt_f32 s[34:35], |v88|, s31
    s_or_b64 s[32:33], s[32:33], s[34:35]
    v_cmp_nlt_f32 s[34:35], |v89|, s31
    s_or_b64 s[32:33], s[32:33], s[34:35]
    v_cmp_nlt_f32 s[34:35], |v90|, s31
    s_or_b64 s[32:33], s[32:33], s[34:35]
    v_cmp_nlt_f32 s[34:35], |v91|, s31
    s_or_b64 s[32:33], s[32:33], s[34:35]
    v_cmp_nlt_f32 s[34:35], |v92|, s31
    s_or_b64 s[32:33], s[32:33], s[34:35]
    v_cmp_nlt_f32 s[34:35], |v93|, s31
    s_or_b64 s[32:33], s[32:33], s[34:35]
    v_cmp_nlt_f32 s[34:35], |v94|, s31
    s_or_b64 s[32:33], s[32:33], s[34:35]
    v_cmp_nlt_f32 s[34:35], |v95|, s31
    s_or_b64 s[32:33], s[32:33], s[34:35]
    v_cmp_nlt_f32 s[34:35], |v96|, s31
    s_or_b64 s[32:33], s[32:33], s[34:35]
    v_cmp_nlt_f32 s[34:35], |v97|, s31
    s_or_b64 s[32:33], s[32:33], s[34:35]
    v_cmp_nlt_f32 s[34:35], |v98|, s31
    s_or_b64 s[32:33], s[32:33], s[34:35]
    s_cmp_eq_u64 s[32:33], 0
    s_cbranch_scc1 .Lepi_26
    s_cmp_eq_u32 s28, 0
    s_cbranch_scc1 .Lepi_26
    s_mov_b32 s28, 0
    s_waitcnt vmcnt(0)
    v_mov_b32 v13, 0
    v_mov_b32 v113, 0xff800000
    v_mov_b32 v104, v110
    v_mov_b32 v105, v111
    s_mov_b32 s29, 0
.Lfl_27:
    ds_read_b128 v[16:19], v104 offset:0
    ds_read_b64 v[24:25], v105 offset:0
    s_waitcnt lgkmcnt(0)
    v_mfma_f32_32x32x16_bf16 v[48:63], v[16:19], v[8:11], 0
    v_mfma_f32_32x32x16_bf16 v[48:63], v[24:27], v[12:15], v[48:63]
    s_nop 15
    v_max3_f32 v113, v113, v48, v49
    v_max3_f32 v113, v113, v50, v51
    v_max3_f32 v113, v113, v52, v53
    v_max3_f32 v113, v113, v54, v55
    v_max3_f32 v113, v113, v56, v57
    v_max3_f32 v113, v113, v58, v59
    v_max3_f32 v113, v113, v60, v61
    v_max3_f32 v113, v113, v62, v63
    ds_read_b128 v[16:19], v104 offset:1024
    ds_read_b64 v[24:25], v105 offset:256
    s_waitcnt lgkmcnt(0)
    v_mfma_f32_32x32x16_bf16 v[48:63], v[16:19], v[8:11], 0
    v_mfma_f32_32x32x16_bf16 v[48:63], v[24:27], v[12:15], v[48:63]
    s_nop 15
    v_max3_f32 v113, v113, v48, v49
    v_max3_f32 v113, v113, v50, v51
    v_max3_f32 v113, v113, v52, v53
    v_max3_f32 v113, v113, v54, v55
    v_max3_f32 v113, v113, v56, v57
    v_max3_f32 v113, v113, v58, v59
    v_max3_f32 v113, v113, v60, v61
    v_max3_f32 v113, v113, v62, v63
    ds_read_b128 v[16:19], v104 offset:2048
    ds_read_b64 v[24:25], v105 offset:512
    s_waitcnt lgkmcnt(0)
    v_mfma_f32_32x32x16_bf16 v[48:63], v[16:19], v[8:11], 0
    v_mfma_f32_32x32x16_bf16 v[48:63], v[24:27], v[12:15], v[48:63]
    s_nop 15
    v_max3_f32 v113, v113, v48, v49
    v_max3_f32 v113, v113, v50, v51
    v_max3_f32 v113, v113, v52, v53
    v_max3_f32 v113, v113, v54, v55
    v_max3_f32 v113, v113, v56, v57
    v_max3_f32 v113, v113, v58, v59
    v_max3_f32 v113, v113, v60, v61
    v_max3_f32 v113, v113, v62, v63
    ds_read_b128 v[16:19], v104 offset:3072
    ds_read_b64 v[24:25], v105 offset:768
    s_waitcnt lgkmcnt(0)
    v_mfma_f32_32x32x16_bf16 v[48:63], v[16:19], v[8:11], 0
    v_mfma_f32_32x32x16_bf16 v[48:63], v[24:27], v[12:15], v[48:63]
    s_nop 15
    v_max3_f32 v113, v113, v48, v49
    v_max3_f32 v113, v113, v50, v51
    v_max3_f32 v113, v113, v52, v53
    v_max3_f32 v113, v113, v54, v55
    v_max3_f32 v113, v113, v56, v57
    v_max3_f32 v113, v113, v58, v59
    v_max3_f32 v113, v113, v60, v61
    v_max3_f32 v113, v113, v62, v63
    ds_read_b128 v[16:19], v104 offset:4096
    ds_read_b64 v[24:25], v105 offset:1024
    s_waitcnt lgkmcnt(0)
    v_mfma_f32_32x32x16_bf16 v[48:63], v[16:19], v[8:11], 0
    v_mfma_f32_32x32x16_bf16 v[48:63], v[24:27], v[12:15], v[48:63]
    s_nop 15
    v_max3_f32 v113, v113, v48, v49
    v_max3_f32 v113, v113, v50, v51
    v_max3_f32 v113, v113, v52, v53
    v_max3_f32 v113, v113, v54, v55
    v_max3_f32 v113, v113, v56, v57
    v_max3_f32 v113, v113, v58, v59
    v_max3_f32 v113, v113, v60, v61
    v_max3_f32 v113, v113, v62, v63
    ds_read_b128 v[16:19], v104 offset:5120
    ds_read_b64 v[24:25], v105 offset:1280
    s_waitcnt lgkmcnt(0)
    v_mfma_f32_32x32x16_bf16 v[48:63], v[16:19], v[8:11], 0
    v_mfma_f32_32x32x16_bf16 v[48:63], v[24:27], v[12:15], v[48:63]
    s_nop 15
    v_max3_f32 v113, v113, v48, v49
    v_max3_f32 v113, v113, v50, v51
    v_max3_f32 v113, v113, v52, v53
    v_max3_f32 v113, v113, v54, v55
    v_max3_f32 v113, v113, v56, v57
    v_max3_f32 v113, v113, v58, v59
    v_max3_f32 v113, v113, v60, v61
    v_max3_f32 v113, v113, v62, v63
    ds_read_b128 v[16:19], v104 offset:6144
    ds_read_b64 v[24:25], v105 offset:1536
    s_waitcnt lgkmcnt(0)
    v_mfma_f32_32x32x16_bf16 v[48:63], v[16:19], v[8:11], 0
    v_mfma_f32_32x32x16_bf16 v[48:63], v[24:27], v[12:15], v[48:63]
    s_nop 15
    v_max3_f32 v113, v113, v48, v49
    v_max3_f32 v113, v113, v50, v51
    v_max3_f32 v113, v113, v52, v53
    v_max3_f32 v113, v113, v54, v55
    v_max3_f32 v113, v113, v56, v57
    v_max3_f32 v113, v113, v58, v59
    v_max3_f32 v113, v113, v60, v61
    v_max3_f32 v113, v113, v62, v63
    ds_read_b128 v[16:19], v104 offset:7168
    ds_read_b64 v[24:25], v105 offset:1792
    s_waitcnt lgkmcnt(0)
    v_mfma_f32_32x32x16_bf16 v[48:63], v[16:19], v[8:11], 0
    v_mfma_f32_32x32x16_bf16 v[48:63], v[24:27], v[12:15], v[48:63]
    s_nop 15
    v_max3_f32 v113, v113, v48, v49
    v_max3_f32 v113, v113, v50, v51
    v_max3_f32 v113, v113, v52, v53
    v_max3_f32 v113, v113, v54, v55
    v_max3_f32 v113, v113, v56, v57
    v_max3_f32 v113, v113, v58, v59
    v_max3_f32 v113, v113, v60, v61
    v_max3_f32 v113, v113, v62, v63
    v_add_u32 v104, 20480, v104
    v_add_u32 v105, 20480, v105
    s_add_u32 s29, s29, 1
    s_cmp_lt_u32 s29, 8
    s_cbranch_scc1 .Lfl_27
    s_branch .Lsetm_11
.Lepi_26:
    v_mov_b32 v113, v98
    v_mov_b32 v114, v98
    s_nop 1
    v_permlane32_swap_b32 v113, v114
    v_rcp_f32 v113, v113
    s_nop 0
    v_mul_f32 v88, v88, v113
    v_mul_f32 v89, v89, v113
    v_mul_f32 v90, v90, v113
    v_mul_f32 v91, v91, v113
    v_mul_f32 v92, v92, v113
    v_mul_f32 v93, v93, v113
    v_mul_f32 v94, v94, v113
    v_mul_f32 v95, v95, v113
    v_mul_f32 v96, v96, v113
    v_mul_f32 v97, v97, v113
    v_cvt_pk_bf16_f32 v80, v88, v89
    v_cvt_pk_bf16_f32 v81, v90, v91
    v_cvt_pk_bf16_f32 v82, v92, v93
    v_cvt_pk_bf16_f32 v83, v94, v95
    v_cvt_pk_bf16_f32 v84, v96, v97
    s_lshr_b32 s22, s21, 4
    s_mul_i32 s22, s22, 18432
    s_and_b32 s23, s21, 15
    s_lshl_b32 s23, s23, 4
    s_add_u32 s22, s22, s23
    v_mul_u32_u24 v4, 18, v2
    v_lshl_add_u32 v4, v3, 2, v4
    v_add_u32 v5, 0, v4
    v_lshrrev_b32 v6, 3, v5
    v_and_b32 v5, 7, v5
    v_lshlrev_b32 v5, 1, v5
    v_lshl_add_u32 v5, v6, 8, v5
    buffer_store_dword v80, v5, s[16:19], s22 offen
    v_add_u32 v5, 2, v4
    v_lshrrev_b32 v6, 3, v5
    v_and_b32 v5, 7, v5
    v_lshlrev_b32 v5, 1, v5
    v_lshl_add_u32 v5, v6, 8, v5
    buffer_store_dword v81, v5, s[16:19], s22 offen
    v_add_u32 v5, 8, v4
    v_lshrrev_b32 v6, 3, v5
    v_and_b32 v5, 7, v5
    v_lshlrev_b32 v5, 1, v5
    v_lshl_add_u32 v5, v6, 8, v5
    buffer_store_dword v82, v5, s[16:19], s22 offen
    v_add_u32 v5, 10, v4
    v_lshrrev_b32 v6, 3, v5
    v_and_b32 v5, 7, v5
    v_lshlrev_b32 v5, 1, v5
    v_lshl_add_u32 v5, v6, 8, v5
    buffer_store_dword v83, v5, s[16:19], s22 offen
    v_add_u32 v5, 16, v4
    v_lshrrev_b32 v6, 3, v5
    v_and_b32 v5, 7, v5
    v_lshlrev_b32 v5, 1, v5
    v_lshl_add_u32 v5, v6, 8, v5
    s_and_b64 exec, exec, s[26:27]
    buffer_store_dword v84, v5, s[16:19], s22 offen
    s_mov_b64 exec, -1
    s_waitcnt vmcnt(5)
    s_mov_b32 s8, s4
    s_mov_b32 s9, s5
    s_mov_b32 s10, 0x1400000
    s_mov_b32 s11, 0x00020000
    v_lshlrev_b32 v6, 4, v1
    v_lshl_or_b32 v48, v121, 16, v120
    v_lshl_or_b32 v49, v123, 16, v122
    v_lshl_or_b32 v50, v125, 16, v124
    v_lshl_or_b32 v51, v127, 16, v126
    buffer_store_dwordx4 v[48:51], v6, s[8:11], s81 offen
    v_lshl_or_b32 v52, v129, 16, v128
    v_lshl_or_b32 v53, v131, 16, v130
    v_lshl_or_b32 v54, v133, 16, v132
    v_lshl_or_b32 v55, v135, 16, v134
    buffer_store_dwordx4 v[52:55], v6, s[8:11], s93 offen
.Lend_4:
    s_endpgm
.section .rodata,"a"
.p2align 6
.amdhsa_kernel attng_kernel
  .amdhsa_next_free_vgpr 136
  .amdhsa_next_free_sgpr 100
  .amdhsa_accum_offset 136
  .amdhsa_group_segment_fixed_size 0
  .amdhsa_kernarg_size 88
  .amdhsa_user_sgpr_count 2
  .amdhsa_user_sgpr_kernarg_segment_ptr 1
  .amdhsa_system_sgpr_workgroup_id_x 1
.end_amdhsa_kernel
.text
.globl outa1_kernel
.p2align 8
.type outa1_kernel,@function
outa1_kernel:
    s_cmp_ge_u32 s2, 199
    s_cbranch_scc1 .Lend_28
    s_cmp_ge_u32 s2, 192
    s_cbranch_scc1 .Lcsentry_29
    s_load_dwordx2 s[8:9], s[0:1], 0
    s_load_dwordx2 s[4:5], s[0:1], 80
    s_lshr_b32 s28, s2, 3
    s_mul_i32 s3, s28, 43691
    s_lshr_b32 s3, s3, 18
    s_mul_i32 s29, s3, 6
    s_sub_u32 s28, s28, s29
    s_and_b32 s29, s2, 7
    s_lshl_b32 s29, s29, 2
    s_add_u32 s3, s3, s29
    v_and_b32 v1, 63, v0
    v_lshrrev_b32 v11, 6, v0
    s_nop 0
    v_readfirstlane_b32 s29, v11
    v_and_b32 v12, 15, v1
    v_lshrrev_b32 v13, 4, v1
    v_lshlrev_b32 v4, 4, v1
    s_lshl_b32 s30, s3, 2
    s_add_u32 s30, s30, s29
    s_mul_i32 s31, s30, 18432
    v_add_u32 v2, s31, v4
    s_mov_b32 s41, 4096
    s_mov_b32 s42, 8192
    s_mov_b32 s43, 12288
    s_mov_b32 s44, 16384
    s_mov_b32 s40, 0
    s_waitcnt lgkmcnt(0)
    s_add_u32 s12, s4, 0x900000
    s_addc_u32 s13, s5, 0
    s_mov_b32 s14, 0x240000
    s_mov_b32 s15, 0x00020000
    s_lshl_b32 s34, s29, 10
    s_add_u32 s16, s4, 0x10a2000
    s_addc_u32 s17, s5, 0
    s_mov_b32 s18, 0xa2000
    s_mov_b32 s19, 0x00020000
    s_mul_i32 s33, s28, 110592
    s_add_u32 s33, s33, s34
    buffer_load_dwordx4 v[16:19], v2, s[12:15], s40 offen offset:0
    buffer_load_dwordx4 v[20:23], v2, s[12:15], s40 offen offset:1024
    s_add_u32 m0, s34, 0
    s_add_u32 s35, s33, 0
    buffer_load_dwordx4 v4, s[16:19], s35 offen lds
    s_add_u32 m0, s34, 4096
    s_add_u32 s35, s33, 4096
    buffer_load_dwordx4 v4, s[16:19], s35 offen lds
    s_add_u32 m0, s34, 8192
    s_add_u32 s35, s33, 8192
    buffer_load_dwordx4 v4, s[16:19], s35 offen lds
    buffer_load_dwordx4 v[24:27], v2, s[12:15], s40 offen offset:2048
    buffer_load_dwordx4 v[28:31], v2, s[12:15], s40 offen offset:3072
    s_add_u32 m0, s34, 12288
    s_add_u32 s35, s33, 12288
    buffer_load_dwordx4 v4, s[16:19], s35 offen lds
    s_add_u32 m0, s34, 16384
    s_add_u32 s35, s33, 16384
    buffer_load_dwordx4 v4, s[16:19], s35 offen lds
    s_add_u32 m0, s34, 20480
    s_add_u32 s35, s33, 20480
    buffer_load_dwordx4 v4, s[16:19], s35 offen lds
    buffer_load_dwordx4 v[32:35], v2, s[12:15], s41 offen offset:0
    buffer_load_dwordx4 v[36:39], v2, s[12:15], s41 offen offset:1024
    s_add_u32 m0, s34, 24576
    s_add_u32 s35, s33, 24576
    buffer_load_dwordx4 v4, s[16:19], s35 offen lds
    s_add_u32 m0, s34, 28672
    s_add_u32 s35, s33, 28672
    buffer_load_dwordx4 v4, s[16:19], s35 offen lds
    s_add_u32 m0, s34, 32768
    s_add_u32 s35, s33, 32768
    buffer_load_dwordx4 v4, s[16:19], s35 offen lds
    v_add_u32 v5, 55296, v4
    v_mov_b32 v136, 0
    v_mov_b32 v137, 0
    v_mov_b32 v138, 0
    v_mov_b32 v139, 0
    v_mov_b32 v140, 0
    v_mov_b32 v141, 0
    v_mov_b32 v142, 0
    v_mov_b32 v143, 0
    v_mov_b32 v144, 0
    v_mov_b32 v145, 0
    v_mov_b32 v146, 0
    v_mov_b32 v147, 0
    v_mov_b32 v148, 0
    v_mov_b32 v149, 0
    v_mov_b32 v150, 0
    v_mov_b32 v151, 0
    v_mov_b32 v152, 0
    v_mov_b32 v153, 0
    v_mov_b32 v154, 0
    v_mov_b32 v155, 0
    v_mov_b32 v156, 0
    v_mov_b32 v157, 0
    v_mov_b32 v158, 0
    v_mov_b32 v159, 0
    s_waitcnt vmcnt(10)
    s_barrier
    ds_read_b128 v[88:91], v4 offset:0
    ds_read_b128 v[92:95], v4 offset:1024
    ds_read_b128 v[96:99], v4 offset:2048
    ds_read_b128 v[100:103], v4 offset:3072
    ds_read_b128 v[104:107], v4 offset:4096
    ds_read_b128 v[108:111], v4 offset:5120
    ds_read_b128 v[112:115], v4 offset:6144
    ds_read_b128 v[116:119], v4 offset:7168
    ds_read_b128 v[120:123], v4 offset:8192
    ds_read_b128 v[124:127], v4 offset:9216
    ds_read_b128 v[128:131], v4 offset:10240
    ds_read_b128 v[132:135], v4 offset:11264
    buffer_load_dwordx4 v[40:43], v2, s[12:15], s41 offen offset:2048
    buffer_load_dwordx4 v[44:47], v2, s[12:15], s41 offen offset:3072
    s_add_u32 m0, s34, 36864
    s_add_u32 s35, s33, 36864
    buffer_load_dwordx4 v4, s[16:19], s35 offen lds
    s_add_u32 m0, s34, 40960
    s_add_u32 s35, s33, 40960
    buffer_load_dwordx4 v4, s[16:19], s35 offen lds
    s_add_u32 m0, s34, 45056
    s_add_u32 s35, s33, 45056
    buffer_load_dwordx4 v4, s[16:19], s35 offen lds
    s_waitcnt lgkmcnt(6)
    v_mfma_f32_16x16x32_bf16 v[136:139], v[88:91], v[16:19], v[136:139]
    v_mfma_f32_16x16x32_bf16 v[140:143], v[92:95], v[16:19], v[140:143]
    v_mfma_f32_16x16x32_bf16 v[144:147], v[96:99], v[16:19], v[144:147]
    v_mfma_f32_16x16x32_bf16 v[148:151], v[100:103], v[16:19], v[148:151]
    v_mfma_f32_16x16x32_bf16 v[152:155], v[104:107], v[16:19], v[152:155]
    v_mfma_f32_16x16x32_bf16 v[156:159], v[108:111], v[16:19], v[156:159]
    s_waitcnt lgkmcnt(0)
    s_waitcnt vmcnt(10)
    s_barrier
    ds_read_b128 v[88:91], v4 offset:12288
    ds_read_b128 v[92:95], v4 offset:13312
    ds_read_b128 v[96:99], v4 offset:14336
    ds_read_b128 v[100:103], v4 offset:15360
    ds_read_b128 v[104:107], v4 offset:16384
    ds_read_b128 v[108:111], v4 offset:17408
    v_mfma_f32_16x16x32_bf16 v[136:139], v[112:115], v[20:23], v[136:139]
    v_mfma_f32_16x16x32_bf16 v[140:143], v[116:119], v[20:23], v[140:143]
    v_mfma_f32_16x16x32_bf16 v[144:147], v[120:123], v[20:23], v[144:147]
    v_mfma_f32_16x16x32_bf16 v[148:151], v[124:127], v[20:23], v[148:151]
    v_mfma_f32_16x16x32_bf16 v[152:155], v[128:131], v[20:23], v[152:155]
    v_mfma_f32_16x16x32_bf16 v[156:159], v[132:135], v[20:23], v[156:159]
    ds_read_b128 v[112:115], v4 offset:18432
    ds_read_b128 v[116:119], v4 offset:19456
    ds_read_b128 v[120:123], v4 offset:20480
    ds_read_b128 v[124:127], v4 offset:21504
    ds_read_b128 v[128:131], v4 offset:22528
    ds_read_b128 v[132:135], v4 offset:23552
    buffer_load_dwordx4 v[48:51], v2, s[12:15], s42 offen offset:0
    buffer_load_dwordx4 v[52:55], v2, s[12:15], s42 offen offset:1024
    s_add_u32 m0, s34, 49152
    s_add_u32 s35, s33, 49152
    buffer_load_dwordx4 v4, s[16:19], s35 offen lds
    s_add_u32 m0, s34, 53248
    s_add_u32 s35, s33, 53248
    buffer_load_dwordx4 v4, s[16:19], s35 offen lds
    s_add_u32 m0, s34, 57344
    s_add_u32 s35, s33, 57344
    buffer_load_dwordx4 v4, s[16:19], s35 offen lds
    s_waitcnt lgkmcnt(6)
    v_mfma_f32_16x16x32_bf16 v[136:139], v[88:91], v[24:27], v[136:139]
    v_mfma_f32_16x16x32_bf16 v[140:143], v[92:95], v[24:27], v[140:143]
    v_mfma_f32_16x16x32_bf16 v[144:147], v[96:99], v[24:27], v[144:147]
    v_mfma_f32_16x16x32_bf16 v[148:151], v[100:103], v[24:27], v[148:151]
    v_mfma_f32_16x16x32_bf16 v[152:155], v[104:107], v[24:27], v[152:155]
    v_mfma_f32_16x16x32_bf16 v[156:159], v[108:111], v[24:27], v[156:159]
    s_waitcnt lgkmcnt(0)
    s_waitcnt vmcnt(10)
    s_barrier
    ds_read_b128 v[88:91], v4 offset:24576
    ds_read_b128 v[92:95], v4 offset:25600
    ds_read_b128 v[96:99], v4 offset:26624
    ds_read_b128 v[100:103], v4 offset:27648
    ds_read_b128 v[104:107], v4 offset:28672
    ds_read_b128 v[108:111], v4 offset:29696
    v_mfma_f32_16x16x32_bf16 v[136:139], v[112:115], v[28:31], v[136:139]
    v_mfma_f32_16x16x32_bf16 v[140:143], v[116:119], v[28:31], v[140:143]
    v_mfma_f32_16x16x32_bf16 v[144:147], v[120:123], v[28:31], v[144:147]
    v_mfma_f32_16x16x32_bf16 v[148:151], v[124:127], v[28:31], v[148:151]
    v_mfma_f32_16x16x32_bf16 v[152:155], v[128:131], v[28:31], v[152:155]
    v_mfma_f32_16x16x32_bf16 v[156:159], v[132:135], v[28:31], v[156:159]
    ds_read_b128 v[112:115], v4 offset:30720
    ds_read_b128 v[116:119], v4 offset:31744
    ds_read_b128 v[120:123], v4 offset:32768
    ds_read_b128 v[124:127], v4 offset:33792
    ds_read_b128 v[128:131], v4 offset:34816
    ds_read_b128 v[132:135], v4 offset:35840
    buffer_load_dwordx4 v[56:59], v2, s[12:15], s42 offen offset:2048
    buffer_load_dwordx4 v[60:63], v2, s[12:15], s42 offen offset:3072
    s_add_u32 m0, s34, 61440
    s_add_u32 s35, s33, 61440
    buffer_load_dwordx4 v4, s[16:19], s35 offen lds
    s_add_u32 m0, s34, 65536
    s_add_u32 s35, s33, 65536
    buffer_load_dwordx4 v4, s[16:19], s35 offen lds
    s_add_u32 m0, s34, 69632
    s_add_u32 s35, s33, 69632
    buffer_load_dwordx4 v4, s[16:19], s35 offen lds
    s_waitcnt lgkmcnt(6)
    v_mfma_f32_16x16x32_bf16 v[136:139], v[88:91], v[32:35], v[136:139]
    v_mfma_f32_16x16x32_bf16 v[140:143], v[92:95], v[32:35], v[140:143]
    v_mfma_f32_16x16x32_bf16 v[144:147], v[96:99], v[32:35], v[144:147]
    v_mfma_f32_16x16x32_bf16 v[148:151], v[100:103], v[32:35], v[148:151]
    v_mfma_f32_16x16x32_bf16 v[152:155], v[104:107], v[32:35], v[152:155]
    v_mfma_f32_16x16x32_bf16 v[156:159], v[108:111], v[32:35], v[156:159]
    s_waitcnt lgkmcnt(0)
    s_waitcnt vmcnt(10)
    s_barrier
    ds_read_b128 v[88:91], v4 offset:36864
    ds_read_b128 v[92:95], v4 offset:37888
    ds_read_b128 v[96:99], v4 offset:38912
    ds_read_b128 v[100:103], v4 offset:39936
    ds_read_b128 v[104:107], v4 offset:40960
    ds_read_b128 v[108:111], v4 offset:41984
    v_mfma_f32_16x16x32_bf16 v[136:139], v[112:115], v[36:39], v[136:139]
    v_mfma_f32_16x16x32_bf16 v[140:143], v[116:119], v[36:39], v[140:143]
    v_mfma_f32_16x16x32_bf16 v[144:147], v[120:123], v[36:39], v[144:147]
    v_mfma_f32_16x16x32_bf16 v[148:151], v[124:127], v[36:39], v[148:151]
    v_mfma_f32_16x16x32_bf16 v[152:155], v[128:131], v[36:39], v[152:155]
    v_mfma_f32_16x16x32_bf16 v[156:159], v[132:135], v[36:39], v[156:159]
    ds_read_b128 v[112:115], v4 offset:43008
    ds_read_b128 v[116:119], v4 offset:44032
    ds_read_b128 v[120:123], v4 offset:45056
    ds_read_b128 v[124:127], v4 offset:46080
    ds_read_b128 v[128:131], v4 offset:47104
    ds_read_b128 v[132:135], v4 offset:48128
    buffer_load_dwordx4 v[64:67], v2, s[12:15], s43 offen offset:0
    buffer_load_dwordx4 v[68:71], v2, s[12:15], s43 offen offset:1024
    s_add_u32 m0, s34, 73728
    s_add_u32 s35, s33, 73728
    buffer_load_dwordx4 v4, s[16:19], s35 offen lds
    s_add_u32 m0, s34, 77824
    s_add_u32 s35, s33, 77824
    buffer_load_dwordx4 v4, s[16:19], s35 offen lds
    s_add_u32 m0, s34, 81920
    s_add_u32 s35, s33, 81920
    buffer_load_dwordx4 v4, s[16:19], s35 offen lds
    s_waitcnt lgkmcnt(6)
    v_mfma_f32_16x16x32_bf16 v[136:139], v[88:91], v[40:43], v[136:139]
    v_mfma_f32_16x16x32_bf16 v[140:143], v[92:95], v[40:43], v[140:143]
    v_mfma_f32_16x16x32_bf16 v[144:147], v[96:99], v[40:43], v[144:147]
    v_mfma_f32_16x16x32_bf16 v[148:151], v[100:103], v[40:43], v[148:151]
    v_mfma_f32_16x16x32_bf16 v[152:155], v[104:107], v[40:43], v[152:155]
    v_mfma_f32_16x16x32_bf16 v[156:159], v[108:111], v[40:43], v[156:159]
    s_waitcnt lgkmcnt(0)
    s_waitcnt vmcnt(10)
    s_barrier
    ds_read_b128 v[88:91], v4 offset:49152
    ds_read_b128 v[92:95], v4 offset:50176
    ds_read_b128 v[96:99], v4 offset:51200
    ds_read_b128 v[100:103], v4 offset:52224
    ds_read_b128 v[104:107], v4 offset:53248
    ds_read_b128 v[108:111], v4 offset:54272
    v_mfma_f32_16x16x32_bf16 v[136:139], v[112:115], v[44:47], v[136:139]
    v_mfma_f32_16x16x32_bf16 v[140:143], v[116:119], v[44:47], v[140:143]
    v_mfma_f32_16x16x32_bf16 v[144:147], v[120:123], v[44:47], v[144:147]
    v_mfma_f32_16x16x32_bf16 v[148:151], v[124:127], v[44:47], v[148:151]
    v_mfma_f32_16x16x32_bf16 v[152:155], v[128:131], v[44:47], v[152:155]
    v_mfma_f32_16x16x32_bf16 v[156:159], v[132:135], v[44:47], v[156:159]
    ds_read_b128 v[112:115], v5 offset:0
    ds_read_b128 v[116:119], v5 offset:1024
    ds_read_b128 v[120:123], v5 offset:2048
    ds_read_b128 v[124:127], v5 offset:3072
    ds_read_b128 v[128:131], v5 offset:4096
    ds_read_b128 v[132:135], v5 offset:5120
    buffer_load_dwordx4 v[72:75], v2, s[12:15], s43 offen offset:2048
    buffer_load_dwordx4 v[76:79], v2, s[12:15], s43 offen offset:3072
    s_add_u32 m0, s34, 86016
    s_add_u32 s35, s33, 86016
    buffer_load_dwordx4 v4, s[16:19], s35 offen lds
    s_add_u32 m0, s34, 90112
    s_add_u32 s35, s33, 90112
    buffer_load_dwordx4 v4, s[16:19], s35 offen lds
    s_add_u32 m0, s34, 94208
    s_add_u32 s35, s33, 94208
    buffer_load_dwordx4 v4, s[16:19], s35 offen lds
    s_waitcnt lgkmcnt(6)
    v_mfma_f32_16x16x32_bf16 v[136:139], v[88:91], v[48:51], v[136:139]
    v_mfma_f32_16x16x32_bf16 v[140:143], v[92:95], v[48:51], v[140:143]
    v_mfma_f32_16x16x32_bf16 v[144:147], v[96:99], v[48:51], v[144:147]
    v_mfma_f32_16x16x32_bf16 v[148:151], v[100:103], v[48:51], v[148:151]
    v_mfma_f32_16x16x32_bf16 v[152:155], v[104:107], v[48:51], v[152:155]
    v_mfma_f32_16x16x32_bf16 v[156:159], v[108:111], v[48:51], v[156:159]
    s_waitcnt lgkmcnt(0)
    s_waitcnt vmcnt(10)
    s_barrier
    ds_read_b128 v[88:91], v5 offset:6144
    ds_read_b128 v[92:95], v5 offset:7168
    ds_read_b128 v[96:99], v5 offset:8192
    ds_read_b128 v[100:103], v5 offset:9216
    ds_read_b128 v[104:107], v5 offset:10240
    ds_read_b128 v[108:111], v5 offset:11264
    v_mfma_f32_16x16x32_bf16 v[136:139], v[112:115], v[52:55], v[136:139]
    v_mfma_f32_16x16x32_bf16 v[140:143], v[116:119], v[52:55], v[140:143]
    v_mfma_f32_16x16x32_bf16 v[144:147], v[120:123], v[52:55], v[144:147]
    v_mfma_f32_16x16x32_bf16 v[148:151], v[124:127], v[52:55], v[148:151]
    v_mfma_f32_16x16x32_bf16 v[152:155], v[128:131], v[52:55], v[152:155]
    v_mfma_f32_16x16x32_bf16 v[156:159], v[132:135], v[52:55], v[156:159]
    ds_read_b128 v[112:115], v5 offset:12288
    ds_read_b128 v[116:119], v5 offset:13312
    ds_read_b128 v[120:123], v5 offset:14336
    ds_read_b128 v[124:127], v5 offset:15360
    ds_read_b128 v[128:131], v5 offset:16384
    ds_read_b128 v[132:135], v5 offset:17408
    buffer_load_dwordx4 v[80:83], v2, s[12:15], s44 offen offset:0
    buffer_load_dwordx4 v[84:87], v2, s[12:15], s44 offen offset:1024
    s_add_u32 m0, s34, 98304
    s_add_u32 s35, s33, 98304
    buffer_load_dwordx4 v4, s[16:19], s35 offen lds
    s_add_u32 m0, s34, 102400
    s_add_u32 s35, s33, 102400
    buffer_load_dwordx4 v4, s[16:19], s35 offen lds
    s_add_u32 m0, s34, 106496
    s_add_u32 s35, s33, 106496
    buffer_load_dwordx4 v4, s[16:19], s35 offen lds
    s_waitcnt lgkmcnt(6)
    v_mfma_f32_16x16x32_bf16 v[136:139], v[88:91], v[56:59], v[136:139]
    v_mfma_f32_16x16x32_bf16 v[140:143], v[92:95], v[56:59], v[140:143]
    v_mfma_f32_16x16x32_bf16 v[144:147], v[96:99], v[56:59], v[144:147]
    v_mfma_f32_16x16x32_bf16 v[148:151], v[100:103], v[56:59], v[148:151]
    v_mfma_f32_16x16x32_bf16 v[152:155], v[104:107], v[56:59], v[152:155]
    v_mfma_f32_16x16x32_bf16 v[156:159], v[108:111], v[56:59], v[156:159]
    s_waitcnt lgkmcnt(0)
    s_waitcnt vmcnt(10)
    s_barrier
    ds_read_b128 v[88:91], v5 offset:18432
    ds_read_b128 v[92:95], v5 offset:19456
    ds_read_b128 v[96:99], v5 offset:20480
    ds_read_b128 v[100:103], v5 offset:21504
    ds_read_b128 v[104:107], v5 offset:22528
    ds_read_b128 v[108:111], v5 offset:23552
    v_mfma_f32_16x16x32_bf16 v[136:139], v[112:115], v[60:63], v[136:139]
    v_mfma_f32_16x16x32_bf16 v[140:143], v[116:119], v[60:63], v[140:143]
    v_mfma_f32_16x16x32_bf16 v[144:147], v[120:123], v[60:63], v[144:147]
    v_mfma_f32_16x16x32_bf16 v[148:151], v[124:127], v[60:63], v[148:151]
    v_mfma_f32_16x16x32_bf16 v[152:155], v[128:131], v[60:63], v[152:155]
    v_mfma_f32_16x16x32_bf16 v[156:159], v[132:135], v[60:63], v[156:159]
    ds_read_b128 v[112:115], v5 offset:24576
    ds_read_b128 v[116:119], v5 offset:25600
    ds_read_b128 v[120:123], v5 offset:26624
    ds_read_b128 v[124:127], v5 offset:27648
    ds_read_b128 v[128:131], v5 offset:28672
    ds_read_b128 v[132:135], v5 offset:29696
    v_lshrrev_b32 v3, 1, v13
    v_lshlrev_b32 v3, 8, v3
    v_lshl_add_u32 v3, v12, 4, v3
    v_and_b32 v11, 1, v13
    v_lshl_add_u32 v3, v11, 3, v3
    s_mul_i32 s36, s28, 3072
    s_add_u32 s36, s36, s31
    v_add_u32 v3, s36, v3
    s_mov_b32 s20, s8
    s_mov_b32 s21, s9
    s_mov_b32 s22, 0x240000
    s_mov_b32 s23, 0x00020000
    s_lshl_b32 s36, s30, 4
    v_add_u32 v6, s36, v12
    v_mul_u32_u24 v6, 1152, v6
    v_lshl_add_u32 v6, v13, 3, v6
    s_mul_i32 s36, s28, 192
    v_add_u32 v6, s36, v6
    buffer_load_dwordx2 v[160:161], v6, s[20:23], 0 offen offset:0
    buffer_load_dwordx2 v[162:163], v6, s[20:23], 0 offen offset:32
    buffer_load_dwordx2 v[164:165], v6, s[20:23], 0 offen offset:64
    buffer_load_dwordx2 v[166:167], v6, s[20:23], 0 offen offset:96
    buffer_load_dwordx2 v[168:169], v6, s[20:23], 0 offen offset:128
    buffer_load_dwordx2 v[170:171], v6, s[20:23], 0 offen offset:160
    s_waitcnt lgkmcnt(6)
    v_mfma_f32_16x16x32_bf16 v[136:139], v[88:91], v[64:67], v[136:139]
    v_mfma_f32_16x16x32_bf16 v[140:143], v[92:95], v[64:67], v[140:143]
    v_mfma_f32_16x16x32_bf16 v[144:147], v[96:99], v[64:67], v[144:147]
    v_mfma_f32_16x16x32_bf16 v[148:151], v[100:103], v[64:67], v[148:151]
    v_mfma_f32_16x16x32_bf16 v[152:155], v[104:107], v[64:67], v[152:155]
    v_mfma_f32_16x16x32_bf16 v[156:159], v[108:111], v[64:67], v[156:159]
    s_waitcnt lgkmcnt(0)
    s_waitcnt vmcnt(11)
    s_barrier
    ds_read_b128 v[88:91], v5 offset:30720
    ds_read_b128 v[92:95], v5 offset:31744
    ds_read_b128 v[96:99], v5 offset:32768
    ds_read_b128 v[100:103], v5 offset:33792
    ds_read_b128 v[104:107], v5 offset:34816
    ds_read_b128 v[108:111], v5 offset:35840
    v_mfma_f32_16x16x32_bf16 v[136:139], v[112:115], v[68:71], v[136:139]
    v_mfma_f32_16x16x32_bf16 v[140:143], v[116:119], v[68:71], v[140:143]
    v_mfma_f32_16x16x32_bf16 v[144:147], v[120:123], v[68:71], v[144:147]
    v_mfma_f32_16x16x32_bf16 v[148:151], v[124:127], v[68:71], v[148:151]
    v_mfma_f32_16x16x32_bf16 v[152:155], v[128:131], v[68:71], v[152:155]
    v_mfma_f32_16x16x32_bf16 v[156:159], v[132:135], v[68:71], v[156:159]
    ds_read_b128 v[112:115], v5 offset:36864
    ds_read_b128 v[116:119], v5 offset:37888
    ds_read_b128 v[120:123], v5 offset:38912
    ds_read_b128 v[124:127], v5 offset:39936
    ds_read_b128 v[128:131], v5 offset:40960
    ds_read_b128 v[132:135], v5 offset:41984
    s_waitcnt lgkmcnt(6)
    v_mfma_f32_16x16x32_bf16 v[136:139], v[88:91], v[72:75], v[136:139]
    v_mfma_f32_16x16x32_bf16 v[140:143], v[92:95], v[72:75], v[140:143]
    v_mfma_f32_16x16x32_bf16 v[144:147], v[96:99], v[72:75], v[144:147]
    v_mfma_f32_16x16x32_bf16 v[148:151], v[100:103], v[72:75], v[148:151]
    v_mfma_f32_16x16x32_bf16 v[152:155], v[104:107], v[72:75], v[152:155]
    v_mfma_f32_16x16x32_bf16 v[156:159], v[108:111], v[72:75], v[156:159]
    s_waitcnt lgkmcnt(0)
    s_waitcnt vmcnt(6)
    s_barrier
    ds_read_b128 v[88:91], v5 offset:43008
    ds_read_b128 v[92:95], v5 offset:44032
    ds_read_b128 v[96:99], v5 offset:45056
    ds_read_b128 v[100:103], v5 offset:46080
    ds_read_b128 v[104:107], v5 offset:47104
    ds_read_b128 v[108:111], v5 offset:48128
    v_mfma_f32_16x16x32_bf16 v[136:139], v[112:115], v[76:79], v[136:139]
    v_mfma_f32_16x16x32_bf16 v[140:143], v[116:119], v[76:79], v[140:143]
    v_mfma_f32_16x16x32_bf16 v[144:147], v[120:123], v[76:79], v[144:147]
    v_mfma_f32_16x16x32_bf16 v[148:151], v[124:127], v[76:79], v[148:151]
    v_mfma_f32_16x16x32_bf16 v[152:155], v[128:131], v[76:79], v[152:155]
    v_mfma_f32_16x16x32_bf16 v[156:159], v[132:135], v[76:79], v[156:159]
    ds_read_b128 v[112:115], v5 offset:49152
    ds_read_b128 v[116:119], v5 offset:50176
    ds_read_b128 v[120:123], v5 offset:51200
    ds_read_b128 v[124:127], v5 offset:52224
    ds_read_b128 v[128:131], v5 offset:53248
    ds_read_b128 v[132:135], v5 offset:54272
    s_waitcnt lgkmcnt(6)
    v_mfma_f32_16x16x32_bf16 v[136:139], v[88:91], v[80:83], v[136:139]
    v_mfma_f32_16x16x32_bf16 v[140:143], v[92:95], v[80:83], v[140:143]
    v_mfma_f32_16x16x32_bf16 v[144:147], v[96:99], v[80:83], v[144:147]
    v_mfma_f32_16x16x32_bf16 v[148:151], v[100:103], v[80:83], v[148:151]
    v_mfma_f32_16x16x32_bf16 v[152:155], v[104:107], v[80:83], v[152:155]
    v_mfma_f32_16x16x32_bf16 v[156:159], v[108:111], v[80:83], v[156:159]
    s_waitcnt lgkmcnt(0)
    v_mfma_f32_16x16x32_bf16 v[136:139], v[112:115], v[84:87], v[136:139]
    v_mfma_f32_16x16x32_bf16 v[140:143], v[116:119], v[84:87], v[140:143]
    v_mfma_f32_16x16x32_bf16 v[144:147], v[120:123], v[84:87], v[144:147]
    v_mfma_f32_16x16x32_bf16 v[148:151], v[124:127], v[84:87], v[148:151]
    v_mfma_f32_16x16x32_bf16 v[152:155], v[128:131], v[84:87], v[152:155]
    v_mfma_f32_16x16x32_bf16 v[156:159], v[132:135], v[84:87], v[156:159]
    s_nop 7
    s_mov_b32 s24, s4
    s_mov_b32 s25, s5
    s_mov_b32 s26, 0x240000
    s_mov_b32 s27, 0x00020000
    s_mov_b32 s36, 0xffff0000
    s_waitcnt vmcnt(0)
    v_cvt_pk_bf16_f32 v136, v136, v137
    v_cvt_pk_bf16_f32 v137, v138, v139
    v_lshlrev_b32 v11, 16, v136
    v_and_b32 v15, s36, v136
    v_lshlrev_b32 v138, 16, v160
    v_and_b32 v139, s36, v160
    v_add_f32 v11, v11, v138
    v_add_f32 v15, v15, v139
    v_cvt_pk_bf16_f32 v160, v11, v15
    v_lshlrev_b32 v11, 16, v137
    v_and_b32 v15, s36, v137
    v_lshlrev_b32 v138, 16, v161
    v_and_b32 v139, s36, v161
    v_add_f32 v11, v11, v138
    v_add_f32 v15, v15, v139
    v_cvt_pk_bf16_f32 v161, v11, v15
    buffer_store_dwordx2 v[160:161], v3, s[24:27], 0 offen offset:0
    v_cvt_pk_bf16_f32 v140, v140, v141
    v_cvt_pk_bf16_f32 v141, v142, v143
    v_lshlrev_b32 v11, 16, v140
    v_and_b32 v15, s36, v140
    v_lshlrev_b32 v142, 16, v162
    v_and_b32 v143, s36, v162
    v_add_f32 v11, v11, v142
    v_add_f32 v15, v15, v143
    v_cvt_pk_bf16_f32 v162, v11, v15
    v_lshlrev_b32 v11, 16, v141
    v_and_b32 v15, s36, v141
    v_lshlrev_b32 v142, 16, v163
    v_and_b32 v143, s36, v163
    v_add_f32 v11, v11, v142
    v_add_f32 v15, v15, v143
    v_cvt_pk_bf16_f32 v163, v11, v15
    buffer_store_dwordx2 v[162:163], v3, s[24:27], 0 offen offset:512
    v_cvt_pk_bf16_f32 v144, v144, v145
    v_cvt_pk_bf16_f32 v145, v146, v147
    v_lshlrev_b32 v11, 16, v144
    v_and_b32 v15, s36, v144
    v_lshlrev_b32 v146, 16, v164
    v_and_b32 v147, s36, v164
    v_add_f32 v11, v11, v146
    v_add_f32 v15, v15, v147
    v_cvt_pk_bf16_f32 v164, v11, v15
    v_lshlrev_b32 v11, 16, v145
    v_and_b32 v15, s36, v145
    v_lshlrev_b32 v146, 16, v165
    v_and_b32 v147, s36, v165
    v_add_f32 v11, v11, v146
    v_add_f32 v15, v15, v147
    v_cvt_pk_bf16_f32 v165, v11, v15
    buffer_store_dwordx2 v[164:165], v3, s[24:27], 0 offen offset:1024
    v_cvt_pk_bf16_f32 v148, v148, v149
    v_cvt_pk_bf16_f32 v149, v150, v151
    v_lshlrev_b32 v11, 16, v148
    v_and_b32 v15, s36, v148
    v_lshlrev_b32 v150, 16, v166
    v_and_b32 v151, s36, v166
    v_add_f32 v11, v11, v150
    v_add_f32 v15, v15, v151
    v_cvt_pk_bf16_f32 v166, v11, v15
    v_lshlrev_b32 v11, 16, v149
    v_and_b32 v15, s36, v149
    v_lshlrev_b32 v150, 16, v167
    v_and_b32 v151, s36, v167
    v_add_f32 v11, v11, v150
    v_add_f32 v15, v15, v151
    v_cvt_pk_bf16_f32 v167, v11, v15
    buffer_store_dwordx2 v[166:167], v3, s[24:27], 0 offen offset:1536
    v_cvt_pk_bf16_f32 v152, v152, v153
    v_cvt_pk_bf16_f32 v153, v154, v155
    v_lshlrev_b32 v11, 16, v152
    v_and_b32 v15, s36, v152
    v_lshlrev_b32 v154, 16, v168
    v_and_b32 v155, s36, v168
    v_add_f32 v11, v11, v154
    v_add_f32 v15, v15, v155
    v_cvt_pk_bf16_f32 v168, v11, v15
    v_lshlrev_b32 v11, 16, v153
    v_and_b32 v15, s36, v153
    v_lshlrev_b32 v154, 16, v169
    v_and_b32 v155, s36, v169
    v_add_f32 v11, v11, v154
    v_add_f32 v15, v15, v155
    v_cvt_pk_bf16_f32 v169, v11, v15
    buffer_store_dwordx2 v[168:169], v3, s[24:27], 0 offen offset:2048
    v_cvt_pk_bf16_f32 v156, v156, v157
    v_cvt_pk_bf16_f32 v157, v158, v159
    v_lshlrev_b32 v11, 16, v156
    v_and_b32 v15, s36, v156
    v_lshlrev_b32 v158, 16, v170
    v_and_b32 v159, s36, v170
    v_add_f32 v11, v11, v158
    v_add_f32 v15, v15, v159
    v_cvt_pk_bf16_f32 v170, v11, v15
    v_lshlrev_b32 v11, 16, v157
    v_and_b32 v15, s36, v157
    v_lshlrev_b32 v158, 16, v171
    v_and_b32 v159, s36, v171
    v_add_f32 v11, v11, v158
    v_add_f32 v15, v15, v159
    v_cvt_pk_bf16_f32 v171, v11, v15
    buffer_store_dwordx2 v[170:171], v3, s[24:27], 0 offen offset:2560
    s_mov_b32 s36, 0x3f803f80
    v_mov_b32 v88, 0
    v_mov_b32 v89, 0
    v_mov_b32 v90, 0
    v_mov_b32 v91, 0
    v_dot2_f32_bf16 v88, v160, s36, v88
    v_dot2_f32_bf16 v90, v160, v160, v90
    v_dot2_f32_bf16 v89, v161, s36, v89
    v_dot2_f32_bf16 v91, v161, v161, v91
    v_dot2_f32_bf16 v88, v162, s36, v88
    v_dot2_f32_bf16 v90, v162, v162, v90
    v_dot2_f32_bf16 v89, v163, s36, v89
    v_dot2_f32_bf16 v91, v163, v163, v91
    v_dot2_f32_bf16 v88, v164, s36, v88
    v_dot2_f32_bf16 v90, v164, v164, v90
    v_dot2_f32_bf16 v89, v165, s36, v89
    v_dot2_f32_bf16 v91, v165, v165, v91
    v_dot2_f32_bf16 v88, v166, s36, v88
    v_dot2_f32_bf16 v90, v166, v166, v90
    v_dot2_f32_bf16 v89, v167, s36, v89
    v_dot2_f32_bf16 v91, v167, v167, v91
    v_dot2_f32_bf16 v88, v168, s36, v88
    v_dot2_f32_bf16 v90, v168, v168, v90
    v_dot2_f32_bf16 v89, v169, s36, v89
    v_dot2_f32_bf16 v91, v169, v169, v91
    v_dot2_f32_bf16 v88, v170, s36, v88
    v_dot2_f32_bf16 v90, v170, v170, v90
    v_dot2_f32_bf16 v89, v171, s36, v89
    v_dot2_f32_bf16 v91, v171, v171, v91
    s_nop 3
    v_add_f32 v88, v88, v89
    v_add_f32 v89, v90, v91
    v_mov_b32 v90, v88
    v_mov_b32 v91, v89
    s_nop 1
    v_permlane32_swap_b32 v88, v90
    v_permlane32_swap_b32 v89, v91
    v_add_f32 v88, v88, v90
    v_add_f32 v89, v89, v91
    v_mov_b32 v90, v88
    v_mov_b32 v91, v89
    s_nop 1
    v_permlane16_swap_b32 v88, v90
    v_permlane16_swap_b32 v89, v91
    v_add_f32 v88, v88, v90
    v_add_f32 v89, v89, v91
    s_add_u32 s20, s4, 0x1400000
    s_addc_u32 s21, s5, 0
    s_mov_b32 s22, 0x18000
    s_mov_b32 s23, 0x00020000
    s_lshl_b32 s36, s30, 4
    v_add_u32 v3, s36, v12
    v_mul_u32_u24 v3, 48, v3
    s_lshl_b32 s36, s28, 3
    v_cmp_eq_u32 vcc, 0, v13
    s_and_saveexec_b64 s[38:39], vcc
    buffer_store_dwordx2 v[88:89], v3, s[20:23], s36 offen
    s_mov_b64 exec, -1
    s_endpgm
.Lcsentry_29:
    s_load_dwordx4 s[8:11], s[0:1], 8
    s_load_dwordx2 s[12:13], s[0:1], 24
    s_load_dwordx2 s[24:25], s[0:1], 80
    s_sub_u32 s2, s2, 192
    v_and_b32 v1, 63, v0
    v_lshrrev_b32 v2, 6, v0
    s_nop 0
    v_readfirstlane_b32 s3, v2
    s_waitcnt lgkmcnt(0)
    s_mov_b32 s31, 0x00020000
    s_cmp_ge_u32 s2, 5
    s_cbranch_scc1 .Lcs2_31
    s_mov_b32 s28, s8
    s_mov_b32 s29, s9
    s_mov_b32 s30, 663552
    s_movk_i32 s40, 1152
    s_lshl_b32 s36, s2, 7
    s_movk_i32 s37, 576
    s_movk_i32 s38, 0
    s_branch .Lcsl_32
.Lcs2_31:
    s_cmp_eq_u32 s2, 6
    s_cselect_b32 s28, s12, s10
    s_cselect_b32 s29, s13, s11
    s_cselect_b32 s38, 128, 0
    s_add_u32 s38, s38, 2304
    s_mov_b32 s30, 20736
    s_movk_i32 s40, 36
    s_mov_b32 s36, 0
    s_movk_i32 s37, 18
.Lcsl_32:
    s_mul_i32 s48, s40, 0
    s_mul_i32 s49, s40, 1
    s_mul_i32 s50, s40, 2
    s_mul_i32 s51, s40, 3
    s_mul_i32 s52, s40, 4
    s_mul_i32 s53, s40, 5
    s_mul_i32 s54, s40, 6
    s_mul_i32 s55, s40, 7
    s_mul_i32 s56, s40, 8
    s_mul_i32 s57, s40, 9
    s_mul_i32 s58, s40, 10
    s_mul_i32 s59, s40, 11
    s_mul_i32 s60, s40, 12
    s_mul_i32 s61, s40, 13
    s_mul_i32 s62, s40, 14
    s_mul_i32 s63, s40, 15
    v_lshl_add_u32 v5, v1, 1, s36
    s_mul_i32 s41, s3, 144
    s_mul_i32 s41, s41, s40
    v_lshl_add_u32 v6, v5, 1, s41
    s_lshl_b32 s41, s40, 4
    v_mov_b32 v8, 0
    v_mov_b32 v9, 0
    s_mov_b32 s42, 0xffff0000
    s_mov_b32 s43, 0
.Lcslp_33:
    buffer_load_dword v16, v6, s[28:31], s48 offen
    buffer_load_dword v17, v6, s[28:31], s49 offen
    buffer_load_dword v18, v6, s[28:31], s50 offen
    buffer_load_dword v19, v6, s[28:31], s51 offen
    buffer_load_dword v20, v6, s[28:31], s52 offen
    buffer_load_dword v21, v6, s[28:31], s53 offen
    buffer_load_dword v22, v6, s[28:31], s54 offen
    buffer_load_dword v23, v6, s[28:31], s55 offen
    buffer_load_dword v24, v6, s[28:31], s56 offen
    buffer_load_dword v25, v6, s[28:31], s57 offen
    buffer_load_dword v26, v6, s[28:31], s58 offen
    buffer_load_dword v27, v6, s[28:31], s59 offen
    buffer_load_dword v28, v6, s[28:31], s60 offen
    buffer_load_dword v29, v6, s[28:31], s61 offen
    buffer_load_dword v30, v6, s[28:31], s62 offen
    buffer_load_dword v31, v6, s[28:31], s63 offen
    v_add_u32 v6, s41, v6
    s_waitcnt vmcnt(15)
    v_lshlrev_b32 v10, 16, v16
    v_and_b32 v11, s42, v16
    v_add_f32 v8, v8, v10
    v_add_f32 v9, v9, v11
    s_waitcnt vmcnt(14)
    v_lshlrev_b32 v10, 16, v17
    v_and_b32 v11, s42, v17
    v_add_f32 v8, v8, v10
    v_add_f32 v9, v9, v11
    s_waitcnt vmcnt(13)
    v_lshlrev_b32 v10, 16, v18
    v_and_b32 v11, s42, v18
    v_add_f32 v8, v8, v10
    v_add_f32 v9, v9, v11
    s_waitcnt vmcnt(12)
    v_lshlrev_b32 v10, 16, v19
    v_and_b32 v11, s42, v19
    v_add_f32 v8, v8, v10
    v_add_f32 v9, v9, v11
    s_waitcnt vmcnt(11)
    v_lshlrev_b32 v10, 16, v20
    v_and_b32 v11, s42, v20
    v_add_f32 v8, v8, v10
    v_add_f32 v9, v9, v11
    s_waitcnt vmcnt(10)
    v_lshlrev_b32 v10, 16, v21
    v_and_b32 v11, s42, v21
    v_add_f32 v8, v8, v10
    v_add_f32 v9, v9, v11
    s_waitcnt vmcnt(9)
    v_lshlrev_b32 v10, 16, v22
    v_and_b32 v11, s42, v22
    v_add_f32 v8, v8, v10
    v_add_f32 v9, v9, v11
    s_waitcnt vmcnt(8)
    v_lshlrev_b32 v10, 16, v23
    v_and_b32 v11, s42, v23
    v_add_f32 v8, v8, v10
    v_add_f32 v9, v9, v11
    s_waitcnt vmcnt(7)
    v_lshlrev_b32 v10, 16, v24
    v_and_b32 v11, s42, v24
    v_add_f32 v8, v8, v10
    v_add_f32 v9, v9, v11
    s_waitcnt vmcnt(6)
    v_lshlrev_b32 v10, 16, v25
    v_and_b32 v11, s42, v25
    v_add_f32 v8, v8, v10
    v_add_f32 v9, v9, v11
    s_waitcnt vmcnt(5)
    v_lshlrev_b32 v10, 16, v26
    v_and_b32 v11, s42, v26
    v_add_f32 v8, v8, v10
    v_add_f32 v9, v9, v11
    s_waitcnt vmcnt(4)
    v_lshlrev_b32 v10, 16, v27
    v_and_b32 v11, s42, v27
    v_add_f32 v8, v8, v10
    v_add_f32 v9, v9, v11
    s_waitcnt vmcnt(3)
    v_lshlrev_b32 v10, 16, v28
    v_and_b32 v11, s42, v28
    v_add_f32 v8, v8, v10
    v_add_f32 v9, v9, v11
    s_waitcnt vmcnt(2)
    v_lshlrev_b32 v10, 16, v29
    v_and_b32 v11, s42, v29
    v_add_f32 v8, v8, v10
    v_add_f32 v9, v9, v11
    s_waitcnt vmcnt(1)
    v_lshlrev_b32 v10, 16, v30
    v_and_b32 v11, s42, v30
    v_add_f32 v8, v8, v10
    v_add_f32 v9, v9, v11
    s_waitcnt vmcnt(0)
    v_lshlrev_b32 v10, 16, v31
    v_and_b32 v11, s42, v31
    v_add_f32 v8, v8, v10
    v_add_f32 v9, v9, v11
    s_add_u32 s43, s43, 1
    s_cmp_lt_u32 s43, 9
    s_cbranch_scc1 .Lcslp_33
    v_lshlrev_b32 v7, 3, v0
    ds_write_b64 v7, v[8:9]
    s_waitcnt lgkmcnt(0)
    s_barrier
    s_cmp_lg_u32 s3, 0
    s_cbranch_scc1 .Lend_28
    ds_read_b64 v[10:11], v7 offset:512
    ds_read_b64 v[12:13], v7 offset:1024
    ds_read_b64 v[14:15], v7 offset:1536
    s_add_u32 s32, s24, 0x1420000
    s_addc_u32 s33, s25, 0
    s_mov_b32 s34, 0x2500
    s_mov_b32 s35, 0x00020000
    s_waitcnt lgkmcnt(0)
    v_add_f32 v8, v8, v10
    v_add_f32 v9, v9, v11
    v_add_f32 v8, v8, v12
    v_add_f32 v9, v9, v13
    v_add_f32 v8, v8, v14
    v_add_f32 v9, v9, v15
    v_lshlrev_b32 v6, 2, v5
    v_cmp_gt_u32 vcc, s37, v5
    s_and_saveexec_b64 s[44:45], vcc
    buffer_store_dwordx2 v[8:9], v6, s[32:35], s38 offen
    s_endpgm
.Lend_28:
    s_endpgm
.section .rodata,"a"
.p2align 6
.amdhsa_kernel outa1_kernel
  .amdhsa_next_free_vgpr 200
  .amdhsa_next_free_sgpr 100
  .amdhsa_accum_offset 200
  .amdhsa_group_segment_fixed_size 0
  .amdhsa_kernarg_size 88
  .amdhsa_user_sgpr_count 2
  .amdhsa_user_sgpr_kernarg_segment_ptr 1
  .amdhsa_system_sgpr_workgroup_id_x 1
.end_amdhsa_kernel
.text
.globl qkvb1_kernel
.p2align 8
.type qkvb1_kernel,@function
qkvb1_kernel:
    s_cmp_ge_u32 s2, 256
    s_cbranch_scc1 .Lend_34
    s_load_dwordx2 s[8:9], s[0:1], 80
    s_bfe_u32 s3, s2, 0x20001
    s_lshl_b32 s3, s3, 2
    s_lshr_b32 s28, s2, 6
    s_add_u32 s3, s3, s28
    s_and_b32 s28, s2, 1
    s_lshl_b32 s28, s28, 3
    s_bfe_u32 s29, s2, 0x30003
    s_add_u32 s28, s28, s29
    v_and_b32 v1, 63, v0
    v_lshrrev_b32 v11, 6, v0
    s_nop 0
    v_readfirstlane_b32 s29, v11
    v_and_b32 v12, 15, v1
    v_lshrrev_b32 v13, 4, v1
    v_lshlrev_b32 v4, 4, v1
    s_add_u32 s30, s29, 1
    s_cmp_eq_u32 s29, 8
    s_cselect_b32 s30, 0, s30
    s_lshl_b32 s31, s3, 3
    s_add_u32 s31, s31, s30
    s_sub_u32 s31, s31, 1
    s_mul_i32 s31, s31, 18432
    v_add_u32 v2, s31, v4
    s_mov_b32 s41, 4096
    s_mov_b32 s42, 8192
    s_mov_b32 s43, 12288
    s_mov_b32 s44, 16384
    s_mov_b32 s40, 0
    s_waitcnt lgkmcnt(0)
    s_mov_b32 s12, s8
    s_mov_b32 s13, s9
    s_mov_b32 s14, 0x240000
    s_mov_b32 s15, 0x00020000
    s_add_u32 s16, s8, 0x1200000
    s_addc_u32 s17, s9, 0
    s_mov_b32 s18, 0x1f8000
    s_mov_b32 s19, 0x00020000
    s_add_u32 s20, s8, 0x900000
    s_addc_u32 s21, s9, 0
    s_mov_b32 s22, 0x240000
    s_mov_b32 s23, 0x00020000
    s_mul_i32 s33, s28, 129024
    s_lshl_b32 s34, s29, 10
    s_add_u32 s33, s33, s34
    v_cmp_ne_u32 s[46:47], 0, v12
    s_cmp_eq_u32 s29, 8
    s_cselect_b64 s[46:47], s[46:47], -1
    s_mov_b64 exec, s[46:47]
    buffer_load_dwordx4 v[16:19], v2, s[12:15], s40 offen offset:0
    buffer_load_dwordx4 v[20:23], v2, s[12:15], s40 offen offset:1024
    s_mov_b64 exec, -1
    s_add_u32 m0, s34, 0
    s_add_u32 s35, s33, 0
    buffer_load_dwordx4 v4, s[16:19], s35 offen lds
    s_add_u32 m0, s34, 9216
    s_add_u32 s35, s33, 9216
    buffer_load_dwordx4 v4, s[16:19], s35 offen lds
    s_mov_b64 exec, s[46:47]
    buffer_load_dwordx4 v[24:27], v2, s[12:15], s40 offen offset:2048
    buffer_load_dwordx4 v[28:31], v2, s[12:15], s40 offen offset:3072
    s_mov_b64 exec, -1
    s_add_u32 m0, s34, 18432
    s_add_u32 s35, s33, 18432
    buffer_load_dwordx4 v4, s[16:19], s35 offen lds
    s_add_u32 m0, s34, 27648
    s_add_u32 s35, s33, 27648
    buffer_load_dwordx4 v4, s[16:19], s35 offen lds
    s_mov_b64 exec, s[46:47]
    buffer_load_dwordx4 v[32:35], v2, s[12:15], s41 offen offset:0
    buffer_load_dwordx4 v[36:39], v2, s[12:15], s41 offen offset:1024
    s_mov_b64 exec, -1
    s_add_u32 m0, s34, 36864
    s_add_u32 s35, s33, 36864
    buffer_load_dwordx4 v4, s[16:19], s35 offen lds
    s_cmp_lg_u32 s29, 8
    s_cbranch_scc1 .Lnoone_35
    s_not_b64 exec, s[46:47]
    v_mov_b32 v16, 0x3f803f80
    v_mov_b32 v17, 0x3f803f80
    v_mov_b32 v18, 0x3f803f80
    v_mov_b32 v19, 0x3f803f80
    v_mov_b32 v20, 0x3f803f80
    v_mov_b32 v21, 0x3f803f80
    v_mov_b32 v22, 0x3f803f80
    v_mov_b32 v23, 0x3f803f80
    v_mov_b32 v24, 0x3f803f80
    v_mov_b32 v25, 0x3f803f80
    v_mov_b32 v26, 0x3f803f80
    v_mov_b32 v27, 0x3f803f80
    v_mov_b32 v28, 0x3f803f80
    v_mov_b32 v29, 0x3f803f80
    v_mov_b32 v30, 0x3f803f80
    v_mov_b32 v31, 0x3f803f80
    v_mov_b32 v32, 0x3f803f80
    v_mov_b32 v33, 0x3f803f80
    v_mov_b32 v34, 0x3f803f80
    v_mov_b32 v35, 0x3f803f80
    v_mov_b32 v36, 0x3f803f80
    v_mov_b32 v37, 0x3f803f80
    v_mov_b32 v38, 0x3f803f80
    v_mov_b32 v39, 0x3f803f80
    v_mov_b32 v40, 0x3f803f80
    v_mov_b32 v41, 0x3f803f80
    v_mov_b32 v42, 0x3f803f80
    v_mov_b32 v43, 0x3f803f80
    v_mov_b32 v44, 0x3f803f80
    v_mov_b32 v45, 0x3f803f80
    v_mov_b32 v46, 0x3f803f80
    v_mov_b32 v47, 0x3f803f80
    v_mov_b32 v48, 0x3f803f80
    v_mov_b32 v49, 0x3f803f80
    v_mov_b32 v50, 0x3f803f80
    v_mov_b32 v51, 0x3f803f80
    v_mov_b32 v52, 0x3f803f80
    v_mov_b32 v53, 0x3f803f80
    v_mov_b32 v54, 0x3f803f80
    v_mov_b32 v55, 0x3f803f80
    v_mov_b32 v56, 0x3f803f80
    v_mov_b32 v57, 0x3f803f80
    v_mov_b32 v58, 0x3f803f80
    v_mov_b32 v59, 0x3f803f80
    v_mov_b32 v60, 0x3f803f80
    v_mov_b32 v61, 0x3f803f80
    v_mov_b32 v62, 0x3f803f80
    v_mov_b32 v63, 0x3f803f80
    v_mov_b32 v64, 0x3f803f80
    v_mov_b32 v65, 0x3f803f80
    v_mov_b32 v66, 0x3f803f80
    v_mov_b32 v67, 0x3f803f80
    v_mov_b32 v68, 0x3f803f80
    v_mov_b32 v69, 0x3f803f80
    v_mov_b32 v70, 0x3f803f80
    v_mov_b32 v71, 0x3f803f80
    v_mov_b32 v72, 0x3f803f80
    v_mov_b32 v73, 0x3f803f80
    v_mov_b32 v74, 0x3f803f80
    v_mov_b32 v75, 0x3f803f80
    v_mov_b32 v76, 0x3f803f80
    v_mov_b32 v77, 0x3f803f80
    v_mov_b32 v78, 0x3f803f80
    v_mov_b32 v79, 0x3f803f80
    v_mov_b32 v80, 0x3f803f80
    v_mov_b32 v81, 0x3f803f80
    v_mov_b32 v82, 0x3f803f80
    v_mov_b32 v83, 0x3f803f80
    v_mov_b32 v84, 0x3f803f80
    v_mov_b32 v85, 0x3f803f80
    v_mov_b32 v86, 0x3f803f80
    v_mov_b32 v87, 0x3f803f80
    s_mov_b64 exec, -1
.Lnoone_35:
    v_add_u32 v5, 64512, v4
    v_mov_b32 v120, 0
    v_mov_b32 v121, 0
    v_mov_b32 v122, 0
    v_mov_b32 v123, 0
    v_mov_b32 v124, 0
    v_mov_b32 v125, 0
    v_mov_b32 v126, 0
    v_mov_b32 v127, 0
    v_mov_b32 v128, 0
    v_mov_b32 v129, 0
    v_mov_b32 v130, 0
    v_mov_b32 v131, 0
    v_mov_b32 v132, 0
    v_mov_b32 v133, 0
    v_mov_b32 v134, 0
    v_mov_b32 v135, 0
    v_mov_b32 v136, 0
    v_mov_b32 v137, 0
    v_mov_b32 v138, 0
    v_mov_b32 v139, 0
    v_mov_b32 v140, 0
    v_mov_b32 v141, 0
    v_mov_b32 v142, 0
    v_mov_b32 v143, 0
    v_mov_b32 v144, 0
    v_mov_b32 v145, 0
    v_mov_b32 v146, 0
    v_mov_b32 v147, 0
    s_waitcnt vmcnt(7)
    s_barrier
    ds_read_b128 v[88:91], v4 offset:0
    ds_read_b128 v[92:95], v4 offset:1024
    ds_read_b128 v[96:99], v4 offset:2048
    ds_read_b128 v[100:103], v4 offset:3072
    ds_read_b128 v[104:107], v4 offset:4096
    ds_read_b128 v[108:111], v4 offset:5120
    ds_read_b128 v[112:115], v4 offset:6144
    s_mov_b64 exec, s[46:47]
    buffer_load_dwordx4 v[40:43], v2, s[12:15], s41 offen offset:2048
    buffer_load_dwordx4 v[44:47], v2, s[12:15], s41 offen offset:3072
    s_mov_b64 exec, -1
    s_add_u32 m0, s34, 46080
    s_add_u32 s35, s33, 46080
    buffer_load_dwordx4 v4, s[16:19], s35 offen lds
    s_add_u32 m0, s34, 55296
    s_add_u32 s35, s33, 55296
    buffer_load_dwordx4 v4, s[16:19], s35 offen lds
    s_waitcnt lgkmcnt(3)
    v_mfma_f32_16x16x32_bf16 v[120:123], v[88:91], v[16:19], v[120:123]
    v_mfma_f32_16x16x32_bf16 v[124:127], v[92:95], v[16:19], v[124:127]
    v_mfma_f32_16x16x32_bf16 v[128:131], v[96:99], v[16:19], v[128:131]
    v_mfma_f32_16x16x32_bf16 v[132:135], v[100:103], v[16:19], v[132:135]
    ds_read_b128 v[88:91], v4 offset:7168
    ds_read_b128 v[92:95], v4 offset:8192
    ds_read_b128 v[96:99], v4 offset:9216
    ds_read_b128 v[100:103], v4 offset:10240
    s_waitcnt lgkmcnt(4)
    v_mfma_f32_16x16x32_bf16 v[136:139], v[104:107], v[16:19], v[136:139]
    v_mfma_f32_16x16x32_bf16 v[140:143], v[108:111], v[16:19], v[140:143]
    v_mfma_f32_16x16x32_bf16 v[144:147], v[112:115], v[16:19], v[144:147]
    ds_read_b128 v[104:107], v4 offset:11264
    ds_read_b128 v[108:111], v4 offset:12288
    ds_read_b128 v[112:115], v4 offset:13312
    s_waitcnt lgkmcnt(3)
    v_mfma_f32_16x16x32_bf16 v[120:123], v[88:91], v[20:23], v[120:123]
    v_mfma_f32_16x16x32_bf16 v[124:127], v[92:95], v[20:23], v[124:127]
    v_mfma_f32_16x16x32_bf16 v[128:131], v[96:99], v[20:23], v[128:131]
    v_mfma_f32_16x16x32_bf16 v[132:135], v[100:103], v[20:23], v[132:135]
    s_waitcnt lgkmcnt(0)
    s_waitcnt vmcnt(7)
    s_barrier
    ds_read_b128 v[88:91], v4 offset:14336
    ds_read_b128 v[92:95], v4 offset:15360
    ds_read_b128 v[96:99], v4 offset:16384
    ds_read_b128 v[100:103], v4 offset:17408
    v_mfma_f32_16x16x32_bf16 v[136:139], v[104:107], v[20:23], v[136:139]
    v_mfma_f32_16x16x32_bf16 v[140:143], v[108:111], v[20:23], v[140:143]
    v_mfma_f32_16x16x32_bf16 v[144:147], v[112:115], v[20:23], v[144:147]
    ds_read_b128 v[104:107], v4 offset:18432
    ds_read_b128 v[108:111], v4 offset:19456
    ds_read_b128 v[112:115], v4 offset:20480
    s_mov_b64 exec, s[46:47]
    buffer_load_dwordx4 v[48:51], v2, s[12:15], s42 offen offset:0
    buffer_load_dwordx4 v[52:55], v2, s[12:15], s42 offen offset:1024
    s_mov_b64 exec, -1
    s_add_u32 m0, s34, 64512
    s_add_u32 s35, s33, 64512
    buffer_load_dwordx4 v4, s[16:19], s35 offen lds
    s_waitcnt lgkmcnt(3)
    v_mfma_f32_16x16x32_bf16 v[120:123], v[88:91], v[24:27], v[120:123]
    v_mfma_f32_16x16x32_bf16 v[124:127], v[92:95], v[24:27], v[124:127]
    v_mfma_f32_16x16x32_bf16 v[128:131], v[96:99], v[24:27], v[128:131]
    v_mfma_f32_16x16x32_bf16 v[132:135], v[100:103], v[24:27], v[132:135]
    ds_read_b128 v[88:91], v4 offset:21504
    ds_read_b128 v[92:95], v4 offset:22528
    ds_read_b128 v[96:99], v4 offset:23552
    ds_read_b128 v[100:103], v4 offset:24576
    s_waitcnt lgkmcnt(4)
    v_mfma_f32_16x16x32_bf16 v[136:139], v[104:107], v[24:27], v[136:139]
    v_mfma_f32_16x16x32_bf16 v[140:143], v[108:111], v[24:27], v[140:143]
    v_mfma_f32_16x16x32_bf16 v[144:147], v[112:115], v[24:27], v[144:147]
    ds_read_b128 v[104:107], v4 offset:25600
    ds_read_b128 v[108:111], v4 offset:26624
    ds_read_b128 v[112:115], v4 offset:27648
    s_waitcnt lgkmcnt(3)
    v_mfma_f32_16x16x32_bf16 v[120:123], v[88:91], v[28:31], v[120:123]
    v_mfma_f32_16x16x32_bf16 v[124:127], v[92:95], v[28:31], v[124:127]
    v_mfma_f32_16x16x32_bf16 v[128:131], v[96:99], v[28:31], v[128:131]
    v_mfma_f32_16x16x32_bf16 v[132:135], v[100:103], v[28:31], v[132:135]
    s_waitcnt lgkmcnt(0)
    s_waitcnt vmcnt(7)
    s_barrier
    ds_read_b128 v[88:91], v4 offset:28672
    ds_read_b128 v[92:95], v4 offset:29696
    ds_read_b128 v[96:99], v4 offset:30720
    ds_read_b128 v[100:103], v4 offset:31744
    v_mfma_f32_16x16x32_bf16 v[136:139], v[104:107], v[28:31], v[136:139]
    v_mfma_f32_16x16x32_bf16 v[140:143], v[108:111], v[28:31], v[140:143]
    v_mfma_f32_16x16x32_bf16 v[144:147], v[112:115], v[28:31], v[144:147]
    ds_read_b128 v[104:107], v4 offset:32768
    ds_read_b128 v[108:111], v4 offset:33792
    ds_read_b128 v[112:115], v4 offset:34816
    s_mov_b64 exec, s[46:47]
    buffer_load_dwordx4 v[56:59], v2, s[12:15], s42 offen offset:2048
    buffer_load_dwordx4 v[60:63], v2, s[12:15], s42 offen offset:3072
    s_mov_b64 exec, -1
    s_add_u32 m0, s34, 73728
    s_add_u32 s35, s33, 73728
    buffer_load_dwordx4 v4, s[16:19], s35 offen lds
    s_add_u32 m0, s34, 82944
    s_add_u32 s35, s33, 82944
    buffer_load_dwordx4 v4, s[16:19], s35 offen lds
    s_waitcnt lgkmcnt(3)
    v_mfma_f32_16x16x32_bf16 v[120:123], v[88:91], v[32:35], v[120:123]
    v_mfma_f32_16x16x32_bf16 v[124:127], v[92:95], v[32:35], v[124:127]
    v_mfma_f32_16x16x32_bf16 v[128:131], v[96:99], v[32:35], v[128:131]
    v_mfma_f32_16x16x32_bf16 v[132:135], v[100:103], v[32:35], v[132:135]
    ds_read_b128 v[88:91], v4 offset:35840
    ds_read_b128 v[92:95], v4 offset:36864
    ds_read_b128 v[96:99], v4 offset:37888
    ds_read_b128 v[100:103], v4 offset:38912
    s_waitcnt lgkmcnt(4)
    v_mfma_f32_16x16x32_bf16 v[136:139], v[104:107], v[32:35], v[136:139]
    v_mfma_f32_16x16x32_bf16 v[140:143], v[108:111], v[32:35], v[140:143]
    v_mfma_f32_16x16x32_bf16 v[144:147], v[112:115], v[32:35], v[144:147]
    ds_read_b128 v[104:107], v4 offset:39936
    ds_read_b128 v[108:111], v4 offset:40960
    ds_read_b128 v[112:115], v4 offset:41984
    s_waitcnt lgkmcnt(3)
    v_mfma_f32_16x16x32_bf16 v[120:123], v[88:91], v[36:39], v[120:123]
    v_mfma_f32_16x16x32_bf16 v[124:127], v[92:95], v[36:39], v[124:127]
    v_mfma_f32_16x16x32_bf16 v[128:131], v[96:99], v[36:39], v[128:131]
    v_mfma_f32_16x16x32_bf16 v[132:135], v[100:103], v[36:39], v[132:135]
    s_waitcnt lgkmcnt(0)
    s_waitcnt vmcnt(7)
    s_barrier
    ds_read_b128 v[88:91], v4 offset:43008
    ds_read_b128 v[92:95], v4 offset:44032
    ds_read_b128 v[96:99], v4 offset:45056
    ds_read_b128 v[100:103], v4 offset:46080
    v_mfma_f32_16x16x32_bf16 v[136:139], v[104:107], v[36:39], v[136:139]
    v_mfma_f32_16x16x32_bf16 v[140:143], v[108:111], v[36:39], v[140:143]
    v_mfma_f32_16x16x32_bf16 v[144:147], v[112:115], v[36:39], v[144:147]
    ds_read_b128 v[104:107], v4 offset:47104
    ds_read_b128 v[108:111], v4 offset:48128
    ds_read_b128 v[112:115], v4 offset:49152
    s_mov_b64 exec, s[46:47]
    buffer_load_dwordx4 v[64:67], v2, s[12:15], s43 offen offset:0
    buffer_load_dwordx4 v[68:71], v2, s[12:15], s43 offen offset:1024
    s_mov_b64 exec, -1
    s_add_u32 m0, s34, 92160
    s_add_u32 s35, s33, 92160
    buffer_load_dwordx4 v4, s[16:19], s35 offen lds
    s_waitcnt lgkmcnt(3)
    v_mfma_f32_16x16x32_bf16 v[120:123], v[88:91], v[40:43], v[120:123]
    v_mfma_f32_16x16x32_bf16 v[124:127], v[92:95], v[40:43], v[124:127]
    v_mfma_f32_16x16x32_bf16 v[128:131], v[96:99], v[40:43], v[128:131]
    v_mfma_f32_16x16x32_bf16 v[132:135], v[100:103], v[40:43], v[132:135]
    ds_read_b128 v[88:91], v4 offset:50176
    ds_read_b128 v[92:95], v4 offset:51200
    ds_read_b128 v[96:99], v4 offset:52224
    ds_read_b128 v[100:103], v4 offset:53248
    s_waitcnt lgkmcnt(4)
    v_mfma_f32_16x16x32_bf16 v[136:139], v[104:107], v[40:43], v[136:139]
    v_mfma_f32_16x16x32_bf16 v[140:143], v[108:111], v[40:43], v[140:143]
    v_mfma_f32_16x16x32_bf16 v[144:147], v[112:115], v[40:43], v[144:147]
    ds_read_b128 v[104:107], v4 offset:54272
    ds_read_b128 v[108:111], v4 offset:55296
    ds_read_b128 v[112:115], v4 offset:56320
    s_waitcnt lgkmcnt(3)
    v_mfma_f32_16x16x32_bf16 v[120:123], v[88:91], v[44:47], v[120:123]
    v_mfma_f32_16x16x32_bf16 v[124:127], v[92:95], v[44:47], v[124:127]
    v_mfma_f32_16x16x32_bf16 v[128:131], v[96:99], v[44:47], v[128:131]
    v_mfma_f32_16x16x32_bf16 v[132:135], v[100:103], v[44:47], v[132:135]
    s_waitcnt lgkmcnt(0)
    s_waitcnt vmcnt(7)
    s_barrier
    ds_read_b128 v[88:91], v4 offset:57344
    ds_read_b128 v[92:95], v4 offset:58368
    ds_read_b128 v[96:99], v4 offset:59392
    ds_read_b128 v[100:103], v4 offset:60416
    v_mfma_f32_16x16x32_bf16 v[136:139], v[104:107], v[44:47], v[136:139]
    v_mfma_f32_16x16x32_bf16 v[140:143], v[108:111], v[44:47], v[140:143]
    v_mfma_f32_16x16x32_bf16 v[144:147], v[112:115], v[44:47], v[144:147]
    ds_read_b128 v[104:107], v4 offset:61440
    ds_read_b128 v[108:111], v4 offset:62464
    ds_read_b128 v[112:115], v4 offset:63488
    s_mov_b64 exec, s[46:47]
    buffer_load_dwordx4 v[72:75], v2, s[12:15], s43 offen offset:2048
    buffer_load_dwordx4 v[76:79], v2, s[12:15], s43 offen offset:3072
    s_mov_b64 exec, -1
    s_add_u32 m0, s34, 101376
    s_add_u32 s35, s33, 101376
    buffer_load_dwordx4 v4, s[16:19], s35 offen lds
    s_add_u32 m0, s34, 110592
    s_add_u32 s35, s33, 110592
    buffer_load_dwordx4 v4, s[16:19], s35 offen lds
    s_waitcnt lgkmcnt(3)
    v_mfma_f32_16x16x32_bf16 v[120:123], v[88:91], v[48:51], v[120:123]
    v_mfma_f32_16x16x32_bf16 v[124:127], v[92:95], v[48:51], v[124:127]
    v_mfma_f32_16x16x32_bf16 v[128:131], v[96:99], v[48:51], v[128:131]
    v_mfma_f32_16x16x32_bf16 v[132:135], v[100:103], v[48:51], v[132:135]
    ds_read_b128 v[88:91], v5 offset:0
    ds_read_b128 v[92:95], v5 offset:1024
    ds_read_b128 v[96:99], v5 offset:2048
    ds_read_b128 v[100:103], v5 offset:3072
    s_waitcnt lgkmcnt(4)
    v_mfma_f32_16x16x32_bf16 v[136:139], v[104:107], v[48:51], v[136:139]
    v_mfma_f32_16x16x32_bf16 v[140:143], v[108:111], v[48:51], v[140:143]
    v_mfma_f32_16x16x32_bf16 v[144:147], v[112:115], v[48:51], v[144:147]
    ds_read_b128 v[104:107], v5 offset:4096
    ds_read_b128 v[108:111], v5 offset:5120
    ds_read_b128 v[112:115], v5 offset:6144
    s_waitcnt lgkmcnt(3)
    v_mfma_f32_16x16x32_bf16 v[120:123], v[88:91], v[52:55], v[120:123]
    v_mfma_f32_16x16x32_bf16 v[124:127], v[92:95], v[52:55], v[124:127]
    v_mfma_f32_16x16x32_bf16 v[128:131], v[96:99], v[52:55], v[128:131]
    v_mfma_f32_16x16x32_bf16 v[132:135], v[100:103], v[52:55], v[132:135]
    s_waitcnt lgkmcnt(0)
    s_waitcnt vmcnt(7)
    s_barrier
    ds_read_b128 v[88:91], v5 offset:7168
    ds_read_b128 v[92:95], v5 offset:8192
    ds_read_b128 v[96:99], v5 offset:9216
    ds_read_b128 v[100:103], v5 offset:10240
    v_mfma_f32_16x16x32_bf16 v[136:139], v[104:107], v[52:55], v[136:139]
    v_mfma_f32_16x16x32_bf16 v[140:143], v[108:111], v[52:55], v[140:143]
    v_mfma_f32_16x16x32_bf16 v[144:147], v[112:115], v[52:55], v[144:147]
    ds_read_b128 v[104:107], v5 offset:11264
    ds_read_b128 v[108:111], v5 offset:12288
    ds_read_b128 v[112:115], v5 offset:13312
    s_mov_b64 exec, s[46:47]
    buffer_load_dwordx4 v[80:83], v2, s[12:15], s44 offen offset:0
    buffer_load_dwordx4 v[84:87], v2, s[12:15], s44 offen offset:1024
    s_mov_b64 exec, -1
    s_add_u32 m0, s34, 119808
    s_add_u32 s35, s33, 119808
    buffer_load_dwordx4 v4, s[16:19], s35 offen lds
    s_waitcnt lgkmcnt(3)
    v_mfma_f32_16x16x32_bf16 v[120:123], v[88:91], v[56:59], v[120:123]
    v_mfma_f32_16x16x32_bf16 v[124:127], v[92:95], v[56:59], v[124:127]
    v_mfma_f32_16x16x32_bf16 v[128:131], v[96:99], v[56:59], v[128:131]
    v_mfma_f32_16x16x32_bf16 v[132:135], v[100:103], v[56:59], v[132:135]
    ds_read_b128 v[88:91], v5 offset:14336
    ds_read_b128 v[92:95], v5 offset:15360
    ds_read_b128 v[96:99], v5 offset:16384
    ds_read_b128 v[100:103], v5 offset:17408
    s_waitcnt lgkmcnt(4)
    v_mfma_f32_16x16x32_bf16 v[136:139], v[104:107], v[56:59], v[136:139]
    v_mfma_f32_16x16x32_bf16 v[140:143], v[108:111], v[56:59], v[140:143]
    v_mfma_f32_16x16x32_bf16 v[144:147], v[112:115], v[56:59], v[144:147]
    ds_read_b128 v[104:107], v5 offset:18432
    ds_read_b128 v[108:111], v5 offset:19456
    ds_read_b128 v[112:115], v5 offset:20480
    s_waitcnt lgkmcnt(3)
    v_mfma_f32_16x16x32_bf16 v[120:123], v[88:91], v[60:63], v[120:123]
    v_mfma_f32_16x16x32_bf16 v[124:127], v[92:95], v[60:63], v[124:127]
    v_mfma_f32_16x16x32_bf16 v[128:131], v[96:99], v[60:63], v[128:131]
    v_mfma_f32_16x16x32_bf16 v[132:135], v[100:103], v[60:63], v[132:135]
    s_waitcnt lgkmcnt(0)
    s_waitcnt vmcnt(7)
    s_barrier
    ds_read_b128 v[88:91], v5 offset:21504
    ds_read_b128 v[92:95], v5 offset:22528
    ds_read_b128 v[96:99], v5 offset:23552
    ds_read_b128 v[100:103], v5 offset:24576
    v_mfma_f32_16x16x32_bf16 v[136:139], v[104:107], v[60:63], v[136:139]
    v_mfma_f32_16x16x32_bf16 v[140:143], v[108:111], v[60:63], v[140:143]
    v_mfma_f32_16x16x32_bf16 v[144:147], v[112:115], v[60:63], v[144:147]
    ds_read_b128 v[104:107], v5 offset:25600
    ds_read_b128 v[108:111], v5 offset:26624
    ds_read_b128 v[112:115], v5 offset:27648
    s_add_u32 s24, s8, 0x1400000
    s_addc_u32 s25, s9, 0
    s_mov_b32 s26, 0x18000
    s_mov_b32 s27, 0x00020000
    s_lshl_b32 s36, s3, 3
    s_add_u32 s36, s36, s30
    s_sub_u32 s36, s36, 1
    s_lshl_b32 s36, s36, 4
    v_add_u32 v3, s36, v12
    v_mul_i32_i24 v3, 48, v3
    buffer_load_dwordx4 v[148:151], v3, s[24:27], 0 offen offset:0
    buffer_load_dwordx4 v[152:155], v3, s[24:27], 0 offen offset:16
    buffer_load_dwordx4 v[156:159], v3, s[24:27], 0 offen offset:32
    s_waitcnt lgkmcnt(3)
    v_mfma_f32_16x16x32_bf16 v[120:123], v[88:91], v[64:67], v[120:123]
    v_mfma_f32_16x16x32_bf16 v[124:127], v[92:95], v[64:67], v[124:127]
    v_mfma_f32_16x16x32_bf16 v[128:131], v[96:99], v[64:67], v[128:131]
    v_mfma_f32_16x16x32_bf16 v[132:135], v[100:103], v[64:67], v[132:135]
    ds_read_b128 v[88:91], v5 offset:28672
    ds_read_b128 v[92:95], v5 offset:29696
    ds_read_b128 v[96:99], v5 offset:30720
    ds_read_b128 v[100:103], v5 offset:31744
    s_waitcnt lgkmcnt(4)
    v_mfma_f32_16x16x32_bf16 v[136:139], v[104:107], v[64:67], v[136:139]
    v_mfma_f32_16x16x32_bf16 v[140:143], v[108:111], v[64:67], v[140:143]
    v_mfma_f32_16x16x32_bf16 v[144:147], v[112:115], v[64:67], v[144:147]
    ds_read_b128 v[104:107], v5 offset:32768
    ds_read_b128 v[108:111], v5 offset:33792
    ds_read_b128 v[112:115], v5 offset:34816
    s_waitcnt lgkmcnt(3)
    v_mfma_f32_16x16x32_bf16 v[120:123], v[88:91], v[68:71], v[120:123]
    v_mfma_f32_16x16x32_bf16 v[124:127], v[92:95], v[68:71], v[124:127]
    v_mfma_f32_16x16x32_bf16 v[128:131], v[96:99], v[68:71], v[128:131]
    v_mfma_f32_16x16x32_bf16 v[132:135], v[100:103], v[68:71], v[132:135]
    s_waitcnt lgkmcnt(0)
    s_waitcnt vmcnt(6)
    s_barrier
    ds_read_b128 v[88:91], v5 offset:35840
    ds_read_b128 v[92:95], v5 offset:36864
    ds_read_b128 v[96:99], v5 offset:37888
    ds_read_b128 v[100:103], v5 offset:38912
    v_mfma_f32_16x16x32_bf16 v[136:139], v[104:107], v[68:71], v[136:139]
    v_mfma_f32_16x16x32_bf16 v[140:143], v[108:111], v[68:71], v[140:143]
    v_mfma_f32_16x16x32_bf16 v[144:147], v[112:115], v[68:71], v[144:147]
    ds_read_b128 v[104:107], v5 offset:39936
    ds_read_b128 v[108:111], v5 offset:40960
    ds_read_b128 v[112:115], v5 offset:41984
    s_waitcnt lgkmcnt(3)
    v_mfma_f32_16x16x32_bf16 v[120:123], v[88:91], v[72:75], v[120:123]
    v_mfma_f32_16x16x32_bf16 v[124:127], v[92:95], v[72:75], v[124:127]
    v_mfma_f32_16x16x32_bf16 v[128:131], v[96:99], v[72:75], v[128:131]
    v_mfma_f32_16x16x32_bf16 v[132:135], v[100:103], v[72:75], v[132:135]
    ds_read_b128 v[88:91], v5 offset:43008
    ds_read_b128 v[92:95], v5 offset:44032
    ds_read_b128 v[96:99], v5 offset:45056
    ds_read_b128 v[100:103], v5 offset:46080
    s_waitcnt lgkmcnt(4)
    v_mfma_f32_16x16x32_bf16 v[136:139], v[104:107], v[72:75], v[136:139]
    v_mfma_f32_16x16x32_bf16 v[140:143], v[108:111], v[72:75], v[140:143]
    v_mfma_f32_16x16x32_bf16 v[144:147], v[112:115], v[72:75], v[144:147]
    ds_read_b128 v[104:107], v5 offset:47104
    ds_read_b128 v[108:111], v5 offset:48128
    ds_read_b128 v[112:115], v5 offset:49152
    s_waitcnt lgkmcnt(3)
    v_mfma_f32_16x16x32_bf16 v[120:123], v[88:91], v[76:79], v[120:123]
    v_mfma_f32_16x16x32_bf16 v[124:127], v[92:95], v[76:79], v[124:127]
    v_mfma_f32_16x16x32_bf16 v[128:131], v[96:99], v[76:79], v[128:131]
    v_mfma_f32_16x16x32_bf16 v[132:135], v[100:103], v[76:79], v[132:135]
    s_waitcnt lgkmcnt(0)
    s_waitcnt vmcnt(3)
    s_barrier
    ds_read_b128 v[88:91], v5 offset:50176
    ds_read_b128 v[92:95], v5 offset:51200
    ds_read_b128 v[96:99], v5 offset:52224
    ds_read_b128 v[100:103], v5 offset:53248
    v_mfma_f32_16x16x32_bf16 v[136:139], v[104:107], v[76:79], v[136:139]
    v_mfma_f32_16x16x32_bf16 v[140:143], v[108:111], v[76:79], v[140:143]
    v_mfma_f32_16x16x32_bf16 v[144:147], v[112:115], v[76:79], v[144:147]
    ds_read_b128 v[104:107], v5 offset:54272
    ds_read_b128 v[108:111], v5 offset:55296
    ds_read_b128 v[112:115], v5 offset:56320
    s_waitcnt lgkmcnt(3)
    v_mfma_f32_16x16x32_bf16 v[120:123], v[88:91], v[80:83], v[120:123]
    v_mfma_f32_16x16x32_bf16 v[124:127], v[92:95], v[80:83], v[124:127]
    v_mfma_f32_16x16x32_bf16 v[128:131], v[96:99], v[80:83], v[128:131]
    v_mfma_f32_16x16x32_bf16 v[132:135], v[100:103], v[80:83], v[132:135]
    ds_read_b128 v[88:91], v5 offset:57344
    ds_read_b128 v[92:95], v5 offset:58368
    ds_read_b128 v[96:99], v5 offset:59392
    ds_read_b128 v[100:103], v5 offset:60416
    s_waitcnt lgkmcnt(4)
    v_mfma_f32_16x16x32_bf16 v[136:139], v[104:107], v[80:83], v[136:139]
    v_mfma_f32_16x16x32_bf16 v[140:143], v[108:111], v[80:83], v[140:143]
    v_mfma_f32_16x16x32_bf16 v[144:147], v[112:115], v[80:83], v[144:147]
    ds_read_b128 v[104:107], v5 offset:61440
    ds_read_b128 v[108:111], v5 offset:62464
    ds_read_b128 v[112:115], v5 offset:63488
    s_waitcnt lgkmcnt(3)
    v_mfma_f32_16x16x32_bf16 v[120:123], v[88:91], v[84:87], v[120:123]
    v_mfma_f32_16x16x32_bf16 v[124:127], v[92:95], v[84:87], v[124:127]
    v_mfma_f32_16x16x32_bf16 v[128:131], v[96:99], v[84:87], v[128:131]
    v_mfma_f32_16x16x32_bf16 v[132:135], v[100:103], v[84:87], v[132:135]
    s_waitcnt lgkmcnt(0)
    v_mfma_f32_16x16x32_bf16 v[136:139], v[104:107], v[84:87], v[136:139]
    v_mfma_f32_16x16x32_bf16 v[140:143], v[108:111], v[84:87], v[140:143]
    v_mfma_f32_16x16x32_bf16 v[144:147], v[112:115], v[84:87], v[144:147]
    s_nop 7
    s_cmp_lg_u32 s29, 8
    s_cbranch_scc1 .Lnocs_36
    v_lshlrev_b32 v3, 4, v13
    v_add_u32 v3, 129024, v3
    v_cmp_eq_u32 vcc, 0, v12
    s_and_saveexec_b64 s[38:39], vcc
    ds_write_b128 v3, v[120:123] offset:0
    ds_write_b128 v3, v[124:127] offset:64
    ds_write_b128 v3, v[128:131] offset:128
    ds_write_b128 v3, v[132:135] offset:192
    ds_write_b128 v3, v[136:139] offset:256
    ds_write_b128 v3, v[140:143] offset:320
    ds_write_b128 v3, v[144:147] offset:384
    s_mov_b64 exec, -1
    s_waitcnt lgkmcnt(0)
.Lnocs_36:
    s_barrier
    v_lshlrev_b32 v3, 4, v13
    v_add_u32 v3, 129024, v3
    ds_read_b128 v[32:35], v3 offset:0
    ds_read_b128 v[36:39], v3 offset:64
    ds_read_b128 v[40:43], v3 offset:128
    ds_read_b128 v[44:47], v3 offset:192
    ds_read_b128 v[48:51], v3 offset:256
    ds_read_b128 v[52:55], v3 offset:320
    ds_read_b128 v[56:59], v3 offset:384
    s_waitcnt vmcnt(0)
    v_add_f32 v148, v148, v150
    v_add_f32 v149, v149, v151
    v_add_f32 v148, v148, v152
    v_add_f32 v149, v149, v153
    v_add_f32 v148, v148, v154
    v_add_f32 v149, v149, v155
    v_add_f32 v148, v148, v156
    v_add_f32 v149, v149, v157
    v_add_f32 v148, v148, v158
    v_add_f32 v149, v149, v159
    s_mov_b32 s36, 0x3ae38e39
    v_mul_f32 v148, s36, v148
    v_mul_f32 v149, s36, v149
    v_fma_f32 v149, -v148, v148, v149
    v_max_f32 v149, 0, v149
    v_cvt_pk_bf16_f32 v150, v148, v149
    v_lshlrev_b32 v148, 16, v150
    v_and_b32 v149, 0xffff0000, v150
    v_add_f32 v149, 0x3727c5ac, v149
    v_cvt_pk_bf16_f32 v149, v149, v149
    v_lshlrev_b32 v149, 16, v149
    v_sqrt_f32 v149, v149
    s_nop 0
    v_cvt_pk_bf16_f32 v149, v149, v149
    v_lshlrev_b32 v149, 16, v149
    v_rcp_f32 v149, v149
    s_nop 0
    s_waitcnt lgkmcnt(0)
    v_fma_f32 v120, -v148, v32, v120
    v_mul_f32 v120, v149, v120
    v_fma_f32 v121, -v148, v33, v121
    v_mul_f32 v121, v149, v121
    v_fma_f32 v122, -v148, v34, v122
    v_mul_f32 v122, v149, v122
    v_fma_f32 v123, -v148, v35, v123
    v_mul_f32 v123, v149, v123
    v_fma_f32 v124, -v148, v36, v124
    v_mul_f32 v124, v149, v124
    v_fma_f32 v125, -v148, v37, v125
    v_mul_f32 v125, v149, v125
    v_fma_f32 v126, -v148, v38, v126
    v_mul_f32 v126, v149, v126
    v_fma_f32 v127, -v148, v39, v127
    v_mul_f32 v127, v149, v127
    v_fma_f32 v128, -v148, v40, v128
    v_mul_f32 v128, v149, v128
    v_fma_f32 v129, -v148, v41, v129
    v_mul_f32 v129, v149, v129
    v_fma_f32 v130, -v148, v42, v130
    v_mul_f32 v130, v149, v130
    v_fma_f32 v131, -v148, v43, v131
    v_mul_f32 v131, v149, v131
    v_fma_f32 v132, -v148, v44, v132
    v_mul_f32 v132, v149, v132
    v_fma_f32 v133, -v148, v45, v133
    v_mul_f32 v133, v149, v133
    v_fma_f32 v134, -v148, v46, v134
    v_mul_f32 v134, v149, v134
    v_fma_f32 v135, -v148, v47, v135
    v_mul_f32 v135, v149, v135
    v_fma_f32 v136, -v148, v48, v136
    v_mul_f32 v136, v149, v136
    v_fma_f32 v137, -v148, v49, v137
    v_mul_f32 v137, v149, v137
    v_fma_f32 v138, -v148, v50, v138
    v_mul_f32 v138, v149, v138
    v_fma_f32 v139, -v148, v51, v139
    v_mul_f32 v139, v149, v139
    v_fma_f32 v140, -v148, v52, v140
    v_mul_f32 v140, v149, v140
    v_fma_f32 v141, -v148, v53, v141
    v_mul_f32 v141, v149, v141
    v_fma_f32 v142, -v148, v54, v142
    v_mul_f32 v142, v149, v142
    v_fma_f32 v143, -v148, v55, v143
    v_mul_f32 v143, v149, v143
    v_fma_f32 v144, -v148, v56, v144
    v_mul_f32 v144, v149, v144
    v_fma_f32 v145, -v148, v57, v145
    v_mul_f32 v145, v149, v145
    v_fma_f32 v146, -v148, v58, v146
    v_mul_f32 v146, v149, v146
    v_fma_f32 v147, -v148, v59, v147
    v_mul_f32 v147, v149, v147
    s_lshl_b32 s32, s30, 4
    v_add_u32 v5, s32, v12
    v_mul_u32_u24 v5, 232, v5
    v_lshl_add_u32 v5, v13, 3, v5
    v_cvt_pk_bf16_f32 v120, v120, v121
    v_cvt_pk_bf16_f32 v121, v122, v123
    ds_write_b64 v5, v[120:121] offset:0
    v_cvt_pk_bf16_f32 v124, v124, v125
    v_cvt_pk_bf16_f32 v125, v126, v127
    ds_write_b64 v5, v[124:125] offset:32
    v_cvt_pk_bf16_f32 v128, v128, v129
    v_cvt_pk_bf16_f32 v129, v130, v131
    ds_write_b64 v5, v[128:129] offset:64
    v_cvt_pk_bf16_f32 v132, v132, v133
    v_cvt_pk_bf16_f32 v133, v134, v135
    ds_write_b64 v5, v[132:133] offset:96
    v_cvt_pk_bf16_f32 v136, v136, v137
    v_cvt_pk_bf16_f32 v137, v138, v139
    ds_write_b64 v5, v[136:137] offset:128
    v_cvt_pk_bf16_f32 v140, v140, v141
    v_cvt_pk_bf16_f32 v141, v142, v143
    ds_write_b64 v5, v[140:141] offset:160
    v_cvt_pk_bf16_f32 v144, v144, v145
    v_cvt_pk_bf16_f32 v145, v146, v147
    ds_write_b64 v5, v[144:145] offset:192
    s_waitcnt lgkmcnt(0)
    s_barrier
    s_cmp_eq_u32 s29, 8
    s_cbranch_scc1 .Lend_34
    v_and_b32 v2, 1, v1
    v_bfe_u32 v3, v1, 1, 1
    v_lshrrev_b32 v4, 2, v1
    s_lshl_b32 s32, s29, 4
    v_add_u32 v4, s32, v4
    v_add_u32 v5, 16, v4
    v_mul_u32_u24 v5, 232, v5
    v_mul_u32_u24 v6, 36, v3
    v_add_u32 v5, v5, v6
    v_mul_u32_u24 v6, 1856, v2
    v_sub_u32 v6, v5, v6
    v_subrev_u32 v8, 0, v6
    v_subrev_u32 v9, 464, v6
    v_subrev_u32 v10, 928, v6
    v_subrev_u32 v11, 1392, v6
    ds_read2_b32 v[16:17], v5 offset0:0 offset1:1
    ds_read2_b32 v[18:19], v5 offset0:2 offset1:3
    ds_read2_b32 v[20:21], v5 offset0:4 offset1:5
    ds_read2_b32 v[22:23], v5 offset0:6 offset1:7
    ds_read_b32 v24, v5 offset:32
    ds_read2_b32 v[32:33], v8 offset0:18 offset1:19
    ds_read2_b32 v[34:35], v8 offset0:20 offset1:21
    ds_read2_b32 v[36:37], v8 offset0:22 offset1:23
    ds_read2_b32 v[38:39], v8 offset0:24 offset1:25
    ds_read_b32 v40, v8 offset:104
    ds_read2_b32 v[42:43], v9 offset0:18 offset1:19
    ds_read2_b32 v[44:45], v9 offset0:20 offset1:21
    ds_read2_b32 v[46:47], v9 offset0:22 offset1:23
    ds_read2_b32 v[48:49], v9 offset0:24 offset1:25
    ds_read_b32 v50, v9 offset:104
    ds_read2_b32 v[52:53], v10 offset0:18 offset1:19
    ds_read2_b32 v[54:55], v10 offset0:20 offset1:21
    ds_read2_b32 v[56:57], v10 offset0:22 offset1:23
    ds_read2_b32 v[58:59], v10 offset0:24 offset1:25
    ds_read_b32 v60, v10 offset:104
    ds_read2_b32 v[62:63], v11 offset0:18 offset1:19
    ds_read2_b32 v[64:65], v11 offset0:20 offset1:21
    ds_read2_b32 v[66:67], v11 offset0:22 offset1:23
    ds_read2_b32 v[68:69], v11 offset0:24 offset1:25
    ds_read_b32 v70, v11 offset:104
    s_waitcnt lgkmcnt(0)
    ds_read2_b32 v[72:73], v8 offset0:36 offset1:37
    ds_read2_b32 v[74:75], v8 offset0:38 offset1:39
    ds_read2_b32 v[76:77], v8 offset0:40 offset1:41
    ds_read2_b32 v[78:79], v8 offset0:42 offset1:43
    ds_read_b32 v80, v8 offset:176
    ds_read2_b32 v[82:83], v9 offset0:36 offset1:37
    ds_read2_b32 v[84:85], v9 offset0:38 offset1:39
    ds_read2_b32 v[86:87], v9 offset0:40 offset1:41
    ds_read2_b32 v[88:89], v9 offset0:42 offset1:43
    ds_read_b32 v90, v9 offset:176
    ds_read2_b32 v[92:93], v10 offset0:36 offset1:37
    ds_read2_b32 v[94:95], v10 offset0:38 offset1:39
    ds_read2_b32 v[96:97], v10 offset0:40 offset1:41
    ds_read2_b32 v[98:99], v10 offset0:42 offset1:43
    ds_read_b32 v100, v10 offset:176
    ds_read2_b32 v[102:103], v11 offset0:36 offset1:37
    ds_read2_b32 v[104:105], v11 offset0:38 offset1:39
    ds_read2_b32 v[106:107], v11 offset0:40 offset1:41
    ds_read2_b32 v[108:109], v11 offset0:42 offset1:43
    ds_read_b32 v110, v11 offset:176
    v_mov_b32 v132, 0
    v_mov_b32 v133, 0
    v_mov_b32 v134, 0
    v_mov_b32 v135, 0
    v_dot2_f32_bf16 v132, v16, v32, v132
    v_dot2_f32_bf16 v133, v16, v42, v133
    v_dot2_f32_bf16 v134, v16, v52, v134
    v_dot2_f32_bf16 v135, v16, v62, v135
    v_dot2_f32_bf16 v132, v17, v33, v132
    v_dot2_f32_bf16 v133, v17, v43, v133
    v_dot2_f32_bf16 v134, v17, v53, v134
    v_dot2_f32_bf16 v135, v17, v63, v135
    v_dot2_f32_bf16 v132, v18, v34, v132
    v_dot2_f32_bf16 v133, v18, v44, v133
    v_dot2_f32_bf16 v134, v18, v54, v134
    v_dot2_f32_bf16 v135, v18, v64, v135
    v_dot2_f32_bf16 v132, v19, v35, v132
    v_dot2_f32_bf16 v133, v19, v45, v133
    v_dot2_f32_bf16 v134, v19, v55, v134
    v_dot2_f32_bf16 v135, v19, v65, v135
    v_dot2_f32_bf16 v132, v20, v36, v132
    v_dot2_f32_bf16 v133, v20, v46, v133
    v_dot2_f32_bf16 v134, v20, v56, v134
    v_dot2_f32_bf16 v135, v20, v66, v135
    v_dot2_f32_bf16 v132, v21, v37, v132
    v_dot2_f32_bf16 v133, v21, v47, v133
    v_dot2_f32_bf16 v134, v21, v57, v134
    v_dot2_f32_bf16 v135, v21, v67, v135
    v_dot2_f32_bf16 v132, v22, v38, v132
    v_dot2_f32_bf16 v133, v22, v48, v133
    v_dot2_f32_bf16 v134, v22, v58, v134
    v_dot2_f32_bf16 v135, v22, v68, v135
    v_dot2_f32_bf16 v132, v23, v39, v132
    v_dot2_f32_bf16 v133, v23, v49, v133
    v_dot2_f32_bf16 v134, v23, v59, v134
    v_dot2_f32_bf16 v135, v23, v69, v135
    v_dot2_f32_bf16 v132, v24, v40, v132
    v_dot2_f32_bf16 v133, v24, v50, v133
    v_dot2_f32_bf16 v134, v24, v60, v134
    v_dot2_f32_bf16 v135, v24, v70, v135
    s_nop 3
    s_mov_b32 s35, 0x3e715bef
    s_lshl_b32 s36, s3, 7
    v_add_u32 v7, s36, v4
    v_lshlrev_b32 v13, 3, v2
    v_mov_b32 v14, 0xce6e6b28
    v_cvt_pk_bf16_f32 v132, v132, v132
    v_lshlrev_b32 v132, 16, v132
    v_mul_f32 v132, s35, v132
    v_cvt_pk_bf16_f32 v132, v132, v132
    v_lshlrev_b32 v132, 16, v132
    v_add_u32 v12, 0, v13
    v_cmp_ge_u32 vcc, v7, v12
    s_nop 1
    v_cndmask_b32 v132, v14, v132, vcc
    v_cvt_pk_bf16_f32 v133, v133, v133
    v_lshlrev_b32 v133, 16, v133
    v_mul_f32 v133, s35, v133
    v_cvt_pk_bf16_f32 v133, v133, v133
    v_lshlrev_b32 v133, 16, v133
    v_add_u32 v12, 2, v13
    v_cmp_ge_u32 vcc, v7, v12
    s_nop 1
    v_cndmask_b32 v133, v14, v133, vcc
    v_cvt_pk_bf16_f32 v134, v134, v134
    v_lshlrev_b32 v134, 16, v134
    v_mul_f32 v134, s35, v134
    v_cvt_pk_bf16_f32 v134, v134, v134
    v_lshlrev_b32 v134, 16, v134
    v_add_u32 v12, 4, v13
    v_cmp_ge_u32 vcc, v7, v12
    s_nop 1
    v_cndmask_b32 v134, v14, v134, vcc
    v_cvt_pk_bf16_f32 v135, v135, v135
    v_lshlrev_b32 v135, 16, v135
    v_mul_f32 v135, s35, v135
    v_cvt_pk_bf16_f32 v135, v135, v135
    v_lshlrev_b32 v135, 16, v135
    v_add_u32 v12, 6, v13
    v_cmp_ge_u32 vcc, v7, v12
    s_nop 1
    v_cndmask_b32 v135, v14, v135, vcc
    v_max3_f32 v12, v132, v133, v134
    v_max_f32 v12, v12, v135
    s_nop 1
    v_max_f32_dpp v12, v12, v12 quad_perm:[1,0,3,2] row_mask:0xf bank_mask:0xf
    s_mov_b32 s35, 0x3fb8aa3b
    v_sub_f32 v132, v132, v12
    v_mul_f32 v132, s35, v132
    v_exp_f32 v132, v132
    v_sub_f32 v133, v133, v12
    v_mul_f32 v133, s35, v133
    v_exp_f32 v133, v133
    v_sub_f32 v134, v134, v12
    v_mul_f32 v134, s35, v134
    v_exp_f32 v134, v134
    v_sub_f32 v135, v135, v12
    v_mul_f32 v135, s35, v135
    v_exp_f32 v135, v135
    s_nop 0
    v_add_f32 v13, v132, v133
    v_add_f32 v14, v134, v135
    v_add_f32 v13, v13, v14
    s_nop 1
    v_add_f32_dpp v13, v13, v13 quad_perm:[1,0,3,2] row_mask:0xf bank_mask:0xf
    v_rcp_f32 v13, v13
    s_nop 0
    v_mul_f32 v132, v132, v13
    v_cvt_pk_bf16_f32 v132, v132, v132
    v_lshlrev_b32 v132, 16, v132
    v_mul_f32 v133, v133, v13
    v_cvt_pk_bf16_f32 v133, v133, v133
    v_lshlrev_b32 v133, 16, v133
    v_mul_f32 v134, v134, v13
    v_cvt_pk_bf16_f32 v134, v134, v134
    v_lshlrev_b32 v134, 16, v134
    v_mul_f32 v135, v135, v13
    v_cvt_pk_bf16_f32 v135, v135, v135
    v_lshlrev_b32 v135, 16, v135
    s_mov_b32 s35, 0xffff0000
    s_waitcnt lgkmcnt(0)
    v_lshlrev_b32 v12, 16, v72
    v_and_b32 v13, s35, v72
    v_mul_f32 v112, v12, v132
    v_mul_f32 v113, v13, v132
    v_lshlrev_b32 v12, 16, v73
    v_and_b32 v13, s35, v73
    v_mul_f32 v114, v12, v132
    v_mul_f32 v115, v13, v132
    v_lshlrev_b32 v12, 16, v74
    v_and_b32 v13, s35, v74
    v_mul_f32 v116, v12, v132
    v_mul_f32 v117, v13, v132
    v_lshlrev_b32 v12, 16, v75
    v_and_b32 v13, s35, v75
    v_mul_f32 v118, v12, v132
    v_mul_f32 v119, v13, v132
    v_lshlrev_b32 v12, 16, v76
    v_and_b32 v13, s35, v76
    v_mul_f32 v120, v12, v132
    v_mul_f32 v121, v13, v132
    v_lshlrev_b32 v12, 16, v77
    v_and_b32 v13, s35, v77
    v_mul_f32 v122, v12, v132
    v_mul_f32 v123, v13, v132
    v_lshlrev_b32 v12, 16, v78
    v_and_b32 v13, s35, v78
    v_mul_f32 v124, v12, v132
    v_mul_f32 v125, v13, v132
    v_lshlrev_b32 v12, 16, v79
    v_and_b32 v13, s35, v79
    v_mul_f32 v126, v12, v132
    v_mul_f32 v127, v13, v132
    v_lshlrev_b32 v12, 16, v80
    v_and_b32 v13, s35, v80
    v_mul_f32 v128, v12, v132
    v_mul_f32 v129, v13, v132
    v_lshlrev_b32 v12, 16, v82
    v_and_b32 v13, s35, v82
    v_fmac_f32 v112, v12, v133
    v_fmac_f32 v113, v13, v133
    v_lshlrev_b32 v12, 16, v83
    v_and_b32 v13, s35, v83
    v_fmac_f32 v114, v12, v133
    v_fmac_f32 v115, v13, v133
    v_lshlrev_b32 v12, 16, v84
    v_and_b32 v13, s35, v84
    v_fmac_f32 v116, v12, v133
    v_fmac_f32 v117, v13, v133
    v_lshlrev_b32 v12, 16, v85
    v_and_b32 v13, s35, v85
    v_fmac_f32 v118, v12, v133
    v_fmac_f32 v119, v13, v133
    v_lshlrev_b32 v12, 16, v86
    v_and_b32 v13, s35, v86
    v_fmac_f32 v120, v12, v133
    v_fmac_f32 v121, v13, v133
    v_lshlrev_b32 v12, 16, v87
    v_and_b32 v13, s35, v87
    v_fmac_f32 v122, v12, v133
    v_fmac_f32 v123, v13, v133
    v_lshlrev_b32 v12, 16, v88
    v_and_b32 v13, s35, v88
    v_fmac_f32 v124, v12, v133
    v_fmac_f32 v125, v13, v133
    v_lshlrev_b32 v12, 16, v89
    v_and_b32 v13, s35, v89
    v_fmac_f32 v126, v12, v133
    v_fmac_f32 v127, v13, v133
    v_lshlrev_b32 v12, 16, v90
    v_and_b32 v13, s35, v90
    v_fmac_f32 v128, v12, v133
    v_fmac_f32 v129, v13, v133
    v_lshlrev_b32 v12, 16, v92
    v_and_b32 v13, s35, v92
    v_fmac_f32 v112, v12, v134
    v_fmac_f32 v113, v13, v134
    v_lshlrev_b32 v12, 16, v93
    v_and_b32 v13, s35, v93
    v_fmac_f32 v114, v12, v134
    v_fmac_f32 v115, v13, v134
    v_lshlrev_b32 v12, 16, v94
    v_and_b32 v13, s35, v94
    v_fmac_f32 v116, v12, v134
    v_fmac_f32 v117, v13, v134
    v_lshlrev_b32 v12, 16, v95
    v_and_b32 v13, s35, v95
    v_fmac_f32 v118, v12, v134
    v_fmac_f32 v119, v13, v134
    v_lshlrev_b32 v12, 16, v96
    v_and_b32 v13, s35, v96
    v_fmac_f32 v120, v12, v134
    v_fmac_f32 v121, v13, v134
    v_lshlrev_b32 v12, 16, v97
    v_and_b32 v13, s35, v97
    v_fmac_f32 v122, v12, v134
    v_fmac_f32 v123, v13, v134
    v_lshlrev_b32 v12, 16, v98
    v_and_b32 v13, s35, v98
    v_fmac_f32 v124, v12, v134
    v_fmac_f32 v125, v13, v134
    v_lshlrev_b32 v12, 16, v99
    v_and_b32 v13, s35, v99
    v_fmac_f32 v126, v12, v134
    v_fmac_f32 v127, v13, v134
    v_lshlrev_b32 v12, 16, v100
    v_and_b32 v13, s35, v100
    v_fmac_f32 v128, v12, v134
    v_fmac_f32 v129, v13, v134
    v_lshlrev_b32 v12, 16, v102
    v_and_b32 v13, s35, v102
    v_fmac_f32 v112, v12, v135
    v_fmac_f32 v113, v13, v135
    v_lshlrev_b32 v12, 16, v103
    v_and_b32 v13, s35, v103
    v_fmac_f32 v114, v12, v135
    v_fmac_f32 v115, v13, v135
    v_lshlrev_b32 v12, 16, v104
    v_and_b32 v13, s35, v104
    v_fmac_f32 v116, v12, v135
    v_fmac_f32 v117, v13, v135
    v_lshlrev_b32 v12, 16, v105
    v_and_b32 v13, s35, v105
    v_fmac_f32 v118, v12, v135
    v_fmac_f32 v119, v13, v135
    v_lshlrev_b32 v12, 16, v106
    v_and_b32 v13, s35, v106
    v_fmac_f32 v120, v12, v135
    v_fmac_f32 v121, v13, v135
    v_lshlrev_b32 v12, 16, v107
    v_and_b32 v13, s35, v107
    v_fmac_f32 v122, v12, v135
    v_fmac_f32 v123, v13, v135
    v_lshlrev_b32 v12, 16, v108
    v_and_b32 v13, s35, v108
    v_fmac_f32 v124, v12, v135
    v_fmac_f32 v125, v13, v135
    v_lshlrev_b32 v12, 16, v109
    v_and_b32 v13, s35, v109
    v_fmac_f32 v126, v12, v135
    v_fmac_f32 v127, v13, v135
    v_lshlrev_b32 v12, 16, v110
    v_and_b32 v13, s35, v110
    v_fmac_f32 v128, v12, v135
    v_fmac_f32 v129, v13, v135
    s_nop 1
    v_add_f32_dpp v112, v112, v112 quad_perm:[1,0,3,2] row_mask:0xf bank_mask:0xf
    v_add_f32_dpp v113, v113, v113 quad_perm:[1,0,3,2] row_mask:0xf bank_mask:0xf
    v_add_f32_dpp v114, v114, v114 quad_perm:[1,0,3,2] row_mask:0xf bank_mask:0xf
    v_add_f32_dpp v115, v115, v115 quad_perm:[1,0,3,2] row_mask:0xf bank_mask:0xf
    v_add_f32_dpp v116, v116, v116 quad_perm:[1,0,3,2] row_mask:0xf bank_mask:0xf
    v_add_f32_dpp v117, v117, v117 quad_perm:[1,0,3,2] row_mask:0xf bank_mask:0xf
    v_add_f32_dpp v118, v118, v118 quad_perm:[1,0,3,2] row_mask:0xf bank_mask:0xf
    v_add_f32_dpp v119, v119, v119 quad_perm:[1,0,3,2] row_mask:0xf bank_mask:0xf
    v_add_f32_dpp v120, v120, v120 quad_perm:[1,0,3,2] row_mask:0xf bank_mask:0xf
    v_add_f32_dpp v121, v121, v121 quad_perm:[1,0,3,2] row_mask:0xf bank_mask:0xf
    v_add_f32_dpp v122, v122, v122 quad_perm:[1,0,3,2] row_mask:0xf bank_mask:0xf
    v_add_f32_dpp v123, v123, v123 quad_perm:[1,0,3,2] row_mask:0xf bank_mask:0xf
    v_add_f32_dpp v124, v124, v124 quad_perm:[1,0,3,2] row_mask:0xf bank_mask:0xf
    v_add_f32_dpp v125, v125, v125 quad_perm:[1,0,3,2] row_mask:0xf bank_mask:0xf
    v_add_f32_dpp v126, v126, v126 quad_perm:[1,0,3,2] row_mask:0xf bank_mask:0xf
    v_add_f32_dpp v127, v127, v127 quad_perm:[1,0,3,2] row_mask:0xf bank_mask:0xf
    v_add_f32_dpp v128, v128, v128 quad_perm:[1,0,3,2] row_mask:0xf bank_mask:0xf
    v_add_f32_dpp v129, v129, v129 quad_perm:[1,0,3,2] row_mask:0xf bank_mask:0xf
    v_cvt_pk_bf16_f32 v16, v112, v113
    v_cvt_pk_bf16_f32 v17, v114, v115
    v_cvt_pk_bf16_f32 v18, v116, v117
    v_cvt_pk_bf16_f32 v19, v118, v119
    v_cvt_pk_bf16_f32 v20, v120, v121
    v_cvt_pk_bf16_f32 v21, v122, v123
    v_cvt_pk_bf16_f32 v22, v124, v125
    v_cvt_pk_bf16_f32 v23, v126, v127
    v_cvt_pk_bf16_f32 v24, v128, v129
    v_lshrrev_b32 v12, 4, v7
    v_mul_u32_u24 v12, 18432, v12
    v_and_b32 v13, 15, v7
    v_lshl_add_u32 v12, v13, 4, v12
    s_mul_i32 s33, s28, 36
    v_mul_u32_u24 v13, 18, v3
    v_add_u32 v13, s33, v13
    v_cmp_eq_u32 vcc, 0, v2
    s_and_saveexec_b64 s[38:39], vcc
    v_add_u32 v14, 0, v13
    v_lshrrev_b32 v15, 3, v14
    v_and_b32 v14, 7, v14
    v_lshl_add_u32 v14, v14, 1, v12
    v_lshl_add_u32 v14, v15, 8, v14
    buffer_store_dword v16, v14, s[20:23], 0 offen
    v_add_u32 v14, 2, v13
    v_lshrrev_b32 v15, 3, v14
    v_and_b32 v14, 7, v14
    v_lshl_add_u32 v14, v14, 1, v12
    v_lshl_add_u32 v14, v15, 8, v14
    buffer_store_dword v17, v14, s[20:23], 0 offen
    v_add_u32 v14, 4, v13
    v_lshrrev_b32 v15, 3, v14
    v_and_b32 v14, 7, v14
    v_lshl_add_u32 v14, v14, 1, v12
    v_lshl_add_u32 v14, v15, 8, v14
    buffer_store_dword v18, v14, s[20:23], 0 offen
    v_add_u32 v14, 6, v13
    v_lshrrev_b32 v15, 3, v14
    v_and_b32 v14, 7, v14
    v_lshl_add_u32 v14, v14, 1, v12
    v_lshl_add_u32 v14, v15, 8, v14
    buffer_store_dword v19, v14, s[20:23], 0 offen
    v_add_u32 v14, 8, v13
    v_lshrrev_b32 v15, 3, v14
    v_and_b32 v14, 7, v14
    v_lshl_add_u32 v14, v14, 1, v12
    v_lshl_add_u32 v14, v15, 8, v14
    buffer_store_dword v20, v14, s[20:23], 0 offen
    v_add_u32 v14, 10, v13
    v_lshrrev_b32 v15, 3, v14
    v_and_b32 v14, 7, v14
    v_lshl_add_u32 v14, v14, 1, v12
    v_lshl_add_u32 v14, v15, 8, v14
    buffer_store_dword v21, v14, s[20:23], 0 offen
    v_add_u32 v14, 12, v13
    v_lshrrev_b32 v15, 3, v14
    v_and_b32 v14, 7, v14
    v_lshl_add_u32 v14, v14, 1, v12
    v_lshl_add_u32 v14, v15, 8, v14
    buffer_store_dword v22, v14, s[20:23], 0 offen
    v_add_u32 v14, 14, v13
    v_lshrrev_b32 v15, 3, v14
    v_and_b32 v14, 7, v14
    v_lshl_add_u32 v14, v14, 1, v12
    v_lshl_add_u32 v14, v15, 8, v14
    buffer_store_dword v23, v14, s[20:23], 0 offen
    v_add_u32 v14, 16, v13
    v_lshrrev_b32 v15, 3, v14
    v_and_b32 v14, 7, v14
    v_lshl_add_u32 v14, v14, 1, v12
    v_lshl_add_u32 v14, v15, 8, v14
    buffer_store_dword v24, v14, s[20:23], 0 offen
    s_mov_b64 exec, -1
.Lend_34:
    s_endpgm
.section .rodata,"a"
.p2align 6
.amdhsa_kernel qkvb1_kernel
  .amdhsa_next_free_vgpr 160
  .amdhsa_next_free_sgpr 100
  .amdhsa_accum_offset 160
  .amdhsa_group_segment_fixed_size 0
  .amdhsa_kernarg_size 88
  .amdhsa_user_sgpr_count 2
  .amdhsa_user_sgpr_kernarg_segment_ptr 1
  .amdhsa_system_sgpr_workgroup_id_x 1
.end_amdhsa_kernel
.text
.globl outb1_kernel
.p2align 8
.type outb1_kernel,@function
outb1_kernel:
    s_cmp_ge_u32 s2, 192
    s_cbranch_scc1 .Lend_37
    s_load_dwordx2 s[4:5], s[0:1], 80
    s_lshr_b32 s28, s2, 3
    s_mul_i32 s3, s28, 43691
    s_lshr_b32 s3, s3, 18
    s_mul_i32 s29, s3, 6
    s_sub_u32 s28, s28, s29
    s_and_b32 s29, s2, 7
    s_lshl_b32 s29, s29, 2
    s_add_u32 s3, s3, s29
    v_and_b32 v1, 63, v0
    v_lshrrev_b32 v11, 6, v0
    s_nop 0
    v_readfirstlane_b32 s29, v11
    v_and_b32 v12, 15, v1
    v_lshrrev_b32 v13, 4, v1
    v_lshlrev_b32 v4, 4, v1
    s_lshl_b32 s30, s3, 2
    s_add_u32 s30, s30, s29
    s_mul_i32 s31, s30, 18432
    v_add_u32 v2, s31, v4
    s_mov_b32 s41, 4096
    s_mov_b32 s42, 8192
    s_mov_b32 s43, 12288
    s_mov_b32 s44, 16384
    s_mov_b32 s40, 0
    s_waitcnt lgkmcnt(0)
    s_add_u32 s12, s4, 0x900000
    s_addc_u32 s13, s5, 0
    s_mov_b32 s14, 0x240000
    s_mov_b32 s15, 0x00020000
    s_lshl_b32 s34, s29, 10
    s_add_u32 s16, s4, 0x1144000
    s_addc_u32 s17, s5, 0
    s_mov_b32 s18, 0xa2000
    s_mov_b32 s19, 0x00020000
    s_mul_i32 s33, s28, 110592
    s_add_u32 s33, s33, s34
    buffer_load_dwordx4 v[16:19], v2, s[12:15], s40 offen offset:0
    buffer_load_dwordx4 v[20:23], v2, s[12:15], s40 offen offset:1024
    s_add_u32 m0, s34, 0
    s_add_u32 s35, s33, 0
    buffer_load_dwordx4 v4, s[16:19], s35 offen lds
    s_add_u32 m0, s34, 4096
    s_add_u32 s35, s33, 4096
    buffer_load_dwordx4 v4, s[16:19], s35 offen lds
    s_add_u32 m0, s34, 8192
    s_add_u32 s35, s33, 8192
    buffer_load_dwordx4 v4, s[16:19], s35 offen lds
    buffer_load_dwordx4 v[24:27], v2, s[12:15], s40 offen offset:2048
    buffer_load_dwordx4 v[28:31], v2, s[12:15], s40 offen offset:3072
    s_add_u32 m0, s34, 12288
    s_add_u32 s35, s33, 12288
    buffer_load_dwordx4 v4, s[16:19], s35 offen lds
    s_add_u32 m0, s34, 16384
    s_add_u32 s35, s33, 16384
    buffer_load_dwordx4 v4, s[16:19], s35 offen lds
    s_add_u32 m0, s34, 20480
    s_add_u32 s35, s33, 20480
    buffer_load_dwordx4 v4, s[16:19], s35 offen lds
    buffer_load_dwordx4 v[32:35], v2, s[12:15], s41 offen offset:0
    buffer_load_dwordx4 v[36:39], v2, s[12:15], s41 offen offset:1024
    s_add_u32 m0, s34, 24576
    s_add_u32 s35, s33, 24576
    buffer_load_dwordx4 v4, s[16:19], s35 offen lds
    s_add_u32 m0, s34, 28672
    s_add_u32 s35, s33, 28672
    buffer_load_dwordx4 v4, s[16:19], s35 offen lds
    s_add_u32 m0, s34, 32768
    s_add_u32 s35, s33, 32768
    buffer_load_dwordx4 v4, s[16:19], s35 offen lds
    v_add_u32 v5, 55296, v4
    v_mov_b32 v136, 0
    v_mov_b32 v137, 0
    v_mov_b32 v138, 0
    v_mov_b32 v139, 0
    v_mov_b32 v140, 0
    v_mov_b32 v141, 0
    v_mov_b32 v142, 0
    v_mov_b32 v143, 0
    v_mov_b32 v144, 0
    v_mov_b32 v145, 0
    v_mov_b32 v146, 0
    v_mov_b32 v147, 0
    v_mov_b32 v148, 0
    v_mov_b32 v149, 0
    v_mov_b32 v150, 0
    v_mov_b32 v151, 0
    v_mov_b32 v152, 0
    v_mov_b32 v153, 0
    v_mov_b32 v154, 0
    v_mov_b32 v155, 0
    v_mov_b32 v156, 0
    v_mov_b32 v157, 0
    v_mov_b32 v158, 0
    v_mov_b32 v159, 0
    s_waitcnt vmcnt(10)
    s_barrier
    ds_read_b128 v[88:91], v4 offset:0
    ds_read_b128 v[92:95], v4 offset:1024
    ds_read_b128 v[96:99], v4 offset:2048
    ds_read_b128 v[100:103], v4 offset:3072
    ds_read_b128 v[104:107], v4 offset:4096
    ds_read_b128 v[108:111], v4 offset:5120
    ds_read_b128 v[112:115], v4 offset:6144
    ds_read_b128 v[116:119], v4 offset:7168
    ds_read_b128 v[120:123], v4 offset:8192
    ds_read_b128 v[124:127], v4 offset:9216
    ds_read_b128 v[128:131], v4 offset:10240
    ds_read_b128 v[132:135], v4 offset:11264
    buffer_load_dwordx4 v[40:43], v2, s[12:15], s41 offen offset:2048
    buffer_load_dwordx4 v[44:47], v2, s[12:15], s41 offen offset:3072
    s_add_u32 m0, s34, 36864
    s_add_u32 s35, s33, 36864
    buffer_load_dwordx4 v4, s[16:19], s35 offen lds
    s_add_u32 m0, s34, 40960
    s_add_u32 s35, s33, 40960
    buffer_load_dwordx4 v4, s[16:19], s35 offen lds
    s_add_u32 m0, s34, 45056
    s_add_u32 s35, s33, 45056
    buffer_load_dwordx4 v4, s[16:19], s35 offen lds
    s_waitcnt lgkmcnt(6)
    v_mfma_f32_16x16x32_bf16 v[136:139], v[88:91], v[16:19], v[136:139]
    v_mfma_f32_16x16x32_bf16 v[140:143], v[92:95], v[16:19], v[140:143]
    v_mfma_f32_16x16x32_bf16 v[144:147], v[96:99], v[16:19], v[144:147]
    v_mfma_f32_16x16x32_bf16 v[148:151], v[100:103], v[16:19], v[148:151]
    v_mfma_f32_16x16x32_bf16 v[152:155], v[104:107], v[16:19], v[152:155]
    v_mfma_f32_16x16x32_bf16 v[156:159], v[108:111], v[16:19], v[156:159]
    s_waitcnt lgkmcnt(0)
    s_waitcnt vmcnt(10)
    s_barrier
    ds_read_b128 v[88:91], v4 offset:12288
    ds_read_b128 v[92:95], v4 offset:13312
    ds_read_b128 v[96:99], v4 offset:14336
    ds_read_b128 v[100:103], v4 offset:15360
    ds_read_b128 v[104:107], v4 offset:16384
    ds_read_b128 v[108:111], v4 offset:17408
    v_mfma_f32_16x16x32_bf16 v[136:139], v[112:115], v[20:23], v[136:139]
    v_mfma_f32_16x16x32_bf16 v[140:143], v[116:119], v[20:23], v[140:143]
    v_mfma_f32_16x16x32_bf16 v[144:147], v[120:123], v[20:23], v[144:147]
    v_mfma_f32_16x16x32_bf16 v[148:151], v[124:127], v[20:23], v[148:151]
    v_mfma_f32_16x16x32_bf16 v[152:155], v[128:131], v[20:23], v[152:155]
    v_mfma_f32_16x16x32_bf16 v[156:159], v[132:135], v[20:23], v[156:159]
    ds_read_b128 v[112:115], v4 offset:18432
    ds_read_b128 v[116:119], v4 offset:19456
    ds_read_b128 v[120:123], v4 offset:20480
    ds_read_b128 v[124:127], v4 offset:21504
    ds_read_b128 v[128:131], v4 offset:22528
    ds_read_b128 v[132:135], v4 offset:23552
    buffer_load_dwordx4 v[48:51], v2, s[12:15], s42 offen offset:0
    buffer_load_dwordx4 v[52:55], v2, s[12:15], s42 offen offset:1024
    s_add_u32 m0, s34, 49152
    s_add_u32 s35, s33, 49152
    buffer_load_dwordx4 v4, s[16:19], s35 offen lds
    s_add_u32 m0, s34, 53248
    s_add_u32 s35, s33, 53248
    buffer_load_dwordx4 v4, s[16:19], s35 offen lds
    s_add_u32 m0, s34, 57344
    s_add_u32 s35, s33, 57344
    buffer_load_dwordx4 v4, s[16:19], s35 offen lds
    s_waitcnt lgkmcnt(6)
    v_mfma_f32_16x16x32_bf16 v[136:139], v[88:91], v[24:27], v[136:139]
    v_mfma_f32_16x16x32_bf16 v[140:143], v[92:95], v[24:27], v[140:143]
    v_mfma_f32_16x16x32_bf16 v[144:147], v[96:99], v[24:27], v[144:147]
    v_mfma_f32_16x16x32_bf16 v[148:151], v[100:103], v[24:27], v[148:151]
    v_mfma_f32_16x16x32_bf16 v[152:155], v[104:107], v[24:27], v[152:155]
    v_mfma_f32_16x16x32_bf16 v[156:159], v[108:111], v[24:27], v[156:159]
    s_waitcnt lgkmcnt(0)
    s_waitcnt vmcnt(10)
    s_barrier
    ds_read_b128 v[88:91], v4 offset:24576
    ds_read_b128 v[92:95], v4 offset:25600
    ds_read_b128 v[96:99], v4 offset:26624
    ds_read_b128 v[100:103], v4 offset:27648
    ds_read_b128 v[104:107], v4 offset:28672
    ds_read_b128 v[108:111], v4 offset:29696
    v_mfma_f32_16x16x32_bf16 v[136:139], v[112:115], v[28:31], v[136:139]
    v_mfma_f32_16x16x32_bf16 v[140:143], v[116:119], v[28:31], v[140:143]
    v_mfma_f32_16x16x32_bf16 v[144:147], v[120:123], v[28:31], v[144:147]
    v_mfma_f32_16x16x32_bf16 v[148:151], v[124:127], v[28:31], v[148:151]
    v_mfma_f32_16x16x32_bf16 v[152:155], v[128:131], v[28:31], v[152:155]
    v_mfma_f32_16x16x32_bf16 v[156:159], v[132:135], v[28:31], v[156:159]
    ds_read_b128 v[112:115], v4 offset:30720
    ds_read_b128 v[116:119], v4 offset:31744
    ds_read_b128 v[120:123], v4 offset:32768
    ds_read_b128 v[124:127], v4 offset:33792
    ds_read_b128 v[128:131], v4 offset:34816
    ds_read_b128 v[132:135], v4 offset:35840
    buffer_load_dwordx4 v[56:59], v2, s[12:15], s42 offen offset:2048
    buffer_load_dwordx4 v[60:63], v2, s[12:15], s42 offen offset:3072
    s_add_u32 m0, s34, 61440
    s_add_u32 s35, s33, 61440
    buffer_load_dwordx4 v4, s[16:19], s35 offen lds
    s_add_u32 m0, s34, 65536
    s_add_u32 s35, s33, 65536
    buffer_load_dwordx4 v4, s[16:19], s35 offen lds
    s_add_u32 m0, s34, 69632
    s_add_u32 s35, s33, 69632
    buffer_load_dwordx4 v4, s[16:19], s35 offen lds
    s_waitcnt lgkmcnt(6)
    v_mfma_f32_16x16x32_bf16 v[136:139], v[88:91], v[32:35], v[136:139]
    v_mfma_f32_16x16x32_bf16 v[140:143], v[92:95], v[32:35], v[140:143]
    v_mfma_f32_16x16x32_bf16 v[144:147], v[96:99], v[32:35], v[144:147]
    v_mfma_f32_16x16x32_bf16 v[148:151], v[100:103], v[32:35], v[148:151]
    v_mfma_f32_16x16x32_bf16 v[152:155], v[104:107], v[32:35], v[152:155]
    v_mfma_f32_16x16x32_bf16 v[156:159], v[108:111], v[32:35], v[156:159]
    s_waitcnt lgkmcnt(0)
    s_waitcnt vmcnt(10)
    s_barrier
    ds_read_b128 v[88:91], v4 offset:36864
    ds_read_b128 v[92:95], v4 offset:37888
    ds_read_b128 v[96:99], v4 offset:38912
    ds_read_b128 v[100:103], v4 offset:39936
    ds_read_b128 v[104:107], v4 offset:40960
    ds_read_b128 v[108:111], v4 offset:41984
    v_mfma_f32_16x16x32_bf16 v[136:139], v[112:115], v[36:39], v[136:139]
    v_mfma_f32_16x16x32_bf16 v[140:143], v[116:119], v[36:39], v[140:143]
    v_mfma_f32_16x16x32_bf16 v[144:147], v[120:123], v[36:39], v[144:147]
    v_mfma_f32_16x16x32_bf16 v[148:151], v[124:127], v[36:39], v[148:151]
    v_mfma_f32_16x16x32_bf16 v[152:155], v[128:131], v[36:39], v[152:155]
    v_mfma_f32_16x16x32_bf16 v[156:159], v[132:135], v[36:39], v[156:159]
    ds_read_b128 v[112:115], v4 offset:43008
    ds_read_b128 v[116:119], v4 offset:44032
    ds_read_b128 v[120:123], v4 offset:45056
    ds_read_b128 v[124:127], v4 offset:46080
    ds_read_b128 v[128:131], v4 offset:47104
    ds_read_b128 v[132:135], v4 offset:48128
    buffer_load_dwordx4 v[64:67], v2, s[12:15], s43 offen offset:0
    buffer_load_dwordx4 v[68:71], v2, s[12:15], s43 offen offset:1024
    s_add_u32 m0, s34, 73728
    s_add_u32 s35, s33, 73728
    buffer_load_dwordx4 v4, s[16:19], s35 offen lds
    s_add_u32 m0, s34, 77824
    s_add_u32 s35, s33, 77824
    buffer_load_dwordx4 v4, s[16:19], s35 offen lds
    s_add_u32 m0, s34, 81920
    s_add_u32 s35, s33, 81920
    buffer_load_dwordx4 v4, s[16:19], s35 offen lds
    s_waitcnt lgkmcnt(6)
    v_mfma_f32_16x16x32_bf16 v[136:139], v[88:91], v[40:43], v[136:139]
    v_mfma_f32_16x16x32_bf16 v[140:143], v[92:95], v[40:43], v[140:143]
    v_mfma_f32_16x16x32_bf16 v[144:147], v[96:99], v[40:43], v[144:147]
    v_mfma_f32_16x16x32_bf16 v[148:151], v[100:103], v[40:43], v[148:151]
    v_mfma_f32_16x16x32_bf16 v[152:155], v[104:107], v[40:43], v[152:155]
    v_mfma_f32_16x16x32_bf16 v[156:159], v[108:111], v[40:43], v[156:159]
    s_waitcnt lgkmcnt(0)
    s_waitcnt vmcnt(10)
    s_barrier
    ds_read_b128 v[88:91], v4 offset:49152
    ds_read_b128 v[92:95], v4 offset:50176
    ds_read_b128 v[96:99], v4 offset:51200
    ds_read_b128 v[100:103], v4 offset:52224
    ds_read_b128 v[104:107], v4 offset:53248
    ds_read_b128 v[108:111], v4 offset:54272
    v_mfma_f32_16x16x32_bf16 v[136:139], v[112:115], v[44:47], v[136:139]
    v_mfma_f32_16x16x32_bf16 v[140:143], v[116:119], v[44:47], v[140:143]
    v_mfma_f32_16x16x32_bf16 v[144:147], v[120:123], v[44:47], v[144:147]
    v_mfma_f32_16x16x32_bf16 v[148:151], v[124:127], v[44:47], v[148:151]
    v_mfma_f32_16x16x32_bf16 v[152:155], v[128:131], v[44:47], v[152:155]
    v_mfma_f32_16x16x32_bf16 v[156:159], v[132:135], v[44:47], v[156:159]
    ds_read_b128 v[112:115], v5 offset:0
    ds_read_b128 v[116:119], v5 offset:1024
    ds_read_b128 v[120:123], v5 offset:2048
    ds_read_b128 v[124:127], v5 offset:3072
    ds_read_b128 v[128:131], v5 offset:4096
    ds_read_b128 v[132:135], v5 offset:5120
    buffer_load_dwordx4 v[72:75], v2, s[12:15], s43 offen offset:2048
    buffer_load_dwordx4 v[76:79], v2, s[12:15], s43 offen offset:3072
    s_add_u32 m0, s34, 86016
    s_add_u32 s35, s33, 86016
    buffer_load_dwordx4 v4, s[16:19], s35 offen lds
    s_add_u32 m0, s34, 90112
    s_add_u32 s35, s33, 90112
    buffer_load_dwordx4 v4, s[16:19], s35 offen lds
    s_add_u32 m0, s34, 94208
    s_add_u32 s35, s33, 94208
    buffer_load_dwordx4 v4, s[16:19], s35 offen lds
    s_waitcnt lgkmcnt(6)
    v_mfma_f32_16x16x32_bf16 v[136:139], v[88:91], v[48:51], v[136:139]
    v_mfma_f32_16x16x32_bf16 v[140:143], v[92:95], v[48:51], v[140:143]
    v_mfma_f32_16x16x32_bf16 v[144:147], v[96:99], v[48:51], v[144:147]
    v_mfma_f32_16x16x32_bf16 v[148:151], v[100:103], v[48:51], v[148:151]
    v_mfma_f32_16x16x32_bf16 v[152:155], v[104:107], v[48:51], v[152:155]
    v_mfma_f32_16x16x32_bf16 v[156:159], v[108:111], v[48:51], v[156:159]
    s_waitcnt lgkmcnt(0)
    s_waitcnt vmcnt(10)
    s_barrier
    ds_read_b128 v[88:91], v5 offset:6144
    ds_read_b128 v[92:95], v5 offset:7168
    ds_read_b128 v[96:99], v5 offset:8192
    ds_read_b128 v[100:103], v5 offset:9216
    ds_read_b128 v[104:107], v5 offset:10240
    ds_read_b128 v[108:111], v5 offset:11264
    v_mfma_f32_16x16x32_bf16 v[136:139], v[112:115], v[52:55], v[136:139]
    v_mfma_f32_16x16x32_bf16 v[140:143], v[116:119], v[52:55], v[140:143]
    v_mfma_f32_16x16x32_bf16 v[144:147], v[120:123], v[52:55], v[144:147]
    v_mfma_f32_16x16x32_bf16 v[148:151], v[124:127], v[52:55], v[148:151]
    v_mfma_f32_16x16x32_bf16 v[152:155], v[128:131], v[52:55], v[152:155]
    v_mfma_f32_16x16x32_bf16 v[156:159], v[132:135], v[52:55], v[156:159]
    ds_read_b128 v[112:115], v5 offset:12288
    ds_read_b128 v[116:119], v5 offset:13312
    ds_read_b128 v[120:123], v5 offset:14336
    ds_read_b128 v[124:127], v5 offset:15360
    ds_read_b128 v[128:131], v5 offset:16384
    ds_read_b128 v[132:135], v5 offset:17408
    buffer_load_dwordx4 v[80:83], v2, s[12:15], s44 offen offset:0
    buffer_load_dwordx4 v[84:87], v2, s[12:15], s44 offen offset:1024
    s_add_u32 m0, s34, 98304
    s_add_u32 s35, s33, 98304
    buffer_load_dwordx4 v4, s[16:19], s35 offen lds
    s_add_u32 m0, s34, 102400
    s_add_u32 s35, s33, 102400
    buffer_load_dwordx4 v4, s[16:19], s35 offen lds
    s_add_u32 m0, s34, 106496
    s_add_u32 s35, s33, 106496
    buffer_load_dwordx4 v4, s[16:19], s35 offen lds
    s_waitcnt lgkmcnt(6)
    v_mfma_f32_16x16x32_bf16 v[136:139], v[88:91], v[56:59], v[136:139]
    v_mfma_f32_16x16x32_bf16 v[140:143], v[92:95], v[56:59], v[140:143]
    v_mfma_f32_16x16x32_bf16 v[144:147], v[96:99], v[56:59], v[144:147]
    v_mfma_f32_16x16x32_bf16 v[148:151], v[100:103], v[56:59], v[148:151]
    v_mfma_f32_16x16x32_bf16 v[152:155], v[104:107], v[56:59], v[152:155]
    v_mfma_f32_16x16x32_bf16 v[156:159], v[108:111], v[56:59], v[156:159]
    s_waitcnt lgkmcnt(0)
    s_waitcnt vmcnt(10)
    s_barrier
    ds_read_b128 v[88:91], v5 offset:18432
    ds_read_b128 v[92:95], v5 offset:19456
    ds_read_b128 v[96:99], v5 offset:20480
    ds_read_b128 v[100:103], v5 offset:21504
    ds_read_b128 v[104:107], v5 offset:22528
    ds_read_b128 v[108:111], v5 offset:23552
    v_mfma_f32_16x16x32_bf16 v[136:139], v[112:115], v[60:63], v[136:139]
    v_mfma_f32_16x16x32_bf16 v[140:143], v[116:119], v[60:63], v[140:143]
    v_mfma_f32_16x16x32_bf16 v[144:147], v[120:123], v[60:63], v[144:147]
    v_mfma_f32_16x16x32_bf16 v[148:151], v[124:127], v[60:63], v[148:151]
    v_mfma_f32_16x16x32_bf16 v[152:155], v[128:131], v[60:63], v[152:155]
    v_mfma_f32_16x16x32_bf16 v[156:159], v[132:135], v[60:63], v[156:159]
    ds_read_b128 v[112:115], v5 offset:24576
    ds_read_b128 v[116:119], v5 offset:25600
    ds_read_b128 v[120:123], v5 offset:26624
    ds_read_b128 v[124:127], v5 offset:27648
    ds_read_b128 v[128:131], v5 offset:28672
    ds_read_b128 v[132:135], v5 offset:29696
    s_mov_b32 s20, s4
    s_mov_b32 s21, s5
    s_mov_b32 s22, 0x240000
    s_mov_b32 s23, 0x00020000
    v_lshrrev_b32 v3, 1, v13
    v_lshlrev_b32 v3, 8, v3
    v_lshl_add_u32 v3, v12, 4, v3
    v_and_b32 v11, 1, v13
    v_lshl_add_u32 v3, v11, 3, v3
    s_mul_i32 s36, s28, 3072
    s_add_u32 s36, s36, s31
    v_add_u32 v3, s36, v3
    buffer_load_dwordx2 v[160:161], v3, s[20:23], 0 offen offset:0
    buffer_load_dwordx2 v[162:163], v3, s[20:23], 0 offen offset:512
    buffer_load_dwordx2 v[164:165], v3, s[20:23], 0 offen offset:1024
    buffer_load_dwordx2 v[166:167], v3, s[20:23], 0 offen offset:1536
    buffer_load_dwordx2 v[168:169], v3, s[20:23], 0 offen offset:2048
    buffer_load_dwordx2 v[170:171], v3, s[20:23], 0 offen offset:2560
    s_waitcnt lgkmcnt(6)
    v_mfma_f32_16x16x32_bf16 v[136:139], v[88:91], v[64:67], v[136:139]
    v_mfma_f32_16x16x32_bf16 v[140:143], v[92:95], v[64:67], v[140:143]
    v_mfma_f32_16x16x32_bf16 v[144:147], v[96:99], v[64:67], v[144:147]
    v_mfma_f32_16x16x32_bf16 v[148:151], v[100:103], v[64:67], v[148:151]
    v_mfma_f32_16x16x32_bf16 v[152:155], v[104:107], v[64:67], v[152:155]
    v_mfma_f32_16x16x32_bf16 v[156:159], v[108:111], v[64:67], v[156:159]
    s_waitcnt lgkmcnt(0)
    s_waitcnt vmcnt(11)
    s_barrier
    ds_read_b128 v[88:91], v5 offset:30720
    ds_read_b128 v[92:95], v5 offset:31744
    ds_read_b128 v[96:99], v5 offset:32768
    ds_read_b128 v[100:103], v5 offset:33792
    ds_read_b128 v[104:107], v5 offset:34816
    ds_read_b128 v[108:111], v5 offset:35840
    v_mfma_f32_16x16x32_bf16 v[136:139], v[112:115], v[68:71], v[136:139]
    v_mfma_f32_16x16x32_bf16 v[140:143], v[116:119], v[68:71], v[140:143]
    v_mfma_f32_16x16x32_bf16 v[144:147], v[120:123], v[68:71], v[144:147]
    v_mfma_f32_16x16x32_bf16 v[148:151], v[124:127], v[68:71], v[148:151]
    v_mfma_f32_16x16x32_bf16 v[152:155], v[128:131], v[68:71], v[152:155]
    v_mfma_f32_16x16x32_bf16 v[156:159], v[132:135], v[68:71], v[156:159]
    ds_read_b128 v[112:115], v5 offset:36864
    ds_read_b128 v[116:119], v5 offset:37888
    ds_read_b128 v[120:123], v5 offset:38912
    ds_read_b128 v[124:127], v5 offset:39936
    ds_read_b128 v[128:131], v5 offset:40960
    ds_read_b128 v[132:135], v5 offset:41984
    s_waitcnt lgkmcnt(6)
    v_mfma_f32_16x16x32_bf16 v[136:139], v[88:91], v[72:75], v[136:139]
    v_mfma_f32_16x16x32_bf16 v[140:143], v[92:95], v[72:75], v[140:143]
    v_mfma_f32_16x16x32_bf16 v[144:147], v[96:99], v[72:75], v[144:147]
    v_mfma_f32_16x16x32_bf16 v[148:151], v[100:103], v[72:75], v[148:151]
    v_mfma_f32_16x16x32_bf16 v[152:155], v[104:107], v[72:75], v[152:155]
    v_mfma_f32_16x16x32_bf16 v[156:159], v[108:111], v[72:75], v[156:159]
    s_waitcnt lgkmcnt(0)
    s_waitcnt vmcnt(6)
    s_barrier
    ds_read_b128 v[88:91], v5 offset:43008
    ds_read_b128 v[92:95], v5 offset:44032
    ds_read_b128 v[96:99], v5 offset:45056
    ds_read_b128 v[100:103], v5 offset:46080
    ds_read_b128 v[104:107], v5 offset:47104
    ds_read_b128 v[108:111], v5 offset:48128
    v_mfma_f32_16x16x32_bf16 v[136:139], v[112:115], v[76:79], v[136:139]
    v_mfma_f32_16x16x32_bf16 v[140:143], v[116:119], v[76:79], v[140:143]
    v_mfma_f32_16x16x32_bf16 v[144:147], v[120:123], v[76:79], v[144:147]
    v_mfma_f32_16x16x32_bf16 v[148:151], v[124:127], v[76:79], v[148:151]
    v_mfma_f32_16x16x32_bf16 v[152:155], v[128:131], v[76:79], v[152:155]
    v_mfma_f32_16x16x32_bf16 v[156:159], v[132:135], v[76:79], v[156:159]
    ds_read_b128 v[112:115], v5 offset:49152
    ds_read_b128 v[116:119], v5 offset:50176
    ds_read_b128 v[120:123], v5 offset:51200
    ds_read_b128 v[124:127], v5 offset:52224
    ds_read_b128 v[128:131], v5 offset:53248
    ds_read_b128 v[132:135], v5 offset:54272
    s_waitcnt lgkmcnt(6)
    v_mfma_f32_16x16x32_bf16 v[136:139], v[88:91], v[80:83], v[136:139]
    v_mfma_f32_16x16x32_bf16 v[140:143], v[92:95], v[80:83], v[140:143]
    v_mfma_f32_16x16x32_bf16 v[144:147], v[96:99], v[80:83], v[144:147]
    v_mfma_f32_16x16x32_bf16 v[148:151], v[100:103], v[80:83], v[148:151]
    v_mfma_f32_16x16x32_bf16 v[152:155], v[104:107], v[80:83], v[152:155]
    v_mfma_f32_16x16x32_bf16 v[156:159], v[108:111], v[80:83], v[156:159]
    s_waitcnt lgkmcnt(0)
    v_mfma_f32_16x16x32_bf16 v[136:139], v[112:115], v[84:87], v[136:139]
    v_mfma_f32_16x16x32_bf16 v[140:143], v[116:119], v[84:87], v[140:143]
    v_mfma_f32_16x16x32_bf16 v[144:147], v[120:123], v[84:87], v[144:147]
    v_mfma_f32_16x16x32_bf16 v[148:151], v[124:127], v[84:87], v[148:151]
    v_mfma_f32_16x16x32_bf16 v[152:155], v[128:131], v[84:87], v[152:155]
    v_mfma_f32_16x16x32_bf16 v[156:159], v[132:135], v[84:87], v[156:159]
    s_nop 7
    s_add_u32 s24, s4, 0x240000
    s_addc_u32 s25, s5, 0
    s_mov_b32 s26, 0x240000
    s_mov_b32 s27, 0x00020000
    s_mov_b32 s36, 0xffff0000
    s_waitcnt vmcnt(0)
    v_cvt_pk_bf16_f32 v136, v136, v137
    v_cvt_pk_bf16_f32 v137, v138, v139
    v_lshlrev_b32 v11, 16, v136
    v_and_b32 v15, s36, v136
    v_lshlrev_b32 v138, 16, v160
    v_and_b32 v139, s36, v160
    v_add_f32 v11, v11, v138
    v_add_f32 v15, v15, v139
    v_cvt_pk_bf16_f32 v160, v11, v15
    v_lshlrev_b32 v11, 16, v137
    v_and_b32 v15, s36, v137
    v_lshlrev_b32 v138, 16, v161
    v_and_b32 v139, s36, v161
    v_add_f32 v11, v11, v138
    v_add_f32 v15, v15, v139
    v_cvt_pk_bf16_f32 v161, v11, v15
    buffer_store_dwordx2 v[160:161], v3, s[24:27], 0 offen offset:0
    v_cvt_pk_bf16_f32 v140, v140, v141
    v_cvt_pk_bf16_f32 v141, v142, v143
    v_lshlrev_b32 v11, 16, v140
    v_and_b32 v15, s36, v140
    v_lshlrev_b32 v142, 16, v162
    v_and_b32 v143, s36, v162
    v_add_f32 v11, v11, v142
    v_add_f32 v15, v15, v143
    v_cvt_pk_bf16_f32 v162, v11, v15
    v_lshlrev_b32 v11, 16, v141
    v_and_b32 v15, s36, v141
    v_lshlrev_b32 v142, 16, v163
    v_and_b32 v143, s36, v163
    v_add_f32 v11, v11, v142
    v_add_f32 v15, v15, v143
    v_cvt_pk_bf16_f32 v163, v11, v15
    buffer_store_dwordx2 v[162:163], v3, s[24:27], 0 offen offset:512
    v_cvt_pk_bf16_f32 v144, v144, v145
    v_cvt_pk_bf16_f32 v145, v146, v147
    v_lshlrev_b32 v11, 16, v144
    v_and_b32 v15, s36, v144
    v_lshlrev_b32 v146, 16, v164
    v_and_b32 v147, s36, v164
    v_add_f32 v11, v11, v146
    v_add_f32 v15, v15, v147
    v_cvt_pk_bf16_f32 v164, v11, v15
    v_lshlrev_b32 v11, 16, v145
    v_and_b32 v15, s36, v145
    v_lshlrev_b32 v146, 16, v165
    v_and_b32 v147, s36, v165
    v_add_f32 v11, v11, v146
    v_add_f32 v15, v15, v147
    v_cvt_pk_bf16_f32 v165, v11, v15
    buffer_store_dwordx2 v[164:165], v3, s[24:27], 0 offen offset:1024
    v_cvt_pk_bf16_f32 v148, v148, v149
    v_cvt_pk_bf16_f32 v149, v150, v151
    v_lshlrev_b32 v11, 16, v148
    v_and_b32 v15, s36, v148
    v_lshlrev_b32 v150, 16, v166
    v_and_b32 v151, s36, v166
    v_add_f32 v11, v11, v150
    v_add_f32 v15, v15, v151
    v_cvt_pk_bf16_f32 v166, v11, v15
    v_lshlrev_b32 v11, 16, v149
    v_and_b32 v15, s36, v149
    v_lshlrev_b32 v150, 16, v167
    v_and_b32 v151, s36, v167
    v_add_f32 v11, v11, v150
    v_add_f32 v15, v15, v151
    v_cvt_pk_bf16_f32 v167, v11, v15
    buffer_store_dwordx2 v[166:167], v3, s[24:27], 0 offen offset:1536
    v_cvt_pk_bf16_f32 v152, v152, v153
    v_cvt_pk_bf16_f32 v153, v154, v155
    v_lshlrev_b32 v11, 16, v152
    v_and_b32 v15, s36, v152
    v_lshlrev_b32 v154, 16, v168
    v_and_b32 v155, s36, v168
    v_add_f32 v11, v11, v154
    v_add_f32 v15, v15, v155
    v_cvt_pk_bf16_f32 v168, v11, v15
    v_lshlrev_b32 v11, 16, v153
    v_and_b32 v15, s36, v153
    v_lshlrev_b32 v154, 16, v169
    v_and_b32 v155, s36, v169
    v_add_f32 v11, v11, v154
    v_add_f32 v15, v15, v155
    v_cvt_pk_bf16_f32 v169, v11, v15
    buffer_store_dwordx2 v[168:169], v3, s[24:27], 0 offen offset:2048
    v_cvt_pk_bf16_f32 v156, v156, v157
    v_cvt_pk_bf16_f32 v157, v158, v159
    v_lshlrev_b32 v11, 16, v156
    v_and_b32 v15, s36, v156
    v_lshlrev_b32 v158, 16, v170
    v_and_b32 v159, s36, v170
    v_add_f32 v11, v11, v158
    v_add_f32 v15, v15, v159
    v_cvt_pk_bf16_f32 v170, v11, v15
    v_lshlrev_b32 v11, 16, v157
    v_and_b32 v15, s36, v157
    v_lshlrev_b32 v158, 16, v171
    v_and_b32 v159, s36, v171
    v_add_f32 v11, v11, v158
    v_add_f32 v15, v15, v159
    v_cvt_pk_bf16_f32 v171, v11, v15
    buffer_store_dwordx2 v[170:171], v3, s[24:27], 0 offen offset:2560
    s_mov_b32 s36, 0x3f803f80
    v_mov_b32 v88, 0
    v_mov_b32 v89, 0
    v_mov_b32 v90, 0
    v_mov_b32 v91, 0
    v_dot2_f32_bf16 v88, v160, s36, v88
    v_dot2_f32_bf16 v90, v160, v160, v90
    v_dot2_f32_bf16 v89, v161, s36, v89
    v_dot2_f32_bf16 v91, v161, v161, v91
    v_dot2_f32_bf16 v88, v162, s36, v88
    v_dot2_f32_bf16 v90, v162, v162, v90
    v_dot2_f32_bf16 v89, v163, s36, v89
    v_dot2_f32_bf16 v91, v163, v163, v91
    v_dot2_f32_bf16 v88, v164, s36, v88
    v_dot2_f32_bf16 v90, v164, v164, v90
    v_dot2_f32_bf16 v89, v165, s36, v89
    v_dot2_f32_bf16 v91, v165, v165, v91
    v_dot2_f32_bf16 v88, v166, s36, v88
    v_dot2_f32_bf16 v90, v166, v166, v90
    v_dot2_f32_bf16 v89, v167, s36, v89
    v_dot2_f32_bf16 v91, v167, v167, v91
    v_dot2_f32_bf16 v88, v168, s36, v88
    v_dot2_f32_bf16 v90, v168, v168, v90
    v_dot2_f32_bf16 v89, v169, s36, v89
    v_dot2_f32_bf16 v91, v169, v169, v91
    v_dot2_f32_bf16 v88, v170, s36, v88
    v_dot2_f32_bf16 v90, v170, v170, v90
    v_dot2_f32_bf16 v89, v171, s36, v89
    v_dot2_f32_bf16 v91, v171, v171, v91
    s_nop 3
    v_add_f32 v88, v88, v89
    v_add_f32 v89, v90, v91
    v_mov_b32 v90, v88
    v_mov_b32 v91, v89
    s_nop 1
    v_permlane32_swap_b32 v88, v90
    v_permlane32_swap_b32 v89, v91
    v_add_f32 v88, v88, v90
    v_add_f32 v89, v89, v91
    v_mov_b32 v90, v88
    v_mov_b32 v91, v89
    s_nop 1
    v_permlane16_swap_b32 v88, v90
    v_permlane16_swap_b32 v89, v91
    v_add_f32 v88, v88, v90
    v_add_f32 v89, v89, v91
    s_add_u32 s20, s4, 0x1400000
    s_addc_u32 s21, s5, 0
    s_mov_b32 s22, 0x18000
    s_mov_b32 s23, 0x00020000
    s_lshl_b32 s36, s30, 4
    v_add_u32 v3, s36, v12
    v_mul_u32_u24 v3, 48, v3
    s_lshl_b32 s36, s28, 3
    v_cmp_eq_u32 vcc, 0, v13
    s_and_saveexec_b64 s[38:39], vcc
    buffer_store_dwordx2 v[88:89], v3, s[20:23], s36 offen
    s_mov_b64 exec, -1
    s_endpgm
.Lend_37:
    s_endpgm
.section .rodata,"a"
.p2align 6
.amdhsa_kernel outb1_kernel
  .amdhsa_next_free_vgpr 200
  .amdhsa_next_free_sgpr 100
  .amdhsa_accum_offset 200
  .amdhsa_group_segment_fixed_size 0
  .amdhsa_kernarg_size 88
  .amdhsa_user_sgpr_count 2
  .amdhsa_user_sgpr_kernarg_segment_ptr 1
  .amdhsa_system_sgpr_workgroup_id_x 1
.end_amdhsa_kernel
.text
.globl qkva2_kernel
.p2align 8
.type qkva2_kernel,@function
qkva2_kernel:
    s_cmp_ge_u32 s2, 256
    s_cbranch_scc1 .Lend_39
    s_load_dwordx2 s[4:5], s[0:1], 80
    s_and_b32 s3, s2, 7
    s_lshl_b32 s3, s3, 2
    s_lshr_b32 s28, s2, 6
    s_add_u32 s3, s3, s28
    s_bfe_u32 s28, s2, 0x30003
    v_and_b32 v1, 63, v0
    v_lshrrev_b32 v11, 6, v0
    s_nop 0
    v_readfirstlane_b32 s29, v11
    v_and_b32 v12, 15, v1
    v_lshrrev_b32 v13, 4, v1
    v_lshlrev_b32 v4, 4, v1
    s_lshl_b32 s30, s3, 2
    s_add_u32 s30, s30, s29
    s_mul_i32 s31, s30, 18432
    v_add_u32 v2, s31, v4
    s_mov_b32 s41, 4096
    s_mov_b32 s42, 8192
    s_mov_b32 s43, 12288
    s_mov_b32 s44, 16384
    s_mov_b32 s40, 0
    s_waitcnt lgkmcnt(0)
    s_add_u32 s12, s4, 0x240000
    s_addc_u32 s13, s5, 0
    s_mov_b32 s14, 0x240000
    s_mov_b32 s15, 0x00020000
    s_lshl_b32 s34, s29, 10
    s_cmp_ge_u32 s28, 6
    s_cbranch_scc1 .Lkv_40
    s_add_u32 s16, s4, 0x1000000
    s_addc_u32 s17, s5, 0
    s_mov_b32 s18, 0xa2000
    s_mov_b32 s19, 0x00020000
    s_mul_i32 s33, s28, 110592
    s_add_u32 s33, s33, s34
    buffer_load_dwordx4 v[16:19], v2, s[12:15], s40 offen offset:0
    buffer_load_dwordx4 v[20:23], v2, s[12:15], s40 offen offset:1024
    s_add_u32 m0, s34, 0
    s_add_u32 s35, s33, 0
    buffer_load_dwordx4 v4, s[16:19], s35 offen lds
    s_add_u32 m0, s34, 4096
    s_add_u32 s35, s33, 4096
    buffer_load_dwordx4 v4, s[16:19], s35 offen lds
    s_add_u32 m0, s34, 8192
    s_add_u32 s35, s33, 8192
    buffer_load_dwordx4 v4, s[16:19], s35 offen lds
    buffer_load_dwordx4 v[24:27], v2, s[12:15], s40 offen offset:2048
    buffer_load_dwordx4 v[28:31], v2, s[12:15], s40 offen offset:3072
    s_add_u32 m0, s34, 12288
    s_add_u32 s35, s33, 12288
    buffer_load_dwordx4 v4, s[16:19], s35 offen lds
    s_add_u32 m0, s34, 16384
    s_add_u32 s35, s33, 16384
    buffer_load_dwordx4 v4, s[16:19], s35 offen lds
    s_add_u32 m0, s34, 20480
    s_add_u32 s35, s33, 20480
    buffer_load_dwordx4 v4, s[16:19], s35 offen lds
    buffer_load_dwordx4 v[32:35], v2, s[12:15], s41 offen offset:0
    buffer_load_dwordx4 v[36:39], v2, s[12:15], s41 offen offset:1024
    s_add_u32 m0, s34, 24576
    s_add_u32 s35, s33, 24576
    buffer_load_dwordx4 v4, s[16:19], s35 offen lds
    s_add_u32 m0, s34, 28672
    s_add_u32 s35, s33, 28672
    buffer_load_dwordx4 v4, s[16:19], s35 offen lds
    s_add_u32 m0, s34, 32768
    s_add_u32 s35, s33, 32768
    buffer_load_dwordx4 v4, s[16:19], s35 offen lds
    v_add_u32 v5, 55296, v4
    v_mov_b32 v136, 0
    v_mov_b32 v137, 0
    v_mov_b32 v138, 0
    v_mov_b32 v139, 0
    v_mov_b32 v140, 0
    v_mov_b32 v141, 0
    v_mov_b32 v142, 0
    v_mov_b32 v143, 0
    v_mov_b32 v144, 0
    v_mov_b32 v145, 0
    v_mov_b32 v146, 0
    v_mov_b32 v147, 0
    v_mov_b32 v148, 0
    v_mov_b32 v149, 0
    v_mov_b32 v150, 0
    v_mov_b32 v151, 0
    v_mov_b32 v152, 0
    v_mov_b32 v153, 0
    v_mov_b32 v154, 0
    v_mov_b32 v155, 0
    v_mov_b32 v156, 0
    v_mov_b32 v157, 0
    v_mov_b32 v158, 0
    v_mov_b32 v159, 0
    s_waitcnt vmcnt(10)
    s_barrier
    ds_read_b128 v[88:91], v4 offset:0
    ds_read_b128 v[92:95], v4 offset:1024
    ds_read_b128 v[96:99], v4 offset:2048
    ds_read_b128 v[100:103], v4 offset:3072
    ds_read_b128 v[104:107], v4 offset:4096
    ds_read_b128 v[108:111], v4 offset:5120
    ds_read_b128 v[112:115], v4 offset:6144
    ds_read_b128 v[116:119], v4 offset:7168
    ds_read_b128 v[120:123], v4 offset:8192
    ds_read_b128 v[124:127], v4 offset:9216
    ds_read_b128 v[128:131], v4 offset:10240
    ds_read_b128 v[132:135], v4 offset:11264
    buffer_load_dwordx4 v[40:43], v2, s[12:15], s41 offen offset:2048
    buffer_load_dwordx4 v[44:47], v2, s[12:15], s41 offen offset:3072
    s_add_u32 m0, s34, 36864
    s_add_u32 s35, s33, 36864
    buffer_load_dwordx4 v4, s[16:19], s35 offen lds
    s_add_u32 m0, s34, 40960
    s_add_u32 s35, s33, 40960
    buffer_load_dwordx4 v4, s[16:19], s35 offen lds
    s_add_u32 m0, s34, 45056
    s_add_u32 s35, s33, 45056
    buffer_load_dwordx4 v4, s[16:19], s35 offen lds
    s_waitcnt lgkmcnt(6)
    v_mfma_f32_16x16x32_bf16 v[136:139], v[88:91], v[16:19], v[136:139]
    v_mfma_f32_16x16x32_bf16 v[140:143], v[92:95], v[16:19], v[140:143]
    v_mfma_f32_16x16x32_bf16 v[144:147], v[96:99], v[16:19], v[144:147]
    v_mfma_f32_16x16x32_bf16 v[148:151], v[100:103], v[16:19], v[148:151]
    v_mfma_f32_16x16x32_bf16 v[152:155], v[104:107], v[16:19], v[152:155]
    v_mfma_f32_16x16x32_bf16 v[156:159], v[108:111], v[16:19], v[156:159]
    s_waitcnt lgkmcnt(0)
    s_waitcnt vmcnt(10)
    s_barrier
    ds_read_b128 v[88:91], v4 offset:12288
    ds_read_b128 v[92:95], v4 offset:13312
    ds_read_b128 v[96:99], v4 offset:14336
    ds_read_b128 v[100:103], v4 offset:15360
    ds_read_b128 v[104:107], v4 offset:16384
    ds_read_b128 v[108:111], v4 offset:17408
    v_mfma_f32_16x16x32_bf16 v[136:139], v[112:115], v[20:23], v[136:139]
    v_mfma_f32_16x16x32_bf16 v[140:143], v[116:119], v[20:23], v[140:143]
    v_mfma_f32_16x16x32_bf16 v[144:147], v[120:123], v[20:23], v[144:147]
    v_mfma_f32_16x16x32_bf16 v[148:151], v[124:127], v[20:23], v[148:151]
    v_mfma_f32_16x16x32_bf16 v[152:155], v[128:131], v[20:23], v[152:155]
    v_mfma_f32_16x16x32_bf16 v[156:159], v[132:135], v[20:23], v[156:159]
    ds_read_b128 v[112:115], v4 offset:18432
    ds_read_b128 v[116:119], v4 offset:19456
    ds_read_b128 v[120:123], v4 offset:20480
    ds_read_b128 v[124:127], v4 offset:21504
    ds_read_b128 v[128:131], v4 offset:22528
    ds_read_b128 v[132:135], v4 offset:23552
    buffer_load_dwordx4 v[48:51], v2, s[12:15], s42 offen offset:0
    buffer_load_dwordx4 v[52:55], v2, s[12:15], s42 offen offset:1024
    s_add_u32 m0, s34, 49152
    s_add_u32 s35, s33, 49152
    buffer_load_dwordx4 v4, s[16:19], s35 offen lds
    s_add_u32 m0, s34, 53248
    s_add_u32 s35, s33, 53248
    buffer_load_dwordx4 v4, s[16:19], s35 offen lds
    s_add_u32 m0, s34, 57344
    s_add_u32 s35, s33, 57344
    buffer_load_dwordx4 v4, s[16:19], s35 offen lds
    s_waitcnt lgkmcnt(6)
    v_mfma_f32_16x16x32_bf16 v[136:139], v[88:91], v[24:27], v[136:139]
    v_mfma_f32_16x16x32_bf16 v[140:143], v[92:95], v[24:27], v[140:143]
    v_mfma_f32_16x16x32_bf16 v[144:147], v[96:99], v[24:27], v[144:147]
    v_mfma_f32_16x16x32_bf16 v[148:151], v[100:103], v[24:27], v[148:151]
    v_mfma_f32_16x16x32_bf16 v[152:155], v[104:107], v[24:27], v[152:155]
    v_mfma_f32_16x16x32_bf16 v[156:159], v[108:111], v[24:27], v[156:159]
    s_waitcnt lgkmcnt(0)
    s_waitcnt vmcnt(10)
    s_barrier
    ds_read_b128 v[88:91], v4 offset:24576
    ds_read_b128 v[92:95], v4 offset:25600
    ds_read_b128 v[96:99], v4 offset:26624
    ds_read_b128 v[100:103], v4 offset:27648
    ds_read_b128 v[104:107], v4 offset:28672
    ds_read_b128 v[108:111], v4 offset:29696
    v_mfma_f32_16x16x32_bf16 v[136:139], v[112:115], v[28:31], v[136:139]
    v_mfma_f32_16x16x32_bf16 v[140:143], v[116:119], v[28:31], v[140:143]
    v_mfma_f32_16x16x32_bf16 v[144:147], v[120:123], v[28:31], v[144:147]
    v_mfma_f32_16x16x32_bf16 v[148:151], v[124:127], v[28:31], v[148:151]
    v_mfma_f32_16x16x32_bf16 v[152:155], v[128:131], v[28:31], v[152:155]
    v_mfma_f32_16x16x32_bf16 v[156:159], v[132:135], v[28:31], v[156:159]
    ds_read_b128 v[112:115], v4 offset:30720
    ds_read_b128 v[116:119], v4 offset:31744
    ds_read_b128 v[120:123], v4 offset:32768
    ds_read_b128 v[124:127], v4 offset:33792
    ds_read_b128 v[128:131], v4 offset:34816
    ds_read_b128 v[132:135], v4 offset:35840
    buffer_load_dwordx4 v[56:59], v2, s[12:15], s42 offen offset:2048
    buffer_load_dwordx4 v[60:63], v2, s[12:15], s42 offen offset:3072
    s_add_u32 m0, s34, 61440
    s_add_u32 s35, s33, 61440
    buffer_load_dwordx4 v4, s[16:19], s35 offen lds
    s_add_u32 m0, s34, 65536
    s_add_u32 s35, s33, 65536
    buffer_load_dwordx4 v4, s[16:19], s35 offen lds
    s_add_u32 m0, s34, 69632
    s_add_u32 s35, s33, 69632
    buffer_load_dwordx4 v4, s[16:19], s35 offen lds
    s_waitcnt lgkmcnt(6)
    v_mfma_f32_16x16x32_bf16 v[136:139], v[88:91], v[32:35], v[136:139]
    v_mfma_f32_16x16x32_bf16 v[140:143], v[92:95], v[32:35], v[140:143]
    v_mfma_f32_16x16x32_bf16 v[144:147], v[96:99], v[32:35], v[144:147]
    v_mfma_f32_16x16x32_bf16 v[148:151], v[100:103], v[32:35], v[148:151]
    v_mfma_f32_16x16x32_bf16 v[152:155], v[104:107], v[32:35], v[152:155]
    v_mfma_f32_16x16x32_bf16 v[156:159], v[108:111], v[32:35], v[156:159]
    s_waitcnt lgkmcnt(0)
    s_waitcnt vmcnt(10)
    s_barrier
    ds_read_b128 v[88:91], v4 offset:36864
    ds_read_b128 v[92:95], v4 offset:37888
    ds_read_b128 v[96:99], v4 offset:38912
    ds_read_b128 v[100:103], v4 offset:39936
    ds_read_b128 v[104:107], v4 offset:40960
    ds_read_b128 v[108:111], v4 offset:41984
    v_mfma_f32_16x16x32_bf16 v[136:139], v[112:115], v[36:39], v[136:139]
    v_mfma_f32_16x16x32_bf16 v[140:143], v[116:119], v[36:39], v[140:143]
    v_mfma_f32_16x16x32_bf16 v[144:147], v[120:123], v[36:39], v[144:147]
    v_mfma_f32_16x16x32_bf16 v[148:151], v[124:127], v[36:39], v[148:151]
    v_mfma_f32_16x16x32_bf16 v[152:155], v[128:131], v[36:39], v[152:155]
    v_mfma_f32_16x16x32_bf16 v[156:159], v[132:135], v[36:39], v[156:159]
    ds_read_b128 v[112:115], v4 offset:43008
    ds_read_b128 v[116:119], v4 offset:44032
    ds_read_b128 v[120:123], v4 offset:45056
    ds_read_b128 v[124:127], v4 offset:46080
    ds_read_b128 v[128:131], v4 offset:47104
    ds_read_b128 v[132:135], v4 offset:48128
    buffer_load_dwordx4 v[64:67], v2, s[12:15], s43 offen offset:0
    buffer_load_dwordx4 v[68:71], v2, s[12:15], s43 offen offset:1024
    s_add_u32 m0, s34, 73728
    s_add_u32 s35, s33, 73728
    buffer_load_dwordx4 v4, s[16:19], s35 offen lds
    s_add_u32 m0, s34, 77824
    s_add_u32 s35, s33, 77824
    buffer_load_dwordx4 v4, s[16:19], s35 offen lds
    s_add_u32 m0, s34, 81920
    s_add_u32 s35, s33, 81920
    buffer_load_dwordx4 v4, s[16:19], s35 offen lds
    s_waitcnt lgkmcnt(6)
    v_mfma_f32_16x16x32_bf16 v[136:139], v[88:91], v[40:43], v[136:139]
    v_mfma_f32_16x16x32_bf16 v[140:143], v[92:95], v[40:43], v[140:143]
    v_mfma_f32_16x16x32_bf16 v[144:147], v[96:99], v[40:43], v[144:147]
    v_mfma_f32_16x16x32_bf16 v[148:151], v[100:103], v[40:43], v[148:151]
    v_mfma_f32_16x16x32_bf16 v[152:155], v[104:107], v[40:43], v[152:155]
    v_mfma_f32_16x16x32_bf16 v[156:159], v[108:111], v[40:43], v[156:159]
    s_waitcnt lgkmcnt(0)
    s_waitcnt vmcnt(10)
    s_barrier
    ds_read_b128 v[88:91], v4 offset:49152
    ds_read_b128 v[92:95], v4 offset:50176
    ds_read_b128 v[96:99], v4 offset:51200
    ds_read_b128 v[100:103], v4 offset:52224
    ds_read_b128 v[104:107], v4 offset:53248
    ds_read_b128 v[108:111], v4 offset:54272
    v_mfma_f32_16x16x32_bf16 v[136:139], v[112:115], v[44:47], v[136:139]
    v_mfma_f32_16x16x32_bf16 v[140:143], v[116:119], v[44:47], v[140:143]
    v_mfma_f32_16x16x32_bf16 v[144:147], v[120:123], v[44:47], v[144:147]
    v_mfma_f32_16x16x32_bf16 v[148:151], v[124:127], v[44:47], v[148:151]
    v_mfma_f32_16x16x32_bf16 v[152:155], v[128:131], v[44:47], v[152:155]
    v_mfma_f32_16x16x32_bf16 v[156:159], v[132:135], v[44:47], v[156:159]
    ds_read_b128 v[112:115], v5 offset:0
    ds_read_b128 v[116:119], v5 offset:1024
    ds_read_b128 v[120:123], v5 offset:2048
    ds_read_b128 v[124:127], v5 offset:3072
    ds_read_b128 v[128:131], v5 offset:4096
    ds_read_b128 v[132:135], v5 offset:5120
    buffer_load_dwordx4 v[72:75], v2, s[12:15], s43 offen offset:2048
    buffer_load_dwordx4 v[76:79], v2, s[12:15], s43 offen offset:3072
    s_add_u32 m0, s34, 86016
    s_add_u32 s35, s33, 86016
    buffer_load_dwordx4 v4, s[16:19], s35 offen lds
    s_add_u32 m0, s34, 90112
    s_add_u32 s35, s33, 90112
    buffer_load_dwordx4 v4, s[16:19], s35 offen lds
    s_add_u32 m0, s34, 94208
    s_add_u32 s35, s33, 94208
    buffer_load_dwordx4 v4, s[16:19], s35 offen lds
    s_waitcnt lgkmcnt(6)
    v_mfma_f32_16x16x32_bf16 v[136:139], v[88:91], v[48:51], v[136:139]
    v_mfma_f32_16x16x32_bf16 v[140:143], v[92:95], v[48:51], v[140:143]
    v_mfma_f32_16x16x32_bf16 v[144:147], v[96:99], v[48:51], v[144:147]
    v_mfma_f32_16x16x32_bf16 v[148:151], v[100:103], v[48:51], v[148:151]
    v_mfma_f32_16x16x32_bf16 v[152:155], v[104:107], v[48:51], v[152:155]
    v_mfma_f32_16x16x32_bf16 v[156:159], v[108:111], v[48:51], v[156:159]
    s_waitcnt lgkmcnt(0)
    s_waitcnt vmcnt(10)
    s_barrier
    ds_read_b128 v[88:91], v5 offset:6144
    ds_read_b128 v[92:95], v5 offset:7168
    ds_read_b128 v[96:99], v5 offset:8192
    ds_read_b128 v[100:103], v5 offset:9216
    ds_read_b128 v[104:107], v5 offset:10240
    ds_read_b128 v[108:111], v5 offset:11264
    v_mfma_f32_16x16x32_bf16 v[136:139], v[112:115], v[52:55], v[136:139]
    v_mfma_f32_16x16x32_bf16 v[140:143], v[116:119], v[52:55], v[140:143]
    v_mfma_f32_16x16x32_bf16 v[144:147], v[120:123], v[52:55], v[144:147]
    v_mfma_f32_16x16x32_bf16 v[148:151], v[124:127], v[52:55], v[148:151]
    v_mfma_f32_16x16x32_bf16 v[152:155], v[128:131], v[52:55], v[152:155]
    v_mfma_f32_16x16x32_bf16 v[156:159], v[132:135], v[52:55], v[156:159]
    ds_read_b128 v[112:115], v5 offset:12288
    ds_read_b128 v[116:119], v5 offset:13312
    ds_read_b128 v[120:123], v5 offset:14336
    ds_read_b128 v[124:127], v5 offset:15360
    ds_read_b128 v[128:131], v5 offset:16384
    ds_read_b128 v[132:135], v5 offset:17408
    buffer_load_dwordx4 v[80:83], v2, s[12:15], s44 offen offset:0
    buffer_load_dwordx4 v[84:87], v2, s[12:15], s44 offen offset:1024
    s_add_u32 m0, s34, 98304
    s_add_u32 s35, s33, 98304
    buffer_load_dwordx4 v4, s[16:19], s35 offen lds
    s_add_u32 m0, s34, 102400
    s_add_u32 s35, s33, 102400
    buffer_load_dwordx4 v4, s[16:19], s35 offen lds
    s_add_u32 m0, s34, 106496
    s_add_u32 s35, s33, 106496
    buffer_load_dwordx4 v4, s[16:19], s35 offen lds
    s_waitcnt lgkmcnt(6)
    v_mfma_f32_16x16x32_bf16 v[136:139], v[88:91], v[56:59], v[136:139]
    v_mfma_f32_16x16x32_bf16 v[140:143], v[92:95], v[56:59], v[140:143]
    v_mfma_f32_16x16x32_bf16 v[144:147], v[96:99], v[56:59], v[144:147]
    v_mfma_f32_16x16x32_bf16 v[148:151], v[100:103], v[56:59], v[148:151]
    v_mfma_f32_16x16x32_bf16 v[152:155], v[104:107], v[56:59], v[152:155]
    v_mfma_f32_16x16x32_bf16 v[156:159], v[108:111], v[56:59], v[156:159]
    s_waitcnt lgkmcnt(0)
    s_waitcnt vmcnt(10)
    s_barrier
    ds_read_b128 v[88:91], v5 offset:18432
    ds_read_b128 v[92:95], v5 offset:19456
    ds_read_b128 v[96:99], v5 offset:20480
    ds_read_b128 v[100:103], v5 offset:21504
    ds_read_b128 v[104:107], v5 offset:22528
    ds_read_b128 v[108:111], v5 offset:23552
    v_mfma_f32_16x16x32_bf16 v[136:139], v[112:115], v[60:63], v[136:139]
    v_mfma_f32_16x16x32_bf16 v[140:143], v[116:119], v[60:63], v[140:143]
    v_mfma_f32_16x16x32_bf16 v[144:147], v[120:123], v[60:63], v[144:147]
    v_mfma_f32_16x16x32_bf16 v[148:151], v[124:127], v[60:63], v[148:151]
    v_mfma_f32_16x16x32_bf16 v[152:155], v[128:131], v[60:63], v[152:155]
    v_mfma_f32_16x16x32_bf16 v[156:159], v[132:135], v[60:63], v[156:159]
    ds_read_b128 v[112:115], v5 offset:24576
    ds_read_b128 v[116:119], v5 offset:25600
    ds_read_b128 v[120:123], v5 offset:26624
    ds_read_b128 v[124:127], v5 offset:27648
    ds_read_b128 v[128:131], v5 offset:28672
    ds_read_b128 v[132:135], v5 offset:29696
    s_mul_i32 s37, s28, 384
    s_add_u32 s20, s4, 0x1400000
    s_addc_u32 s21, s5, 0
    s_mov_b32 s22, 0x18000
    s_mov_b32 s23, 0x00020000
    s_add_u32 s48, s4, 0x1420000
    s_addc_u32 s49, s5, 0
    s_mov_b32 s50, 0x2500
    s_mov_b32 s51, 0x00020000
    s_lshl_b32 s36, s30, 4
    v_add_u32 v3, s36, v12
    v_mul_u32_u24 v3, 48, v3
    buffer_load_dwordx4 v[160:163], v3, s[20:23], 0 offen offset:0
    buffer_load_dwordx4 v[164:167], v3, s[20:23], 0 offen offset:16
    buffer_load_dwordx4 v[168:171], v3, s[20:23], 0 offen offset:32
    v_lshlrev_b32 v3, 4, v13
    buffer_load_dwordx4 v[172:175], v3, s[48:51], s37 offen offset:0
    buffer_load_dwordx4 v[176:179], v3, s[48:51], s37 offen offset:64
    buffer_load_dwordx4 v[180:183], v3, s[48:51], s37 offen offset:128
    buffer_load_dwordx4 v[184:187], v3, s[48:51], s37 offen offset:192
    buffer_load_dwordx4 v[188:191], v3, s[48:51], s37 offen offset:256
    buffer_load_dwordx4 v[192:195], v3, s[48:51], s37 offen offset:320
    s_waitcnt lgkmcnt(6)
    v_mfma_f32_16x16x32_bf16 v[136:139], v[88:91], v[64:67], v[136:139]
    v_mfma_f32_16x16x32_bf16 v[140:143], v[92:95], v[64:67], v[140:143]
    v_mfma_f32_16x16x32_bf16 v[144:147], v[96:99], v[64:67], v[144:147]
    v_mfma_f32_16x16x32_bf16 v[148:151], v[100:103], v[64:67], v[148:151]
    v_mfma_f32_16x16x32_bf16 v[152:155], v[104:107], v[64:67], v[152:155]
    v_mfma_f32_16x16x32_bf16 v[156:159], v[108:111], v[64:67], v[156:159]
    s_waitcnt lgkmcnt(0)
    s_waitcnt vmcnt(14)
    s_barrier
    ds_read_b128 v[88:91], v5 offset:30720
    ds_read_b128 v[92:95], v5 offset:31744
    ds_read_b128 v[96:99], v5 offset:32768
    ds_read_b128 v[100:103], v5 offset:33792
    ds_read_b128 v[104:107], v5 offset:34816
    ds_read_b128 v[108:111], v5 offset:35840
    v_mfma_f32_16x16x32_bf16 v[136:139], v[112:115], v[68:71], v[136:139]
    v_mfma_f32_16x16x32_bf16 v[140:143], v[116:119], v[68:71], v[140:143]
    v_mfma_f32_16x16x32_bf16 v[144:147], v[120:123], v[68:71], v[144:147]
    v_mfma_f32_16x16x32_bf16 v[148:151], v[124:127], v[68:71], v[148:151]
    v_mfma_f32_16x16x32_bf16 v[152:155], v[128:131], v[68:71], v[152:155]
    v_mfma_f32_16x16x32_bf16 v[156:159], v[132:135], v[68:71], v[156:159]
    ds_read_b128 v[112:115], v5 offset:36864
    ds_read_b128 v[116:119], v5 offset:37888
    ds_read_b128 v[120:123], v5 offset:38912
    ds_read_b128 v[124:127], v5 offset:39936
    ds_read_b128 v[128:131], v5 offset:40960
    ds_read_b128 v[132:135], v5 offset:41984
    s_waitcnt lgkmcnt(6)
    v_mfma_f32_16x16x32_bf16 v[136:139], v[88:91], v[72:75], v[136:139]
    v_mfma_f32_16x16x32_bf16 v[140:143], v[92:95], v[72:75], v[140:143]
    v_mfma_f32_16x16x32_bf16 v[144:147], v[96:99], v[72:75], v[144:147]
    v_mfma_f32_16x16x32_bf16 v[148:151], v[100:103], v[72:75], v[148:151]
    v_mfma_f32_16x16x32_bf16 v[152:155], v[104:107], v[72:75], v[152:155]
    v_mfma_f32_16x16x32_bf16 v[156:159], v[108:111], v[72:75], v[156:159]
    s_waitcnt lgkmcnt(0)
    s_waitcnt vmcnt(9)
    s_barrier
    ds_read_b128 v[88:91], v5 offset:43008
    ds_read_b128 v[92:95], v5 offset:44032
    ds_read_b128 v[96:99], v5 offset:45056
    ds_read_b128 v[100:103], v5 offset:46080
    ds_read_b128 v[104:107], v5 offset:47104
    ds_read_b128 v[108:111], v5 offset:48128
    v_mfma_f32_16x16x32_bf16 v[136:139], v[112:115], v[76:79], v[136:139]
    v_mfma_f32_16x16x32_bf16 v[140:143], v[116:119], v[76:79], v[140:143]
    v_mfma_f32_16x16x32_bf16 v[144:147], v[120:123], v[76:79], v[144:147]
    v_mfma_f32_16x16x32_bf16 v[148:151], v[124:127], v[76:79], v[148:151]
    v_mfma_f32_16x16x32_bf16 v[152:155], v[128:131], v[76:79], v[152:155]
    v_mfma_f32_16x16x32_bf16 v[156:159], v[132:135], v[76:79], v[156:159]
    ds_read_b128 v[112:115], v5 offset:49152
    ds_read_b128 v[116:119], v5 offset:50176
    ds_read_b128 v[120:123], v5 offset:51200
    ds_read_b128 v[124:127], v5 offset:52224
    ds_read_b128 v[128:131], v5 offset:53248
    ds_read_b128 v[132:135], v5 offset:54272
    s_waitcnt lgkmcnt(6)
    v_mfma_f32_16x16x32_bf16 v[136:139], v[88:91], v[80:83], v[136:139]
    v_mfma_f32_16x16x32_bf16 v[140:143], v[92:95], v[80:83], v[140:143]
    v_mfma_f32_16x16x32_bf16 v[144:147], v[96:99], v[80:83], v[144:147]
    v_mfma_f32_16x16x32_bf16 v[148:151], v[100:103], v[80:83], v[148:151]
    v_mfma_f32_16x16x32_bf16 v[152:155], v[104:107], v[80:83], v[152:155]
    v_mfma_f32_16x16x32_bf16 v[156:159], v[108:111], v[80:83], v[156:159]
    s_waitcnt lgkmcnt(0)
    v_mfma_f32_16x16x32_bf16 v[136:139], v[112:115], v[84:87], v[136:139]
    v_mfma_f32_16x16x32_bf16 v[140:143], v[116:119], v[84:87], v[140:143]
    v_mfma_f32_16x16x32_bf16 v[144:147], v[120:123], v[84:87], v[144:147]
    v_mfma_f32_16x16x32_bf16 v[148:151], v[124:127], v[84:87], v[148:151]
    v_mfma_f32_16x16x32_bf16 v[152:155], v[128:131], v[84:87], v[152:155]
    v_mfma_f32_16x16x32_bf16 v[156:159], v[132:135], v[84:87], v[156:159]
    s_nop 7
    s_add_u32 s24, s4, 0x6c0000
    s_addc_u32 s25, s5, 0
    s_mov_b32 s26, 0x240000
    s_mov_b32 s27, 0x00020000
    s_lshl_b32 s36, s30, 4
    v_add_u32 v3, s36, v12
    v_mul_u32_u24 v3, 1152, v3
    v_lshl_add_u32 v3, v13, 3, v3
    s_mul_i32 s36, s28, 192
    v_add_u32 v3, s36, v3
    s_waitcnt vmcnt(0)
    v_add_f32 v160, v160, v162
    v_add_f32 v161, v161, v163
    v_add_f32 v160, v160, v164
    v_add_f32 v161, v161, v165
    v_add_f32 v160, v160, v166
    v_add_f32 v161, v161, v167
    v_add_f32 v160, v160, v168
    v_add_f32 v161, v161, v169
    v_add_f32 v160, v160, v170
    v_add_f32 v161, v161, v171
    s_mov_b32 s36, 0x3ae38e39
    v_mul_f32 v160, s36, v160
    v_mul_f32 v161, s36, v161
    v_fma_f32 v161, -v160, v160, v161
    v_max_f32 v161, 0, v161
    v_cvt_pk_bf16_f32 v162, v160, v161
    v_lshlrev_b32 v160, 16, v162
    v_and_b32 v161, 0xffff0000, v162
    v_add_f32 v161, 0x3727c5ac, v161
    v_cvt_pk_bf16_f32 v161, v161, v161
    v_lshlrev_b32 v161, 16, v161
    v_sqrt_f32 v161, v161
    s_nop 0
    v_cvt_pk_bf16_f32 v161, v161, v161
    v_lshlrev_b32 v161, 16, v161
    v_rcp_f32 v161, v161
    s_nop 0
    s_mov_b32 s36, 0x3eae1a93
    v_mul_f32 v161, s36, v161
    v_fma_f32 v136, -v160, v172, v136
    v_mul_f32 v136, v161, v136
    v_fma_f32 v137, -v160, v173, v137
    v_mul_f32 v137, v161, v137
    v_fma_f32 v138, -v160, v174, v138
    v_mul_f32 v138, v161, v138
    v_fma_f32 v139, -v160, v175, v139
    v_mul_f32 v139, v161, v139
    v_cvt_pk_bf16_f32 v136, v136, v137
    v_cvt_pk_bf16_f32 v137, v138, v139
    buffer_store_dwordx2 v[136:137], v3, s[24:27], 0 offen offset:0
    v_fma_f32 v140, -v160, v176, v140
    v_mul_f32 v140, v161, v140
    v_fma_f32 v141, -v160, v177, v141
    v_mul_f32 v141, v161, v141
    v_fma_f32 v142, -v160, v178, v142
    v_mul_f32 v142, v161, v142
    v_fma_f32 v143, -v160, v179, v143
    v_mul_f32 v143, v161, v143
    v_cvt_pk_bf16_f32 v140, v140, v141
    v_cvt_pk_bf16_f32 v141, v142, v143
    buffer_store_dwordx2 v[140:141], v3, s[24:27], 0 offen offset:32
    v_fma_f32 v144, -v160, v180, v144
    v_mul_f32 v144, v161, v144
    v_fma_f32 v145, -v160, v181, v145
    v_mul_f32 v145, v161, v145
    v_fma_f32 v146, -v160, v182, v146
    v_mul_f32 v146, v161, v146
    v_fma_f32 v147, -v160, v183, v147
    v_mul_f32 v147, v161, v147
    v_cvt_pk_bf16_f32 v144, v144, v145
    v_cvt_pk_bf16_f32 v145, v146, v147
    buffer_store_dwordx2 v[144:145], v3, s[24:27], 0 offen offset:64
    v_fma_f32 v148, -v160, v184, v148
    v_mul_f32 v148, v161, v148
    v_fma_f32 v149, -v160, v185, v149
    v_mul_f32 v149, v161, v149
    v_fma_f32 v150, -v160, v186, v150
    v_mul_f32 v150, v161, v150
    v_fma_f32 v151, -v160, v187, v151
    v_mul_f32 v151, v161, v151
    v_cvt_pk_bf16_f32 v148, v148, v149
    v_cvt_pk_bf16_f32 v149, v150, v151
    buffer_store_dwordx2 v[148:149], v3, s[24:27], 0 offen offset:96
    v_fma_f32 v152, -v160, v188, v152
    v_mul_f32 v152, v161, v152
    v_fma_f32 v153, -v160, v189, v153
    v_mul_f32 v153, v161, v153
    v_fma_f32 v154, -v160, v190, v154
    v_mul_f32 v154, v161, v154
    v_fma_f32 v155, -v160, v191, v155
    v_mul_f32 v155, v161, v155
    v_cvt_pk_bf16_f32 v152, v152, v153
    v_cvt_pk_bf16_f32 v153, v154, v155
    buffer_store_dwordx2 v[152:153], v3, s[24:27], 0 offen offset:128
    v_fma_f32 v156, -v160, v192, v156
    v_mul_f32 v156, v161, v156
    v_fma_f32 v157, -v160, v193, v157
    v_mul_f32 v157, v161, v157
    v_fma_f32 v158, -v160, v194, v158
    v_mul_f32 v158, v161, v158
    v_fma_f32 v159, -v160, v195, v159
    v_mul_f32 v159, v161, v159
    v_cvt_pk_bf16_f32 v156, v156, v157
    v_cvt_pk_bf16_f32 v157, v158, v159
    buffer_store_dwordx2 v[156:157], v3, s[24:27], 0 offen offset:160
    s_endpgm
.Lkv_40:
    s_add_u32 s16, s4, 0x11e6000
    s_addc_u32 s17, s5, 0
    s_mov_b32 s18, 0x12000
    s_mov_b32 s19, 0x00020000
    s_sub_u32 s33, s28, 6
    s_mul_i32 s37, s33, 128
    s_add_u32 s37, s37, 2304
    s_mul_i32 s33, s33, 36864
    s_add_u32 s33, s33, s34
    s_add_u32 m0, s34, 0
    s_add_u32 s35, s33, 0
    buffer_load_dwordx4 v4, s[16:19], s35 offen lds
    s_add_u32 m0, s34, 4096
    s_add_u32 s35, s33, 4096
    buffer_load_dwordx4 v4, s[16:19], s35 offen lds
    s_add_u32 m0, s34, 8192
    s_add_u32 s35, s33, 8192
    buffer_load_dwordx4 v4, s[16:19], s35 offen lds
    s_add_u32 m0, s34, 12288
    s_add_u32 s35, s33, 12288
    buffer_load_dwordx4 v4, s[16:19], s35 offen lds
    s_add_u32 m0, s34, 16384
    s_add_u32 s35, s33, 16384
    buffer_load_dwordx4 v4, s[16:19], s35 offen lds
    s_add_u32 m0, s34, 20480
    s_add_u32 s35, s33, 20480
    buffer_load_dwordx4 v4, s[16:19], s35 offen lds
    s_add_u32 m0, s34, 24576
    s_add_u32 s35, s33, 24576
    buffer_load_dwordx4 v4, s[16:19], s35 offen lds
    s_add_u32 m0, s34, 28672
    s_add_u32 s35, s33, 28672
    buffer_load_dwordx4 v4, s[16:19], s35 offen lds
    s_add_u32 m0, s34, 32768
    s_add_u32 s35, s33, 32768
    buffer_load_dwordx4 v4, s[16:19], s35 offen lds
    buffer_load_dwordx4 v[16:19], v2, s[12:15], s40 offen offset:0
    buffer_load_dwordx4 v[20:23], v2, s[12:15], s40 offen offset:1024
    buffer_load_dwordx4 v[24:27], v2, s[12:15], s40 offen offset:2048
    buffer_load_dwordx4 v[28:31], v2, s[12:15], s40 offen offset:3072
    buffer_load_dwordx4 v[32:35], v2, s[12:15], s41 offen offset:0
    buffer_load_dwordx4 v[36:39], v2, s[12:15], s41 offen offset:1024
    buffer_load_dwordx4 v[40:43], v2, s[12:15], s41 offen offset:2048
    buffer_load_dwordx4 v[44:47], v2, s[12:15], s41 offen offset:3072
    buffer_load_dwordx4 v[48:51], v2, s[12:15], s42 offen offset:0
    buffer_load_dwordx4 v[52:55], v2, s[12:15], s42 offen offset:1024
    buffer_load_dwordx4 v[56:59], v2, s[12:15], s42 offen offset:2048
    buffer_load_dwordx4 v[60:63], v2, s[12:15], s42 offen offset:3072
    buffer_load_dwordx4 v[64:67], v2, s[12:15], s43 offen offset:0
    buffer_load_dwordx4 v[68:71], v2, s[12:15], s43 offen offset:1024
    buffer_load_dwordx4 v[72:75], v2, s[12:15], s43 offen offset:2048
    buffer_load_dwordx4 v[76:79], v2, s[12:15], s43 offen offset:3072
    buffer_load_dwordx4 v[80:83], v2, s[12:15], s44 offen offset:0
    buffer_load_dwordx4 v[84:87], v2, s[12:15], s44 offen offset:1024
    s_add_u32 s20, s4, 0x1400000
    s_addc_u32 s21, s5, 0
    s_mov_b32 s22, 0x18000
    s_mov_b32 s23, 0x00020000
    s_add_u32 s48, s4, 0x1420000
    s_addc_u32 s49, s5, 0
    s_mov_b32 s50, 0x2500
    s_mov_b32 s51, 0x00020000
    s_lshl_b32 s36, s30, 4
    v_add_u32 v3, s36, v12
    v_mul_u32_u24 v3, 48, v3
    buffer_load_dwordx4 v[160:163], v3, s[20:23], 0 offen offset:0
    buffer_load_dwordx4 v[164:167], v3, s[20:23], 0 offen offset:16
    buffer_load_dwordx4 v[168:171], v3, s[20:23], 0 offen offset:32
    v_lshlrev_b32 v3, 4, v13
    buffer_load_dwordx4 v[172:175], v3, s[48:51], s37 offen offset:0
    buffer_load_dwordx4 v[176:179], v3, s[48:51], s37 offen offset:64
    v_mov_b32 v136, 0
    v_mov_b32 v137, 0
    v_mov_b32 v138, 0
    v_mov_b32 v139, 0
    v_mov_b32 v140, 0
    v_mov_b32 v141, 0
    v_mov_b32 v142, 0
    v_mov_b32 v143, 0
    s_waitcnt vmcnt(0)
    s_barrier
    ds_read_b128 v[88:91], v4 offset:0
    ds_read_b128 v[92:95], v4 offset:1024
    ds_read_b128 v[96:99], v4 offset:2048
    ds_read_b128 v[100:103], v4 offset:3072
    ds_read_b128 v[104:107], v4 offset:4096
    ds_read_b128 v[108:111], v4 offset:5120
    s_waitcnt lgkmcnt(0)
    v_mfma_f32_16x16x32_bf16 v[136:139], v[88:91], v[16:19], v[136:139]
    v_mfma_f32_16x16x32_bf16 v[140:143], v[92:95], v[16:19], v[140:143]
    v_mfma_f32_16x16x32_bf16 v[136:139], v[96:99], v[20:23], v[136:139]
    v_mfma_f32_16x16x32_bf16 v[140:143], v[100:103], v[20:23], v[140:143]
    v_mfma_f32_16x16x32_bf16 v[136:139], v[104:107], v[24:27], v[136:139]
    v_mfma_f32_16x16x32_bf16 v[140:143], v[108:111], v[24:27], v[140:143]
    ds_read_b128 v[112:115], v4 offset:6144
    ds_read_b128 v[116:119], v4 offset:7168
    ds_read_b128 v[120:123], v4 offset:8192
    ds_read_b128 v[124:127], v4 offset:9216
    ds_read_b128 v[128:131], v4 offset:10240
    ds_read_b128 v[132:135], v4 offset:11264
    s_waitcnt lgkmcnt(0)
    v_mfma_f32_16x16x32_bf16 v[136:139], v[112:115], v[28:31], v[136:139]
    v_mfma_f32_16x16x32_bf16 v[140:143], v[116:119], v[28:31], v[140:143]
    v_mfma_f32_16x16x32_bf16 v[136:139], v[120:123], v[32:35], v[136:139]
    v_mfma_f32_16x16x32_bf16 v[140:143], v[124:127], v[32:35], v[140:143]
    v_mfma_f32_16x16x32_bf16 v[136:139], v[128:131], v[36:39], v[136:139]
    v_mfma_f32_16x16x32_bf16 v[140:143], v[132:135], v[36:39], v[140:143]
    ds_read_b128 v[88:91], v4 offset:12288
    ds_read_b128 v[92:95], v4 offset:13312
    ds_read_b128 v[96:99], v4 offset:14336
    ds_read_b128 v[100:103], v4 offset:15360
    ds_read_b128 v[104:107], v4 offset:16384
    ds_read_b128 v[108:111], v4 offset:17408
    s_waitcnt lgkmcnt(0)
    v_mfma_f32_16x16x32_bf16 v[136:139], v[88:91], v[40:43], v[136:139]
    v_mfma_f32_16x16x32_bf16 v[140:143], v[92:95], v[40:43], v[140:143]
    v_mfma_f32_16x16x32_bf16 v[136:139], v[96:99], v[44:47], v[136:139]
    v_mfma_f32_16x16x32_bf16 v[140:143], v[100:103], v[44:47], v[140:143]
    v_mfma_f32_16x16x32_bf16 v[136:139], v[104:107], v[48:51], v[136:139]
    v_mfma_f32_16x16x32_bf16 v[140:143], v[108:111], v[48:51], v[140:143]
    ds_read_b128 v[112:115], v4 offset:18432
    ds_read_b128 v[116:119], v4 offset:19456
    ds_read_b128 v[120:123], v4 offset:20480
    ds_read_b128 v[124:127], v4 offset:21504
    ds_read_b128 v[128:131], v4 offset:22528
    ds_read_b128 v[132:135], v4 offset:23552
    s_waitcnt lgkmcnt(0)
    v_mfma_f32_16x16x32_bf16 v[136:139], v[112:115], v[52:55], v[136:139]
    v_mfma_f32_16x16x32_bf16 v[140:143], v[116:119], v[52:55], v[140:143]
    v_mfma_f32_16x16x32_bf16 v[136:139], v[120:123], v[56:59], v[136:139]
    v_mfma_f32_16x16x32_bf16 v[140:143], v[124:127], v[56:59], v[140:143]
    v_mfma_f32_16x16x32_bf16 v[136:139], v[128:131], v[60:63], v[136:139]
    v_mfma_f32_16x16x32_bf16 v[140:143], v[132:135], v[60:63], v[140:143]
    ds_read_b128 v[88:91], v4 offset:24576
    ds_read_b128 v[92:95], v4 offset:25600
    ds_read_b128 v[96:99], v4 offset:26624
    ds_read_b128 v[100:103], v4 offset:27648
    ds_read_b128 v[104:107], v4 offset:28672
    ds_read_b128 v[108:111], v4 offset:29696
    s_waitcnt lgkmcnt(0)
    v_mfma_f32_16x16x32_bf16 v[136:139], v[88:91], v[64:67], v[136:139]
    v_mfma_f32_16x16x32_bf16 v[140:143], v[92:95], v[64:67], v[140:143]
    v_mfma_f32_16x16x32_bf16 v[136:139], v[96:99], v[68:71], v[136:139]
    v_mfma_f32_16x16x32_bf16 v[140:143], v[100:103], v[68:71], v[140:143]
    v_mfma_f32_16x16x32_bf16 v[136:139], v[104:107], v[72:75], v[136:139]
    v_mfma_f32_16x16x32_bf16 v[140:143], v[108:111], v[72:75], v[140:143]
    ds_read_b128 v[112:115], v4 offset:30720
    ds_read_b128 v[116:119], v4 offset:31744
    ds_read_b128 v[120:123], v4 offset:32768
    ds_read_b128 v[124:127], v4 offset:33792
    ds_read_b128 v[128:131], v4 offset:34816
    ds_read_b128 v[132:135], v4 offset:35840
    s_waitcnt lgkmcnt(0)
    v_mfma_f32_16x16x32_bf16 v[136:139], v[112:115], v[76:79], v[136:139]
    v_mfma_f32_16x16x32_bf16 v[140:143], v[116:119], v[76:79], v[140:143]
    v_mfma_f32_16x16x32_bf16 v[136:139], v[120:123], v[80:83], v[136:139]
    v_mfma_f32_16x16x32_bf16 v[140:143], v[124:127], v[80:83], v[140:143]
    v_mfma_f32_16x16x32_bf16 v[136:139], v[128:131], v[84:87], v[136:139]
    v_mfma_f32_16x16x32_bf16 v[140:143], v[132:135], v[84:87], v[140:143]
    s_nop 7
    v_add_f32 v160, v160, v162
    v_add_f32 v161, v161, v163
    v_add_f32 v160, v160, v164
    v_add_f32 v161, v161, v165
    v_add_f32 v160, v160, v166
    v_add_f32 v161, v161, v167
    v_add_f32 v160, v160, v168
    v_add_f32 v161, v161, v169
    v_add_f32 v160, v160, v170
    v_add_f32 v161, v161, v171
    s_mov_b32 s36, 0x3ae38e39
    v_mul_f32 v160, s36, v160
    v_mul_f32 v161, s36, v161
    v_fma_f32 v161, -v160, v160, v161
    v_max_f32 v161, 0, v161
    v_cvt_pk_bf16_f32 v162, v160, v161
    v_lshlrev_b32 v160, 16, v162
    v_and_b32 v161, 0xffff0000, v162
    v_add_f32 v161, 0x3727c5ac, v161
    v_cvt_pk_bf16_f32 v161, v161, v161
    v_lshlrev_b32 v161, 16, v161
    v_sqrt_f32 v161, v161
    s_nop 0
    v_cvt_pk_bf16_f32 v161, v161, v161
    v_lshlrev_b32 v161, 16, v161
    v_rcp_f32 v161, v161
    s_nop 0
    v_fma_f32 v136, -v160, v172, v136
    v_mul_f32 v136, v161, v136
    v_fma_f32 v137, -v160, v173, v137
    v_mul_f32 v137, v161, v137
    v_fma_f32 v138, -v160, v174, v138
    v_mul_f32 v138, v161, v138
    v_fma_f32 v139, -v160, v175, v139
    v_mul_f32 v139, v161, v139
    v_fma_f32 v140, -v160, v176, v140
    v_mul_f32 v140, v161, v140
    v_fma_f32 v141, -v160, v177, v141
    v_mul_f32 v141, v161, v141
    v_fma_f32 v142, -v160, v178, v142
    v_mul_f32 v142, v161, v142
    v_fma_f32 v143, -v160, v179, v143
    v_mul_f32 v143, v161, v143
    s_add_u32 s24, s4, 0xb40000
    s_addc_u32 s25, s5, 0
    s_mov_b32 s26, 0x28000
    s_mov_b32 s27, 0x00020000
    s_lshl_b32 s36, s30, 4
    v_add_u32 v11, s36, v12
    v_lshrrev_b32 v15, 8, v11
    v_mul_u32_u24 v15, 20480, v15
    v_and_b32 v11, 255, v11
    s_cmp_eq_u32 s28, 7
    s_cbranch_scc1 .Lvp_41
    v_cvt_pk_bf16_f32 v136, v136, v137
    v_cvt_pk_bf16_f32 v137, v138, v139
    v_lshl_add_u32 v3, v11, 5, v15
    v_lshl_add_u32 v3, v13, 3, v3
    buffer_store_dwordx2 v[136:137], v3, s[24:27], 0 offen
    v_cvt_pk_bf16_f32 v140, v140, v141
    v_mov_b32 v141, 0x3f80
    v_lshl_add_u32 v3, v11, 3, v15
    v_cmp_eq_u32 vcc, 0, v13
    s_mov_b32 s37, 8192
    s_and_saveexec_b64 s[38:39], vcc
    buffer_store_dwordx2 v[140:141], v3, s[24:27], s37 offen
    s_endpgm
.Lvp_41:
    v_lshrrev_b32 v3, 4, v11
    v_mul_u32_u24 v3, 640, v3
    v_add_u32 v3, v3, v15
    v_add_u32 v3, 10240, v3
    v_bfe_u32 v7, v11, 2, 1
    v_lshl_add_u32 v3, v7, 4, v3
    v_and_b32 v7, 3, v11
    v_lshl_add_u32 v3, v7, 1, v3
    v_bfe_u32 v7, v11, 3, 1
    v_lshl_add_u32 v3, v7, 3, v3
    v_lshl_add_u32 v8, v13, 7, v3
    v_cvt_pk_bf16_f32 v136, v136, v137
    v_cvt_pk_bf16_f32 v137, v138, v139
    v_cvt_pk_bf16_f32 v140, v140, v141
    v_mov_b32 v141, 0x3f80
    buffer_store_short v136, v8, s[24:27], 0 offen offset:0
    buffer_store_short_d16_hi v136, v8, s[24:27], 0 offen offset:32
    buffer_store_short v137, v8, s[24:27], 0 offen offset:64
    buffer_store_short_d16_hi v137, v8, s[24:27], 0 offen offset:96
    v_cmp_eq_u32 vcc, 0, v13
    s_and_saveexec_b64 s[38:39], vcc
    buffer_store_short v140, v3, s[24:27], 0 offen offset:512
    buffer_store_short_d16_hi v140, v3, s[24:27], 0 offen offset:544
    buffer_store_short v141, v3, s[24:27], 0 offen offset:576
    buffer_store_short_d16_hi v141, v3, s[24:27], 0 offen offset:608
    s_endpgm
.Lend_39:
    s_endpgm
.section .rodata,"a"
.p2align 6
.amdhsa_kernel qkva2_kernel
  .amdhsa_next_free_vgpr 200
  .amdhsa_next_free_sgpr 100
  .amdhsa_accum_offset 200
  .amdhsa_group_segment_fixed_size 0
  .amdhsa_kernarg_size 88
  .amdhsa_user_sgpr_count 2
  .amdhsa_user_sgpr_kernarg_segment_ptr 1
  .amdhsa_system_sgpr_workgroup_id_x 1
.end_amdhsa_kernel
.text
.globl attn_kernel
.p2align 8
.type attn_kernel,@function
attn_kernel:
    s_cmp_ge_u32 s2, 256
    s_cbranch_scc1 .Lend_42
    s_load_dwordx2 s[4:5], s[0:1], 80
    v_and_b32 v1, 63, v0
    v_lshrrev_b32 v2, 6, v0
    s_nop 0
    v_readfirstlane_b32 s20, v2
    v_and_b32 v2, 31, v1
    v_lshrrev_b32 v3, 5, v1
    s_lshl_b32 s21, s2, 3
    s_add_u32 s21, s21, s20
    s_mul_i32 s22, s21, 1152
    v_mul_u32_u24 v4, 36, v2
    v_add_u32 v4, s22, v4
    v_lshl_add_u32 v5, v3, 4, v4
    v_lshlrev_b32 v6, 4, v1
    s_waitcnt lgkmcnt(0)
    s_add_u32 s8, s4, 0x6c0000
    s_addc_u32 s9, s5, 0
    s_mov_b32 s10, 0x240000
    s_mov_b32 s11, 0x00020000
    s_add_u32 s12, s4, 0xb40000
    s_addc_u32 s13, s5, 0
    s_mov_b32 s14, 0x28000
    s_mov_b32 s15, 0x00020000
    s_add_u32 s16, s4, 0x900000
    s_addc_u32 s17, s5, 0
    s_mov_b32 s18, 0x240000
    s_mov_b32 s19, 0x00020000
    buffer_load_dwordx4 v[8:11], v5, s[8:11], 0 offen
    buffer_load_dword v12, v4, s[8:11], 0 offen offset:32
    s_lshl_b32 s23, s20, 10
    s_add_u32 s24, s23, 0
    s_mov_b32 m0, s24
    s_nop 0
    buffer_load_dwordx4 v6, s[12:15], s24 offen lds
    s_add_u32 s24, s23, 8192
    s_mov_b32 m0, s24
    s_nop 0
    buffer_load_dwordx4 v6, s[12:15], s24 offen lds
    s_add_u32 s24, s23, 16384
    s_mov_b32 m0, s24
    s_nop 0
    buffer_load_dwordx4 v6, s[12:15], s24 offen lds
    s_add_u32 s24, s24, 8192
    s_add_u32 s25, s23, 163840
    v_lshlrev_b32 v110, 5, v2
    v_lshl_add_u32 v110, v3, 4, v110
    v_add_u32 v112, 10240, v110
    v_lshlrev_b32 v111, 3, v2
    v_add_u32 v111, 8192, v111
    v_mov_b32 v26, 0
    v_mov_b32 v27, 0
    v_mov_b32 v30, 0
    v_mov_b32 v31, 0
    v_mov_b32 v13, 0
    v_mov_b32 v14, 0
    v_mov_b32 v15, 0
    v_cmp_eq_u32 s[26:27], 0, v3
    s_mov_b32 s28, 1
    s_waitcnt vmcnt(0)
    v_cndmask_b32 v12, 0, v12, s[26:27]
    s_barrier
    ds_read_b128 v[16:19], v110
    ds_read_b64 v[24:25], v111
    s_waitcnt lgkmcnt(0)
    v_mfma_f32_32x32x16_bf16 v[48:63], v[16:19], v[8:11], 0
    v_mfma_f32_32x32x16_bf16 v[48:63], v[24:27], v[12:15], v[48:63]
    s_nop 15
    v_max3_f32 v113, v48, v49, v50
    v_max3_f32 v113, v113, v51, v52
    v_max3_f32 v113, v113, v53, v54
    v_max3_f32 v113, v113, v55, v56
    v_max3_f32 v113, v113, v57, v58
    v_max3_f32 v113, v113, v59, v60
    v_max3_f32 v113, v113, v61, v62
    v_max_f32 v113, v113, v63
.Lsetm_43:
    v_mov_b32 v114, v113
    s_nop 1
    v_permlane32_swap_b32 v113, v114
    v_max_f32 v113, v113, v114
    v_cvt_pk_bf16_f32 v113, v113, v113
    v_and_b32 v113, 0xffff, v113
    v_xor_b32 v113, 0x8000, v113
    v_cndmask_b32 v13, 0, v113, s[26:27]
    v_mov_b32 v88, 0
    v_mov_b32 v89, 0
    v_mov_b32 v90, 0
    v_mov_b32 v91, 0
    v_mov_b32 v92, 0
    v_mov_b32 v93, 0
    v_mov_b32 v94, 0
    v_mov_b32 v95, 0
    v_mov_b32 v96, 0
    v_mov_b32 v97, 0
    v_mov_b32 v98, 0
    v_mov_b32 v99, 0
    v_mov_b32 v100, 0
    v_mov_b32 v101, 0
    v_mov_b32 v102, 0
    v_mov_b32 v103, 0
    v_mov_b32 v84, 0
    v_mov_b32 v44, 0
    v_mov_b32 v85, 0
    v_mov_b32 v45, 0
    v_mov_b32 v86, 0
    v_mov_b32 v46, 0
    v_mov_b32 v87, 0
    v_mov_b32 v47, 0
    v_mov_b32 v104, v110
    v_add_u32 v107, 20480, v110
    v_mov_b32 v105, v111
    v_add_u32 v108, 20480, v111
    v_mov_b32 v106, v112
    v_add_u32 v109, 20480, v112
    ds_read_b128 v[16:19], v110
    ds_read_b64 v[24:25], v111
    ds_read_b128 v[20:23], v110 offset:1024
    ds_read_b64 v[28:29], v111 offset:256
    ds_read_b128 v[32:35], v112
    ds_read_b128 v[36:39], v112 offset:640
    s_mov_b32 s29, 0
    s_waitcnt lgkmcnt(4)
    v_mfma_f32_32x32x16_bf16 v[48:63], v[16:19], v[8:11], 0
    v_mfma_f32_32x32x16_bf16 v[48:63], v[24:27], v[12:15], v[48:63]
    s_nop 7
.Lloop_44:
    ds_read_b128 v[16:19], v104 offset:2048
    ds_read_b64 v[24:25], v105 offset:512
    v_mfma_f32_32x32x16_bf16 v[88:103], v[44:47], v[84:87], v[88:103]
    ds_read_b128 v[40:43], v106 offset:1280
    ds_read_b128 v[44:47], v106 offset:1920
    s_waitcnt lgkmcnt(4)
    v_mfma_f32_32x32x16_bf16 v[64:79], v[20:23], v[8:11], 0
    v_exp_f32 v48, v48
    v_exp_f32 v49, v49
    v_exp_f32 v50, v50
    v_exp_f32 v51, v51
    v_mfma_f32_32x32x16_bf16 v[64:79], v[28:31], v[12:15], v[64:79]
    v_exp_f32 v52, v52
    v_exp_f32 v53, v53
    v_exp_f32 v54, v54
    v_exp_f32 v55, v55
    v_cvt_pk_bf16_f32 v80, v48, v49
    v_cvt_pk_bf16_f32 v81, v50, v51
    v_cvt_pk_bf16_f32 v82, v52, v53
    v_cvt_pk_bf16_f32 v83, v54, v55
    v_exp_f32 v56, v56
    v_exp_f32 v57, v57
    v_exp_f32 v58, v58
    v_exp_f32 v59, v59
    v_mfma_f32_32x32x16_bf16 v[88:103], v[32:35], v[80:83], v[88:103]
    v_exp_f32 v60, v60
    v_exp_f32 v61, v61
    v_exp_f32 v62, v62
    v_exp_f32 v63, v63
    v_cvt_pk_bf16_f32 v84, v56, v57
    v_cvt_pk_bf16_f32 v85, v58, v59
    v_cvt_pk_bf16_f32 v86, v60, v61
    v_cvt_pk_bf16_f32 v87, v62, v63
    s_cmp_ge_u32 s24, s25
    s_cbranch_scc1 .Lnodma_45
    s_mov_b32 m0, s24
    s_nop 0
    buffer_load_dwordx4 v6, s[12:15], s24 offen lds
    s_add_u32 s24, s24, 8192
.Lnodma_45:
    ds_read_b128 v[20:23], v104 offset:3072
    ds_read_b64 v[28:29], v105 offset:768
    v_mfma_f32_32x32x16_bf16 v[88:103], v[36:39], v[84:87], v[88:103]
    ds_read_b128 v[32:35], v106 offset:2560
    ds_read_b128 v[36:39], v106 offset:3200
    s_waitcnt lgkmcnt(4)
    v_mfma_f32_32x32x16_bf16 v[48:63], v[16:19], v[8:11], 0
    v_exp_f32 v64, v64
    v_exp_f32 v65, v65
    v_exp_f32 v66, v66
    v_exp_f32 v67, v67
    v_mfma_f32_32x32x16_bf16 v[48:63], v[24:27], v[12:15], v[48:63]
    v_exp_f32 v68, v68
    v_exp_f32 v69, v69
    v_exp_f32 v70, v70
    v_exp_f32 v71, v71
    v_cvt_pk_bf16_f32 v80, v64, v65
    v_cvt_pk_bf16_f32 v81, v66, v67
    v_cvt_pk_bf16_f32 v82, v68, v69
    v_cvt_pk_bf16_f32 v83, v70, v71
    v_exp_f32 v72, v72
    v_exp_f32 v73, v73
    v_exp_f32 v74, v74
    v_exp_f32 v75, v75
    v_mfma_f32_32x32x16_bf16 v[88:103], v[40:43], v[80:83], v[88:103]
    v_exp_f32 v76, v76
    v_exp_f32 v77, v77
    v_exp_f32 v78, v78
    v_exp_f32 v79, v79
    v_cvt_pk_bf16_f32 v84, v72, v73
    v_cvt_pk_bf16_f32 v85, v74, v75
    v_cvt_pk_bf16_f32 v86, v76, v77
    v_cvt_pk_bf16_f32 v87, v78, v79
    s_cmp_ge_u32 s24, s25
    s_cbranch_scc1 .Lnodma_46
    s_mov_b32 m0, s24
    s_nop 0
    buffer_load_dwordx4 v6, s[12:15], s24 offen lds
    s_add_u32 s24, s24, 8192
.Lnodma_46:
    ds_read_b128 v[16:19], v104 offset:4096
    ds_read_b64 v[24:25], v105 offset:1024
    v_mfma_f32_32x32x16_bf16 v[88:103], v[44:47], v[84:87], v[88:103]
    ds_read_b128 v[40:43], v106 offset:3840
    ds_read_b128 v[44:47], v106 offset:4480
    s_waitcnt lgkmcnt(4)
    v_mfma_f32_32x32x16_bf16 v[64:79], v[20:23], v[8:11], 0
    v_exp_f32 v48, v48
    v_exp_f32 v49, v49
    v_exp_f32 v50, v50
    v_exp_f32 v51, v51
    v_mfma_f32_32x32x16_bf16 v[64:79], v[28:31], v[12:15], v[64:79]
    v_exp_f32 v52, v52
    v_exp_f32 v53, v53
    v_exp_f32 v54, v54
    v_exp_f32 v55, v55
    v_cvt_pk_bf16_f32 v80, v48, v49
    v_cvt_pk_bf16_f32 v81, v50, v51
    v_cvt_pk_bf16_f32 v82, v52, v53
    v_cvt_pk_bf16_f32 v83, v54, v55
    v_exp_f32 v56, v56
    v_exp_f32 v57, v57
    v_exp_f32 v58, v58
    v_exp_f32 v59, v59
    v_mfma_f32_32x32x16_bf16 v[88:103], v[32:35], v[80:83], v[88:103]
    v_exp_f32 v60, v60
    v_exp_f32 v61, v61
    v_exp_f32 v62, v62
    v_exp_f32 v63, v63
    v_cvt_pk_bf16_f32 v84, v56, v57
    v_cvt_pk_bf16_f32 v85, v58, v59
    v_cvt_pk_bf16_f32 v86, v60, v61
    v_cvt_pk_bf16_f32 v87, v62, v63
    s_cmp_ge_u32 s24, s25
    s_cbranch_scc1 .Lnodma_47
    s_mov_b32 m0, s24
    s_nop 0
    buffer_load_dwordx4 v6, s[12:15], s24 offen lds
    s_add_u32 s24, s24, 8192
.Lnodma_47:
    ds_read_b128 v[20:23], v104 offset:5120
    ds_read_b64 v[28:29], v105 offset:1280
    v_mfma_f32_32x32x16_bf16 v[88:103], v[36:39], v[84:87], v[88:103]
    ds_read_b128 v[32:35], v106 offset:5120
    ds_read_b128 v[36:39], v106 offset:5760
    s_waitcnt lgkmcnt(4)
    v_mfma_f32_32x32x16_bf16 v[48:63], v[16:19], v[8:11], 0
    v_exp_f32 v64, v64
    v_exp_f32 v65, v65
    v_exp_f32 v66, v66
    v_exp_f32 v67, v67
    v_mfma_f32_32x32x16_bf16 v[48:63], v[24:27], v[12:15], v[48:63]
    v_exp_f32 v68, v68
    v_exp_f32 v69, v69
    v_exp_f32 v70, v70
    v_exp_f32 v71, v71
    v_cvt_pk_bf16_f32 v80, v64, v65
    v_cvt_pk_bf16_f32 v81, v66, v67
    v_cvt_pk_bf16_f32 v82, v68, v69
    v_cvt_pk_bf16_f32 v83, v70, v71
    v_exp_f32 v72, v72
    v_exp_f32 v73, v73
    v_exp_f32 v74, v74
    v_exp_f32 v75, v75
    v_mfma_f32_32x32x16_bf16 v[88:103], v[40:43], v[80:83], v[88:103]
    v_exp_f32 v76, v76
    v_exp_f32 v77, v77
    v_exp_f32 v78, v78
    v_exp_f32 v79, v79
    v_cvt_pk_bf16_f32 v84, v72, v73
    v_cvt_pk_bf16_f32 v85, v74, v75
    v_cvt_pk_bf16_f32 v86, v76, v77
    v_cvt_pk_bf16_f32 v87, v78, v79
    s_cmp_ge_u32 s24, s25
    s_cbranch_scc1 .Lnodma_48
    s_mov_b32 m0, s24
    s_nop 0
    buffer_load_dwordx4 v6, s[12:15], s24 offen lds
    s_add_u32 s24, s24, 8192
.Lnodma_48:
    ds_read_b128 v[16:19], v104 offset:6144
    ds_read_b64 v[24:25], v105 offset:1536
    v_mfma_f32_32x32x16_bf16 v[88:103], v[44:47], v[84:87], v[88:103]
    ds_read_b128 v[40:43], v106 offset:6400
    ds_read_b128 v[44:47], v106 offset:7040
    s_waitcnt lgkmcnt(4)
    v_mfma_f32_32x32x16_bf16 v[64:79], v[20:23], v[8:11], 0
    v_exp_f32 v48, v48
    v_exp_f32 v49, v49
    v_exp_f32 v50, v50
    v_exp_f32 v51, v51
    v_mfma_f32_32x32x16_bf16 v[64:79], v[28:31], v[12:15], v[64:79]
    v_exp_f32 v52, v52
    v_exp_f32 v53, v53
    v_exp_f32 v54, v54
    v_exp_f32 v55, v55
    v_cvt_pk_bf16_f32 v80, v48, v49
    v_cvt_pk_bf16_f32 v81, v50, v51
    v_cvt_pk_bf16_f32 v82, v52, v53
    v_cvt_pk_bf16_f32 v83, v54, v55
    v_exp_f32 v56, v56
    v_exp_f32 v57, v57
    v_exp_f32 v58, v58
    v_exp_f32 v59, v59
    v_mfma_f32_32x32x16_bf16 v[88:103], v[32:35], v[80:83], v[88:103]
    v_exp_f32 v60, v60
    v_exp_f32 v61, v61
    v_exp_f32 v62, v62
    v_exp_f32 v63, v63
    v_cvt_pk_bf16_f32 v84, v56, v57
    v_cvt_pk_bf16_f32 v85, v58, v59
    v_cvt_pk_bf16_f32 v86, v60, v61
    v_cvt_pk_bf16_f32 v87, v62, v63
    s_cmp_ge_u32 s24, s25
    s_cbranch_scc1 .Lnodma_49
    s_mov_b32 m0, s24
    s_nop 0
    buffer_load_dwordx4 v6, s[12:15], s24 offen lds
    s_add_u32 s24, s24, 8192
.Lnodma_49:
    ds_read_b128 v[20:23], v104 offset:7168
    ds_read_b64 v[28:29], v105 offset:1792
    v_mfma_f32_32x32x16_bf16 v[88:103], v[36:39], v[84:87], v[88:103]
    ds_read_b128 v[32:35], v106 offset:7680
    ds_read_b128 v[36:39], v106 offset:8320
    s_waitcnt lgkmcnt(4)
    v_mfma_f32_32x32x16_bf16 v[48:63], v[16:19], v[8:11], 0
    v_exp_f32 v64, v64
    v_exp_f32 v65, v65
    v_exp_f32 v66, v66
    v_exp_f32 v67, v67
    v_mfma_f32_32x32x16_bf16 v[48:63], v[24:27], v[12:15], v[48:63]
    v_exp_f32 v68, v68
    v_exp_f32 v69, v69
    v_exp_f32 v70, v70
    v_exp_f32 v71, v71
    v_cvt_pk_bf16_f32 v80, v64, v65
    v_cvt_pk_bf16_f32 v81, v66, v67
    v_cvt_pk_bf16_f32 v82, v68, v69
    v_cvt_pk_bf16_f32 v83, v70, v71
    v_exp_f32 v72, v72
    v_exp_f32 v73, v73
    v_exp_f32 v74, v74
    v_exp_f32 v75, v75
    v_mfma_f32_32x32x16_bf16 v[88:103], v[40:43], v[80:83], v[88:103]
    v_exp_f32 v76, v76
    v_exp_f32 v77, v77
    v_exp_f32 v78, v78
    v_exp_f32 v79, v79
    v_cvt_pk_bf16_f32 v84, v72, v73
    v_cvt_pk_bf16_f32 v85, v74, v75
    v_cvt_pk_bf16_f32 v86, v76, v77
    v_cvt_pk_bf16_f32 v87, v78, v79
    s_cmp_ge_u32 s24, s25
    s_cbranch_scc1 .Lnodma_50
    s_mov_b32 m0, s24
    s_nop 0
    buffer_load_dwordx4 v6, s[12:15], s24 offen lds
    s_add_u32 s24, s24, 8192
.Lnodma_50:
    s_cmp_eq_u32 s28, 0
    s_cbranch_scc1 .Lnosync_51
    s_cmp_eq_u32 s29, 1
    s_cbranch_scc1 .Ll5_52
    s_cmp_eq_u32 s29, 3
    s_cbranch_scc1 .Ll0_53
    s_cmp_lg_u32 s29, 0
    s_cbranch_scc1 .Lnosync_51
    s_waitcnt vmcnt(4)
    s_branch .Llb_54
.Ll5_52:
    s_waitcnt vmcnt(7)
    s_branch .Llb_54
.Ll0_53:
    s_waitcnt vmcnt(0)
.Llb_54:
    s_barrier
.Lnosync_51:
    ds_read_b128 v[16:19], v107 offset:0
    ds_read_b64 v[24:25], v108 offset:0
    v_mfma_f32_32x32x16_bf16 v[88:103], v[44:47], v[84:87], v[88:103]
    ds_read_b128 v[40:43], v106 offset:8960
    ds_read_b128 v[44:47], v106 offset:9600
    s_waitcnt lgkmcnt(4)
    v_mfma_f32_32x32x16_bf16 v[64:79], v[20:23], v[8:11], 0
    v_exp_f32 v48, v48
    v_exp_f32 v49, v49
    v_exp_f32 v50, v50
    v_exp_f32 v51, v51
    v_mfma_f32_32x32x16_bf16 v[64:79], v[28:31], v[12:15], v[64:79]
    v_exp_f32 v52, v52
    v_exp_f32 v53, v53
    v_exp_f32 v54, v54
    v_exp_f32 v55, v55
    v_cvt_pk_bf16_f32 v80, v48, v49
    v_cvt_pk_bf16_f32 v81, v50, v51
    v_cvt_pk_bf16_f32 v82, v52, v53
    v_cvt_pk_bf16_f32 v83, v54, v55
    v_exp_f32 v56, v56
    v_exp_f32 v57, v57
    v_exp_f32 v58, v58
    v_exp_f32 v59, v59
    v_mfma_f32_32x32x16_bf16 v[88:103], v[32:35], v[80:83], v[88:103]
    v_exp_f32 v60, v60
    v_exp_f32 v61, v61
    v_exp_f32 v62, v62
    v_exp_f32 v63, v63
    v_cvt_pk_bf16_f32 v84, v56, v57
    v_cvt_pk_bf16_f32 v85, v58, v59
    v_cvt_pk_bf16_f32 v86, v60, v61
    v_cvt_pk_bf16_f32 v87, v62, v63
    s_cmp_ge_u32 s24, s25
    s_cbranch_scc1 .Lnodma_55
    s_mov_b32 m0, s24
    s_nop 0
    buffer_load_dwordx4 v6, s[12:15], s24 offen lds
    s_add_u32 s24, s24, 8192
.Lnodma_55:
    ds_read_b128 v[20:23], v107 offset:1024
    ds_read_b64 v[28:29], v108 offset:256
    v_mfma_f32_32x32x16_bf16 v[88:103], v[36:39], v[84:87], v[88:103]
    ds_read_b128 v[32:35], v109 offset:0
    ds_read_b128 v[36:39], v109 offset:640
    s_waitcnt lgkmcnt(4)
    v_mfma_f32_32x32x16_bf16 v[48:63], v[16:19], v[8:11], 0
    v_exp_f32 v64, v64
    v_exp_f32 v65, v65
    v_exp_f32 v66, v66
    v_exp_f32 v67, v67
    v_mfma_f32_32x32x16_bf16 v[48:63], v[24:27], v[12:15], v[48:63]
    v_exp_f32 v68, v68
    v_exp_f32 v69, v69
    v_exp_f32 v70, v70
    v_exp_f32 v71, v71
    v_cvt_pk_bf16_f32 v80, v64, v65
    v_cvt_pk_bf16_f32 v81, v66, v67
    v_cvt_pk_bf16_f32 v82, v68, v69
    v_cvt_pk_bf16_f32 v83, v70, v71
    v_exp_f32 v72, v72
    v_exp_f32 v73, v73
    v_exp_f32 v74, v74
    v_exp_f32 v75, v75
    v_mfma_f32_32x32x16_bf16 v[88:103], v[40:43], v[80:83], v[88:103]
    v_exp_f32 v76, v76
    v_exp_f32 v77, v77
    v_exp_f32 v78, v78
    v_exp_f32 v79, v79
    v_cvt_pk_bf16_f32 v84, v72, v73
    v_cvt_pk_bf16_f32 v85, v74, v75
    v_cvt_pk_bf16_f32 v86, v76, v77
    v_cvt_pk_bf16_f32 v87, v78, v79
    s_cmp_ge_u32 s24, s25
    s_cbranch_scc1 .Lnodma_56
    s_mov_b32 m0, s24
    s_nop 0
    buffer_load_dwordx4 v6, s[12:15], s24 offen lds
    s_add_u32 s24, s24, 8192
.Lnodma_56:
    s_add_u32 s29, s29, 1
    s_add_u32 s30, s29, 1
    s_and_b32 s30, s30, 7
    s_mul_i32 s30, s30, 20480
    v_mov_b32 v104, v107
    v_add_u32 v107, s30, v110
    v_mov_b32 v105, v108
    v_add_u32 v108, s30, v111
    v_mov_b32 v106, v109
    v_add_u32 v109, s30, v112
    s_cmp_lt_u32 s29, 8
    s_cbranch_scc1 .Lloop_44
    v_mfma_f32_32x32x16_bf16 v[88:103], v[44:47], v[84:87], v[88:103]
    s_waitcnt lgkmcnt(0)
    s_nop 15
    s_nop 3
    s_mov_b32 s31, 0x71800000
    s_mov_b64 s[32:33], 0
    v_cmp_nlt_f32 s[34:35], |v88|, s31
    s_or_b64 s[32:33], s[32:33], s[34:35]
    v_cmp_nlt_f32 s[34:35], |v89|, s31
    s_or_b64 s[32:33], s[32:33], s[34:35]
    v_cmp_nlt_f32 s[34:35], |v90|, s31
    s_or_b64 s[32:33], s[32:33], s[34:35]
    v_cmp_nlt_f32 s[34:35], |v91|, s31
    s_or_b64 s[32:33], s[32:33], s[34:35]
    v_cmp_nlt_f32 s[34:35], |v92|, s31
    s_or_b64 s[32:33], s[32:33], s[34:35]
    v_cmp_nlt_f32 s[34:35], |v93|, s31
    s_or_b64 s[32:33], s[32:33], s[34:35]
    v_cmp_nlt_f32 s[34:35], |v94|, s31
    s_or_b64 s[32:33], s[32:33], s[34:35]
    v_cmp_nlt_f32 s[34:35], |v95|, s31
    s_or_b64 s[32:33], s[32:33], s[34:35]
    v_cmp_nlt_f32 s[34:35], |v96|, s31
    s_or_b64 s[32:33], s[32:33], s[34:35]
    v_cmp_nlt_f32 s[34:35], |v97|, s31
    s_or_b64 s[32:33], s[32:33], s[34:35]
    v_cmp_nlt_f32 s[34:35], |v98|, s31
    s_or_b64 s[32:33], s[32:33], s[34:35]
    s_cmp_eq_u64 s[32:33], 0
    s_cbranch_scc1 .Lepi_57
    s_cmp_eq_u32 s28, 0
    s_cbranch_scc1 .Lepi_57
    s_mov_b32 s28, 0
    s_waitcnt vmcnt(0)
    v_mov_b32 v13, 0
    v_mov_b32 v113, 0xff800000
    v_mov_b32 v104, v110
    v_mov_b32 v105, v111
    s_mov_b32 s29, 0
.Lfl_58:
    ds_read_b128 v[16:19], v104 offset:0
    ds_read_b64 v[24:25], v105 offset:0
    s_waitcnt lgkmcnt(0)
    v_mfma_f32_32x32x16_bf16 v[48:63], v[16:19], v[8:11], 0
    v_mfma_f32_32x32x16_bf16 v[48:63], v[24:27], v[12:15], v[48:63]
    s_nop 15
    v_max3_f32 v113, v113, v48, v49
    v_max3_f32 v113, v113, v50, v51
    v_max3_f32 v113, v113, v52, v53
    v_max3_f32 v113, v113, v54, v55
    v_max3_f32 v113, v113, v56, v57
    v_max3_f32 v113, v113, v58, v59
    v_max3_f32 v113, v113, v60, v61
    v_max3_f32 v113, v113, v62, v63
    ds_read_b128 v[16:19], v104 offset:1024
    ds_read_b64 v[24:25], v105 offset:256
    s_waitcnt lgkmcnt(0)
    v_mfma_f32_32x32x16_bf16 v[48:63], v[16:19], v[8:11], 0
    v_mfma_f32_32x32x16_bf16 v[48:63], v[24:27], v[12:15], v[48:63]
    s_nop 15
    v_max3_f32 v113, v113, v48, v49
    v_max3_f32 v113, v113, v50, v51
    v_max3_f32 v113, v113, v52, v53
    v_max3_f32 v113, v113, v54, v55
    v_max3_f32 v113, v113, v56, v57
    v_max3_f32 v113, v113, v58, v59
    v_max3_f32 v113, v113, v60, v61
    v_max3_f32 v113, v113, v62, v63
    ds_read_b128 v[16:19], v104 offset:2048
    ds_read_b64 v[24:25], v105 offset:512
    s_waitcnt lgkmcnt(0)
    v_mfma_f32_32x32x16_bf16 v[48:63], v[16:19], v[8:11], 0
    v_mfma_f32_32x32x16_bf16 v[48:63], v[24:27], v[12:15], v[48:63]
    s_nop 15
    v_max3_f32 v113, v113, v48, v49
    v_max3_f32 v113, v113, v50, v51
    v_max3_f32 v113, v113, v52, v53
    v_max3_f32 v113, v113, v54, v55
    v_max3_f32 v113, v113, v56, v57
    v_max3_f32 v113, v113, v58, v59
    v_max3_f32 v113, v113, v60, v61
    v_max3_f32 v113, v113, v62, v63
    ds_read_b128 v[16:19], v104 offset:3072
    ds_read_b64 v[24:25], v105 offset:768
    s_waitcnt lgkmcnt(0)
    v_mfma_f32_32x32x16_bf16 v[48:63], v[16:19], v[8:11], 0
    v_mfma_f32_32x32x16_bf16 v[48:63], v[24:27], v[12:15], v[48:63]
    s_nop 15
    v_max3_f32 v113, v113, v48, v49
    v_max3_f32 v113, v113, v50, v51
    v_max3_f32 v113, v113, v52, v53
    v_max3_f32 v113, v113, v54, v55
    v_max3_f32 v113, v113, v56, v57
    v_max3_f32 v113, v113, v58, v59
    v_max3_f32 v113, v113, v60, v61
    v_max3_f32 v113, v113, v62, v63
    ds_read_b128 v[16:19], v104 offset:4096
    ds_read_b64 v[24:25], v105 offset:1024
    s_waitcnt lgkmcnt(0)
    v_mfma_f32_32x32x16_bf16 v[48:63], v[16:19], v[8:11], 0
    v_mfma_f32_32x32x16_bf16 v[48:63], v[24:27], v[12:15], v[48:63]
    s_nop 15
    v_max3_f32 v113, v113, v48, v49
    v_max3_f32 v113, v113, v50, v51
    v_max3_f32 v113, v113, v52, v53
    v_max3_f32 v113, v113, v54, v55
    v_max3_f32 v113, v113, v56, v57
    v_max3_f32 v113, v113, v58, v59
    v_max3_f32 v113, v113, v60, v61
    v_max3_f32 v113, v113, v62, v63
    ds_read_b128 v[16:19], v104 offset:5120
    ds_read_b64 v[24:25], v105 offset:1280
    s_waitcnt lgkmcnt(0)
    v_mfma_f32_32x32x16_bf16 v[48:63], v[16:19], v[8:11], 0
    v_mfma_f32_32x32x16_bf16 v[48:63], v[24:27], v[12:15], v[48:63]
    s_nop 15
    v_max3_f32 v113, v113, v48, v49
    v_max3_f32 v113, v113, v50, v51
    v_max3_f32 v113, v113, v52, v53
    v_max3_f32 v113, v113, v54, v55
    v_max3_f32 v113, v113, v56, v57
    v_max3_f32 v113, v113, v58, v59
    v_max3_f32 v113, v113, v60, v61
    v_max3_f32 v113, v113, v62, v63
    ds_read_b128 v[16:19], v104 offset:6144
    ds_read_b64 v[24:25], v105 offset:1536
    s_waitcnt lgkmcnt(0)
    v_mfma_f32_32x32x16_bf16 v[48:63], v[16:19], v[8:11], 0
    v_mfma_f32_32x32x16_bf16 v[48:63], v[24:27], v[12:15], v[48:63]
    s_nop 15
    v_max3_f32 v113, v113, v48, v49
    v_max3_f32 v113, v113, v50, v51
    v_max3_f32 v113, v113, v52, v53
    v_max3_f32 v113, v113, v54, v55
    v_max3_f32 v113, v113, v56, v57
    v_max3_f32 v113, v113, v58, v59
    v_max3_f32 v113, v113, v60, v61
    v_max3_f32 v113, v113, v62, v63
    ds_read_b128 v[16:19], v104 offset:7168
    ds_read_b64 v[24:25], v105 offset:1792
    s_waitcnt lgkmcnt(0)
    v_mfma_f32_32x32x16_bf16 v[48:63], v[16:19], v[8:11], 0
    v_mfma_f32_32x32x16_bf16 v[48:63], v[24:27], v[12:15], v[48:63]
    s_nop 15
    v_max3_f32 v113, v113, v48, v49
    v_max3_f32 v113, v113, v50, v51
    v_max3_f32 v113, v113, v52, v53
    v_max3_f32 v113, v113, v54, v55
    v_max3_f32 v113, v113, v56, v57
    v_max3_f32 v113, v113, v58, v59
    v_max3_f32 v113, v113, v60, v61
    v_max3_f32 v113, v113, v62, v63
    v_add_u32 v104, 20480, v104
    v_add_u32 v105, 20480, v105
    s_add_u32 s29, s29, 1
    s_cmp_lt_u32 s29, 8
    s_cbranch_scc1 .Lfl_58
    s_branch .Lsetm_43
.Lepi_57:
    v_mov_b32 v113, v98
    v_mov_b32 v114, v98
    s_nop 1
    v_permlane32_swap_b32 v113, v114
    v_rcp_f32 v113, v113
    s_nop 0
    v_mul_f32 v88, v88, v113
    v_mul_f32 v89, v89, v113
    v_mul_f32 v90, v90, v113
    v_mul_f32 v91, v91, v113
    v_mul_f32 v92, v92, v113
    v_mul_f32 v93, v93, v113
    v_mul_f32 v94, v94, v113
    v_mul_f32 v95, v95, v113
    v_mul_f32 v96, v96, v113
    v_mul_f32 v97, v97, v113
    v_cvt_pk_bf16_f32 v80, v88, v89
    v_cvt_pk_bf16_f32 v81, v90, v91
    v_cvt_pk_bf16_f32 v82, v92, v93
    v_cvt_pk_bf16_f32 v83, v94, v95
    v_cvt_pk_bf16_f32 v84, v96, v97
    s_lshr_b32 s22, s21, 4
    s_mul_i32 s22, s22, 18432
    s_and_b32 s23, s21, 15
    s_lshl_b32 s23, s23, 4
    s_add_u32 s22, s22, s23
    v_mul_u32_u24 v4, 18, v2
    v_lshl_add_u32 v4, v3, 2, v4
    v_add_u32 v5, 0, v4
    v_lshrrev_b32 v6, 3, v5
    v_and_b32 v5, 7, v5
    v_lshlrev_b32 v5, 1, v5
    v_lshl_add_u32 v5, v6, 8, v5
    buffer_store_dword v80, v5, s[16:19], s22 offen
    v_add_u32 v5, 2, v4
    v_lshrrev_b32 v6, 3, v5
    v_and_b32 v5, 7, v5
    v_lshlrev_b32 v5, 1, v5
    v_lshl_add_u32 v5, v6, 8, v5
    buffer_store_dword v81, v5, s[16:19], s22 offen
    v_add_u32 v5, 8, v4
    v_lshrrev_b32 v6, 3, v5
    v_and_b32 v5, 7, v5
    v_lshlrev_b32 v5, 1, v5
    v_lshl_add_u32 v5, v6, 8, v5
    buffer_store_dword v82, v5, s[16:19], s22 offen
    v_add_u32 v5, 10, v4
    v_lshrrev_b32 v6, 3, v5
    v_and_b32 v5, 7, v5
    v_lshlrev_b32 v5, 1, v5
    v_lshl_add_u32 v5, v6, 8, v5
    buffer_store_dword v83, v5, s[16:19], s22 offen
    v_add_u32 v5, 16, v4
    v_lshrrev_b32 v6, 3, v5
    v_and_b32 v5, 7, v5
    v_lshlrev_b32 v5, 1, v5
    v_lshl_add_u32 v5, v6, 8, v5
    s_and_b64 exec, exec, s[26:27]
    buffer_store_dword v84, v5, s[16:19], s22 offen
    s_mov_b64 exec, -1
.Lend_42:
    s_endpgm
.section .rodata,"a"
.p2align 6
.amdhsa_kernel attn_kernel
  .amdhsa_next_free_vgpr 120
  .amdhsa_next_free_sgpr 100
  .amdhsa_accum_offset 120
  .amdhsa_group_segment_fixed_size 0
  .amdhsa_kernarg_size 88
  .amdhsa_user_sgpr_count 2
  .amdhsa_user_sgpr_kernarg_segment_ptr 1
  .amdhsa_system_sgpr_workgroup_id_x 1
.end_amdhsa_kernel
.text
.globl outa2_kernel
.p2align 8
.type outa2_kernel,@function
outa2_kernel:
    s_cmp_ge_u32 s2, 192
    s_cbranch_scc1 .Lend_59
    s_load_dwordx2 s[4:5], s[0:1], 80
    s_lshr_b32 s28, s2, 3
    s_mul_i32 s3, s28, 43691
    s_lshr_b32 s3, s3, 18
    s_mul_i32 s29, s3, 6
    s_sub_u32 s28, s28, s29
    s_and_b32 s29, s2, 7
    s_lshl_b32 s29, s29, 2
    s_add_u32 s3, s3, s29
    v_and_b32 v1, 63, v0
    v_lshrrev_b32 v11, 6, v0
    s_nop 0
    v_readfirstlane_b32 s29, v11
    v_and_b32 v12, 15, v1
    v_lshrrev_b32 v13, 4, v1
    v_lshlrev_b32 v4, 4, v1
    s_lshl_b32 s30, s3, 2
    s_add_u32 s30, s30, s29
    s_mul_i32 s31, s30, 18432
    v_add_u32 v2, s31, v4
    s_mov_b32 s41, 4096
    s_mov_b32 s42, 8192
    s_mov_b32 s43, 12288
    s_mov_b32 s44, 16384
    s_mov_b32 s40, 0
    s_waitcnt lgkmcnt(0)
    s_add_u32 s12, s4, 0x900000
    s_addc_u32 s13, s5, 0
    s_mov_b32 s14, 0x240000
    s_mov_b32 s15, 0x00020000
    s_lshl_b32 s34, s29, 10
    s_add_u32 s16, s4, 0x10a2000
    s_addc_u32 s17, s5, 0
    s_mov_b32 s18, 0xa2000
    s_mov_b32 s19, 0x00020000
    s_mul_i32 s33, s28, 110592
    s_add_u32 s33, s33, s34
    buffer_load_dwordx4 v[16:19], v2, s[12:15], s40 offen offset:0
    buffer_load_dwordx4 v[20:23], v2, s[12:15], s40 offen offset:1024
    s_add_u32 m0, s34, 0
    s_add_u32 s35, s33, 0
    buffer_load_dwordx4 v4, s[16:19], s35 offen lds
    s_add_u32 m0, s34, 4096
    s_add_u32 s35, s33, 4096
    buffer_load_dwordx4 v4, s[16:19], s35 offen lds
    s_add_u32 m0, s34, 8192
    s_add_u32 s35, s33, 8192
    buffer_load_dwordx4 v4, s[16:19], s35 offen lds
    buffer_load_dwordx4 v[24:27], v2, s[12:15], s40 offen offset:2048
    buffer_load_dwordx4 v[28:31], v2, s[12:15], s40 offen offset:3072
    s_add_u32 m0, s34, 12288
    s_add_u32 s35, s33, 12288
    buffer_load_dwordx4 v4, s[16:19], s35 offen lds
    s_add_u32 m0, s34, 16384
    s_add_u32 s35, s33, 16384
    buffer_load_dwordx4 v4, s[16:19], s35 offen lds
    s_add_u32 m0, s34, 20480
    s_add_u32 s35, s33, 20480
    buffer_load_dwordx4 v4, s[16:19], s35 offen lds
    buffer_load_dwordx4 v[32:35], v2, s[12:15], s41 offen offset:0
    buffer_load_dwordx4 v[36:39], v2, s[12:15], s41 offen offset:1024
    s_add_u32 m0, s34, 24576
    s_add_u32 s35, s33, 24576
    buffer_load_dwordx4 v4, s[16:19], s35 offen lds
    s_add_u32 m0, s34, 28672
    s_add_u32 s35, s33, 28672
    buffer_load_dwordx4 v4, s[16:19], s35 offen lds
    s_add_u32 m0, s34, 32768
    s_add_u32 s35, s33, 32768
    buffer_load_dwordx4 v4, s[16:19], s35 offen lds
    v_add_u32 v5, 55296, v4
    v_mov_b32 v136, 0
    v_mov_b32 v137, 0
    v_mov_b32 v138, 0
    v_mov_b32 v139, 0
    v_mov_b32 v140, 0
    v_mov_b32 v141, 0
    v_mov_b32 v142, 0
    v_mov_b32 v143, 0
    v_mov_b32 v144, 0
    v_mov_b32 v145, 0
    v_mov_b32 v146, 0
    v_mov_b32 v147, 0
    v_mov_b32 v148, 0
    v_mov_b32 v149, 0
    v_mov_b32 v150, 0
    v_mov_b32 v151, 0
    v_mov_b32 v152, 0
    v_mov_b32 v153, 0
    v_mov_b32 v154, 0
    v_mov_b32 v155, 0
    v_mov_b32 v156, 0
    v_mov_b32 v157, 0
    v_mov_b32 v158, 0
    v_mov_b32 v159, 0
    s_waitcnt vmcnt(10)
    s_barrier
    ds_read_b128 v[88:91], v4 offset:0
    ds_read_b128 v[92:95], v4 offset:1024
    ds_read_b128 v[96:99], v4 offset:2048
    ds_read_b128 v[100:103], v4 offset:3072
    ds_read_b128 v[104:107], v4 offset:4096
    ds_read_b128 v[108:111], v4 offset:5120
    ds_read_b128 v[112:115], v4 offset:6144
    ds_read_b128 v[116:119], v4 offset:7168
    ds_read_b128 v[120:123], v4 offset:8192
    ds_read_b128 v[124:127], v4 offset:9216
    ds_read_b128 v[128:131], v4 offset:10240
    ds_read_b128 v[132:135], v4 offset:11264
    buffer_load_dwordx4 v[40:43], v2, s[12:15], s41 offen offset:2048
    buffer_load_dwordx4 v[44:47], v2, s[12:15], s41 offen offset:3072
    s_add_u32 m0, s34, 36864
    s_add_u32 s35, s33, 36864
    buffer_load_dwordx4 v4, s[16:19], s35 offen lds
    s_add_u32 m0, s34, 40960
    s_add_u32 s35, s33, 40960
    buffer_load_dwordx4 v4, s[16:19], s35 offen lds
    s_add_u32 m0, s34, 45056
    s_add_u32 s35, s33, 45056
    buffer_load_dwordx4 v4, s[16:19], s35 offen lds
    s_waitcnt lgkmcnt(6)
    v_mfma_f32_16x16x32_bf16 v[136:139], v[88:91], v[16:19], v[136:139]
    v_mfma_f32_16x16x32_bf16 v[140:143], v[92:95], v[16:19], v[140:143]
    v_mfma_f32_16x16x32_bf16 v[144:147], v[96:99], v[16:19], v[144:147]
    v_mfma_f32_16x16x32_bf16 v[148:151], v[100:103], v[16:19], v[148:151]
    v_mfma_f32_16x16x32_bf16 v[152:155], v[104:107], v[16:19], v[152:155]
    v_mfma_f32_16x16x32_bf16 v[156:159], v[108:111], v[16:19], v[156:159]
    s_waitcnt lgkmcnt(0)
    s_waitcnt vmcnt(10)
    s_barrier
    ds_read_b128 v[88:91], v4 offset:12288
    ds_read_b128 v[92:95], v4 offset:13312
    ds_read_b128 v[96:99], v4 offset:14336
    ds_read_b128 v[100:103], v4 offset:15360
    ds_read_b128 v[104:107], v4 offset:16384
    ds_read_b128 v[108:111], v4 offset:17408
    v_mfma_f32_16x16x32_bf16 v[136:139], v[112:115], v[20:23], v[136:139]
    v_mfma_f32_16x16x32_bf16 v[140:143], v[116:119], v[20:23], v[140:143]
    v_mfma_f32_16x16x32_bf16 v[144:147], v[120:123], v[20:23], v[144:147]
    v_mfma_f32_16x16x32_bf16 v[148:151], v[124:127], v[20:23], v[148:151]
    v_mfma_f32_16x16x32_bf16 v[152:155], v[128:131], v[20:23], v[152:155]
    v_mfma_f32_16x16x32_bf16 v[156:159], v[132:135], v[20:23], v[156:159]
    ds_read_b128 v[112:115], v4 offset:18432
    ds_read_b128 v[116:119], v4 offset:19456
    ds_read_b128 v[120:123], v4 offset:20480
    ds_read_b128 v[124:127], v4 offset:21504
    ds_read_b128 v[128:131], v4 offset:22528
    ds_read_b128 v[132:135], v4 offset:23552
    buffer_load_dwordx4 v[48:51], v2, s[12:15], s42 offen offset:0
    buffer_load_dwordx4 v[52:55], v2, s[12:15], s42 offen offset:1024
    s_add_u32 m0, s34, 49152
    s_add_u32 s35, s33, 49152
    buffer_load_dwordx4 v4, s[16:19], s35 offen lds
    s_add_u32 m0, s34, 53248
    s_add_u32 s35, s33, 53248
    buffer_load_dwordx4 v4, s[16:19], s35 offen lds
    s_add_u32 m0, s34, 57344
    s_add_u32 s35, s33, 57344
    buffer_load_dwordx4 v4, s[16:19], s35 offen lds
    s_waitcnt lgkmcnt(6)
    v_mfma_f32_16x16x32_bf16 v[136:139], v[88:91], v[24:27], v[136:139]
    v_mfma_f32_16x16x32_bf16 v[140:143], v[92:95], v[24:27], v[140:143]
    v_mfma_f32_16x16x32_bf16 v[144:147], v[96:99], v[24:27], v[144:147]
    v_mfma_f32_16x16x32_bf16 v[148:151], v[100:103], v[24:27], v[148:151]
    v_mfma_f32_16x16x32_bf16 v[152:155], v[104:107], v[24:27], v[152:155]
    v_mfma_f32_16x16x32_bf16 v[156:159], v[108:111], v[24:27], v[156:159]
    s_waitcnt lgkmcnt(0)
    s_waitcnt vmcnt(10)
    s_barrier
    ds_read_b128 v[88:91], v4 offset:24576
    ds_read_b128 v[92:95], v4 offset:25600
    ds_read_b128 v[96:99], v4 offset:26624
    ds_read_b128 v[100:103], v4 offset:27648
    ds_read_b128 v[104:107], v4 offset:28672
    ds_read_b128 v[108:111], v4 offset:29696
    v_mfma_f32_16x16x32_bf16 v[136:139], v[112:115], v[28:31], v[136:139]
    v_mfma_f32_16x16x32_bf16 v[140:143], v[116:119], v[28:31], v[140:143]
    v_mfma_f32_16x16x32_bf16 v[144:147], v[120:123], v[28:31], v[144:147]
    v_mfma_f32_16x16x32_bf16 v[148:151], v[124:127], v[28:31], v[148:151]
    v_mfma_f32_16x16x32_bf16 v[152:155], v[128:131], v[28:31], v[152:155]
    v_mfma_f32_16x16x32_bf16 v[156:159], v[132:135], v[28:31], v[156:159]
    ds_read_b128 v[112:115], v4 offset:30720
    ds_read_b128 v[116:119], v4 offset:31744
    ds_read_b128 v[120:123], v4 offset:32768
    ds_read_b128 v[124:127], v4 offset:33792
    ds_read_b128 v[128:131], v4 offset:34816
    ds_read_b128 v[132:135], v4 offset:35840
    buffer_load_dwordx4 v[56:59], v2, s[12:15], s42 offen offset:2048
    buffer_load_dwordx4 v[60:63], v2, s[12:15], s42 offen offset:3072
    s_add_u32 m0, s34, 61440
    s_add_u32 s35, s33, 61440
    buffer_load_dwordx4 v4, s[16:19], s35 offen lds
    s_add_u32 m0, s34, 65536
    s_add_u32 s35, s33, 65536
    buffer_load_dwordx4 v4, s[16:19], s35 offen lds
    s_add_u32 m0, s34, 69632
    s_add_u32 s35, s33, 69632
    buffer_load_dwordx4 v4, s[16:19], s35 offen lds
    s_waitcnt lgkmcnt(6)
    v_mfma_f32_16x16x32_bf16 v[136:139], v[88:91], v[32:35], v[136:139]
    v_mfma_f32_16x16x32_bf16 v[140:143], v[92:95], v[32:35], v[140:143]
    v_mfma_f32_16x16x32_bf16 v[144:147], v[96:99], v[32:35], v[144:147]
    v_mfma_f32_16x16x32_bf16 v[148:151], v[100:103], v[32:35], v[148:151]
    v_mfma_f32_16x16x32_bf16 v[152:155], v[104:107], v[32:35], v[152:155]
    v_mfma_f32_16x16x32_bf16 v[156:159], v[108:111], v[32:35], v[156:159]
    s_waitcnt lgkmcnt(0)
    s_waitcnt vmcnt(10)
    s_barrier
    ds_read_b128 v[88:91], v4 offset:36864
    ds_read_b128 v[92:95], v4 offset:37888
    ds_read_b128 v[96:99], v4 offset:38912
    ds_read_b128 v[100:103], v4 offset:39936
    ds_read_b128 v[104:107], v4 offset:40960
    ds_read_b128 v[108:111], v4 offset:41984
    v_mfma_f32_16x16x32_bf16 v[136:139], v[112:115], v[36:39], v[136:139]
    v_mfma_f32_16x16x32_bf16 v[140:143], v[116:119], v[36:39], v[140:143]
    v_mfma_f32_16x16x32_bf16 v[144:147], v[120:123], v[36:39], v[144:147]
    v_mfma_f32_16x16x32_bf16 v[148:151], v[124:127], v[36:39], v[148:151]
    v_mfma_f32_16x16x32_bf16 v[152:155], v[128:131], v[36:39], v[152:155]
    v_mfma_f32_16x16x32_bf16 v[156:159], v[132:135], v[36:39], v[156:159]
    ds_read_b128 v[112:115], v4 offset:43008
    ds_read_b128 v[116:119], v4 offset:44032
    ds_read_b128 v[120:123], v4 offset:45056
    ds_read_b128 v[124:127], v4 offset:46080
    ds_read_b128 v[128:131], v4 offset:47104
    ds_read_b128 v[132:135], v4 offset:48128
    buffer_load_dwordx4 v[64:67], v2, s[12:15], s43 offen offset:0
    buffer_load_dwordx4 v[68:71], v2, s[12:15], s43 offen offset:1024
    s_add_u32 m0, s34, 73728
    s_add_u32 s35, s33, 73728
    buffer_load_dwordx4 v4, s[16:19], s35 offen lds
    s_add_u32 m0, s34, 77824
    s_add_u32 s35, s33, 77824
    buffer_load_dwordx4 v4, s[16:19], s35 offen lds
    s_add_u32 m0, s34, 81920
    s_add_u32 s35, s33, 81920
    buffer_load_dwordx4 v4, s[16:19], s35 offen lds
    s_waitcnt lgkmcnt(6)
    v_mfma_f32_16x16x32_bf16 v[136:139], v[88:91], v[40:43], v[136:139]
    v_mfma_f32_16x16x32_bf16 v[140:143], v[92:95], v[40:43], v[140:143]
    v_mfma_f32_16x16x32_bf16 v[144:147], v[96:99], v[40:43], v[144:147]
    v_mfma_f32_16x16x32_bf16 v[148:151], v[100:103], v[40:43], v[148:151]
    v_mfma_f32_16x16x32_bf16 v[152:155], v[104:107], v[40:43], v[152:155]
    v_mfma_f32_16x16x32_bf16 v[156:159], v[108:111], v[40:43], v[156:159]
    s_waitcnt lgkmcnt(0)
    s_waitcnt vmcnt(10)
    s_barrier
    ds_read_b128 v[88:91], v4 offset:49152
    ds_read_b128 v[92:95], v4 offset:50176
    ds_read_b128 v[96:99], v4 offset:51200
    ds_read_b128 v[100:103], v4 offset:52224
    ds_read_b128 v[104:107], v4 offset:53248
    ds_read_b128 v[108:111], v4 offset:54272
    v_mfma_f32_16x16x32_bf16 v[136:139], v[112:115], v[44:47], v[136:139]
    v_mfma_f32_16x16x32_bf16 v[140:143], v[116:119], v[44:47], v[140:143]
    v_mfma_f32_16x16x32_bf16 v[144:147], v[120:123], v[44:47], v[144:147]
    v_mfma_f32_16x16x32_bf16 v[148:151], v[124:127], v[44:47], v[148:151]
    v_mfma_f32_16x16x32_bf16 v[152:155], v[128:131], v[44:47], v[152:155]
    v_mfma_f32_16x16x32_bf16 v[156:159], v[132:135], v[44:47], v[156:159]
    ds_read_b128 v[112:115], v5 offset:0
    ds_read_b128 v[116:119], v5 offset:1024
    ds_read_b128 v[120:123], v5 offset:2048
    ds_read_b128 v[124:127], v5 offset:3072
    ds_read_b128 v[128:131], v5 offset:4096
    ds_read_b128 v[132:135], v5 offset:5120
    buffer_load_dwordx4 v[72:75], v2, s[12:15], s43 offen offset:2048
    buffer_load_dwordx4 v[76:79], v2, s[12:15], s43 offen offset:3072
    s_add_u32 m0, s34, 86016
    s_add_u32 s35, s33, 86016
    buffer_load_dwordx4 v4, s[16:19], s35 offen lds
    s_add_u32 m0, s34, 90112
    s_add_u32 s35, s33, 90112
    buffer_load_dwordx4 v4, s[16:19], s35 offen lds
    s_add_u32 m0, s34, 94208
    s_add_u32 s35, s33, 94208
    buffer_load_dwordx4 v4, s[16:19], s35 offen lds
    s_waitcnt lgkmcnt(6)
    v_mfma_f32_16x16x32_bf16 v[136:139], v[88:91], v[48:51], v[136:139]
    v_mfma_f32_16x16x32_bf16 v[140:143], v[92:95], v[48:51], v[140:143]
    v_mfma_f32_16x16x32_bf16 v[144:147], v[96:99], v[48:51], v[144:147]
    v_mfma_f32_16x16x32_bf16 v[148:151], v[100:103], v[48:51], v[148:151]
    v_mfma_f32_16x16x32_bf16 v[152:155], v[104:107], v[48:51], v[152:155]
    v_mfma_f32_16x16x32_bf16 v[156:159], v[108:111], v[48:51], v[156:159]
    s_waitcnt lgkmcnt(0)
    s_waitcnt vmcnt(10)
    s_barrier
    ds_read_b128 v[88:91], v5 offset:6144
    ds_read_b128 v[92:95], v5 offset:7168
    ds_read_b128 v[96:99], v5 offset:8192
    ds_read_b128 v[100:103], v5 offset:9216
    ds_read_b128 v[104:107], v5 offset:10240
    ds_read_b128 v[108:111], v5 offset:11264
    v_mfma_f32_16x16x32_bf16 v[136:139], v[112:115], v[52:55], v[136:139]
    v_mfma_f32_16x16x32_bf16 v[140:143], v[116:119], v[52:55], v[140:143]
    v_mfma_f32_16x16x32_bf16 v[144:147], v[120:123], v[52:55], v[144:147]
    v_mfma_f32_16x16x32_bf16 v[148:151], v[124:127], v[52:55], v[148:151]
    v_mfma_f32_16x16x32_bf16 v[152:155], v[128:131], v[52:55], v[152:155]
    v_mfma_f32_16x16x32_bf16 v[156:159], v[132:135], v[52:55], v[156:159]
    ds_read_b128 v[112:115], v5 offset:12288
    ds_read_b128 v[116:119], v5 offset:13312
    ds_read_b128 v[120:123], v5 offset:14336
    ds_read_b128 v[124:127], v5 offset:15360
    ds_read_b128 v[128:131], v5 offset:16384
    ds_read_b128 v[132:135], v5 offset:17408
    buffer_load_dwordx4 v[80:83], v2, s[12:15], s44 offen offset:0
    buffer_load_dwordx4 v[84:87], v2, s[12:15], s44 offen offset:1024
    s_add_u32 m0, s34, 98304
    s_add_u32 s35, s33, 98304
    buffer_load_dwordx4 v4, s[16:19], s35 offen lds
    s_add_u32 m0, s34, 102400
    s_add_u32 s35, s33, 102400
    buffer_load_dwordx4 v4, s[16:19], s35 offen lds
    s_add_u32 m0, s34, 106496
    s_add_u32 s35, s33, 106496
    buffer_load_dwordx4 v4, s[16:19], s35 offen lds
    s_waitcnt lgkmcnt(6)
    v_mfma_f32_16x16x32_bf16 v[136:139], v[88:91], v[56:59], v[136:139]
    v_mfma_f32_16x16x32_bf16 v[140:143], v[92:95], v[56:59], v[140:143]
    v_mfma_f32_16x16x32_bf16 v[144:147], v[96:99], v[56:59], v[144:147]
    v_mfma_f32_16x16x32_bf16 v[148:151], v[100:103], v[56:59], v[148:151]
    v_mfma_f32_16x16x32_bf16 v[152:155], v[104:107], v[56:59], v[152:155]
    v_mfma_f32_16x16x32_bf16 v[156:159], v[108:111], v[56:59], v[156:159]
    s_waitcnt lgkmcnt(0)
    s_waitcnt vmcnt(10)
    s_barrier
    ds_read_b128 v[88:91], v5 offset:18432
    ds_read_b128 v[92:95], v5 offset:19456
    ds_read_b128 v[96:99], v5 offset:20480
    ds_read_b128 v[100:103], v5 offset:21504
    ds_read_b128 v[104:107], v5 offset:22528
    ds_read_b128 v[108:111], v5 offset:23552
    v_mfma_f32_16x16x32_bf16 v[136:139], v[112:115], v[60:63], v[136:139]
    v_mfma_f32_16x16x32_bf16 v[140:143], v[116:119], v[60:63], v[140:143]
    v_mfma_f32_16x16x32_bf16 v[144:147], v[120:123], v[60:63], v[144:147]
    v_mfma_f32_16x16x32_bf16 v[148:151], v[124:127], v[60:63], v[148:151]
    v_mfma_f32_16x16x32_bf16 v[152:155], v[128:131], v[60:63], v[152:155]
    v_mfma_f32_16x16x32_bf16 v[156:159], v[132:135], v[60:63], v[156:159]
    ds_read_b128 v[112:115], v5 offset:24576
    ds_read_b128 v[116:119], v5 offset:25600
    ds_read_b128 v[120:123], v5 offset:26624
    ds_read_b128 v[124:127], v5 offset:27648
    ds_read_b128 v[128:131], v5 offset:28672
    ds_read_b128 v[132:135], v5 offset:29696
    s_add_u32 s20, s4, 0x240000
    s_addc_u32 s21, s5, 0
    s_mov_b32 s22, 0x240000
    s_mov_b32 s23, 0x00020000
    v_lshrrev_b32 v3, 1, v13
    v_lshlrev_b32 v3, 8, v3
    v_lshl_add_u32 v3, v12, 4, v3
    v_and_b32 v11, 1, v13
    v_lshl_add_u32 v3, v11, 3, v3
    s_mul_i32 s36, s28, 3072
    s_add_u32 s36, s36, s31
    v_add_u32 v3, s36, v3
    buffer_load_dwordx2 v[160:161], v3, s[20:23], 0 offen offset:0
    buffer_load_dwordx2 v[162:163], v3, s[20:23], 0 offen offset:512
    buffer_load_dwordx2 v[164:165], v3, s[20:23], 0 offen offset:1024
    buffer_load_dwordx2 v[166:167], v3, s[20:23], 0 offen offset:1536
    buffer_load_dwordx2 v[168:169], v3, s[20:23], 0 offen offset:2048
    buffer_load_dwordx2 v[170:171], v3, s[20:23], 0 offen offset:2560
    s_waitcnt lgkmcnt(6)
    v_mfma_f32_16x16x32_bf16 v[136:139], v[88:91], v[64:67], v[136:139]
    v_mfma_f32_16x16x32_bf16 v[140:143], v[92:95], v[64:67], v[140:143]
    v_mfma_f32_16x16x32_bf16 v[144:147], v[96:99], v[64:67], v[144:147]
    v_mfma_f32_16x16x32_bf16 v[148:151], v[100:103], v[64:67], v[148:151]
    v_mfma_f32_16x16x32_bf16 v[152:155], v[104:107], v[64:67], v[152:155]
    v_mfma_f32_16x16x32_bf16 v[156:159], v[108:111], v[64:67], v[156:159]
    s_waitcnt lgkmcnt(0)
    s_waitcnt vmcnt(11)
    s_barrier
    ds_read_b128 v[88:91], v5 offset:30720
    ds_read_b128 v[92:95], v5 offset:31744
    ds_read_b128 v[96:99], v5 offset:32768
    ds_read_b128 v[100:103], v5 offset:33792
    ds_read_b128 v[104:107], v5 offset:34816
    ds_read_b128 v[108:111], v5 offset:35840
    v_mfma_f32_16x16x32_bf16 v[136:139], v[112:115], v[68:71], v[136:139]
    v_mfma_f32_16x16x32_bf16 v[140:143], v[116:119], v[68:71], v[140:143]
    v_mfma_f32_16x16x32_bf16 v[144:147], v[120:123], v[68:71], v[144:147]
    v_mfma_f32_16x16x32_bf16 v[148:151], v[124:127], v[68:71], v[148:151]
    v_mfma_f32_16x16x32_bf16 v[152:155], v[128:131], v[68:71], v[152:155]
    v_mfma_f32_16x16x32_bf16 v[156:159], v[132:135], v[68:71], v[156:159]
    ds_read_b128 v[112:115], v5 offset:36864
    ds_read_b128 v[116:119], v5 offset:37888
    ds_read_b128 v[120:123], v5 offset:38912
    ds_read_b128 v[124:127], v5 offset:39936
    ds_read_b128 v[128:131], v5 offset:40960
    ds_read_b128 v[132:135], v5 offset:41984
    s_waitcnt lgkmcnt(6)
    v_mfma_f32_16x16x32_bf16 v[136:139], v[88:91], v[72:75], v[136:139]
    v_mfma_f32_16x16x32_bf16 v[140:143], v[92:95], v[72:75], v[140:143]
    v_mfma_f32_16x16x32_bf16 v[144:147], v[96:99], v[72:75], v[144:147]
    v_mfma_f32_16x16x32_bf16 v[148:151], v[100:103], v[72:75], v[148:151]
    v_mfma_f32_16x16x32_bf16 v[152:155], v[104:107], v[72:75], v[152:155]
    v_mfma_f32_16x16x32_bf16 v[156:159], v[108:111], v[72:75], v[156:159]
    s_waitcnt lgkmcnt(0)
    s_waitcnt vmcnt(6)
    s_barrier
    ds_read_b128 v[88:91], v5 offset:43008
    ds_read_b128 v[92:95], v5 offset:44032
    ds_read_b128 v[96:99], v5 offset:45056
    ds_read_b128 v[100:103], v5 offset:46080
    ds_read_b128 v[104:107], v5 offset:47104
    ds_read_b128 v[108:111], v5 offset:48128
    v_mfma_f32_16x16x32_bf16 v[136:139], v[112:115], v[76:79], v[136:139]
    v_mfma_f32_16x16x32_bf16 v[140:143], v[116:119], v[76:79], v[140:143]
    v_mfma_f32_16x16x32_bf16 v[144:147], v[120:123], v[76:79], v[144:147]
    v_mfma_f32_16x16x32_bf16 v[148:151], v[124:127], v[76:79], v[148:151]
    v_mfma_f32_16x16x32_bf16 v[152:155], v[128:131], v[76:79], v[152:155]
    v_mfma_f32_16x16x32_bf16 v[156:159], v[132:135], v[76:79], v[156:159]
    ds_read_b128 v[112:115], v5 offset:49152
    ds_read_b128 v[116:119], v5 offset:50176
    ds_read_b128 v[120:123], v5 offset:51200
    ds_read_b128 v[124:127], v5 offset:52224
    ds_read_b128 v[128:131], v5 offset:53248
    ds_read_b128 v[132:135], v5 offset:54272
    s_waitcnt lgkmcnt(6)
    v_mfma_f32_16x16x32_bf16 v[136:139], v[88:91], v[80:83], v[136:139]
    v_mfma_f32_16x16x32_bf16 v[140:143], v[92:95], v[80:83], v[140:143]
    v_mfma_f32_16x16x32_bf16 v[144:147], v[96:99], v[80:83], v[144:147]
    v_mfma_f32_16x16x32_bf16 v[148:151], v[100:103], v[80:83], v[148:151]
    v_mfma_f32_16x16x32_bf16 v[152:155], v[104:107], v[80:83], v[152:155]
    v_mfma_f32_16x16x32_bf16 v[156:159], v[108:111], v[80:83], v[156:159]
    s_waitcnt lgkmcnt(0)
    v_mfma_f32_16x16x32_bf16 v[136:139], v[112:115], v[84:87], v[136:139]
    v_mfma_f32_16x16x32_bf16 v[140:143], v[116:119], v[84:87], v[140:143]
    v_mfma_f32_16x16x32_bf16 v[144:147], v[120:123], v[84:87], v[144:147]
    v_mfma_f32_16x16x32_bf16 v[148:151], v[124:127], v[84:87], v[148:151]
    v_mfma_f32_16x16x32_bf16 v[152:155], v[128:131], v[84:87], v[152:155]
    v_mfma_f32_16x16x32_bf16 v[156:159], v[132:135], v[84:87], v[156:159]
    s_nop 7
    s_add_u32 s24, s4, 0x480000
    s_addc_u32 s25, s5, 0
    s_mov_b32 s26, 0x240000
    s_mov_b32 s27, 0x00020000
    s_mov_b32 s36, 0xffff0000
    s_waitcnt vmcnt(0)
    v_cvt_pk_bf16_f32 v136, v136, v137
    v_cvt_pk_bf16_f32 v137, v138, v139
    v_lshlrev_b32 v11, 16, v136
    v_and_b32 v15, s36, v136
    v_lshlrev_b32 v138, 16, v160
    v_and_b32 v139, s36, v160
    v_add_f32 v11, v11, v138
    v_add_f32 v15, v15, v139
    v_cvt_pk_bf16_f32 v160, v11, v15
    v_lshlrev_b32 v11, 16, v137
    v_and_b32 v15, s36, v137
    v_lshlrev_b32 v138, 16, v161
    v_and_b32 v139, s36, v161
    v_add_f32 v11, v11, v138
    v_add_f32 v15, v15, v139
    v_cvt_pk_bf16_f32 v161, v11, v15
    buffer_store_dwordx2 v[160:161], v3, s[24:27], 0 offen offset:0
    v_cvt_pk_bf16_f32 v140, v140, v141
    v_cvt_pk_bf16_f32 v141, v142, v143
    v_lshlrev_b32 v11, 16, v140
    v_and_b32 v15, s36, v140
    v_lshlrev_b32 v142, 16, v162
    v_and_b32 v143, s36, v162
    v_add_f32 v11, v11, v142
    v_add_f32 v15, v15, v143
    v_cvt_pk_bf16_f32 v162, v11, v15
    v_lshlrev_b32 v11, 16, v141
    v_and_b32 v15, s36, v141
    v_lshlrev_b32 v142, 16, v163
    v_and_b32 v143, s36, v163
    v_add_f32 v11, v11, v142
    v_add_f32 v15, v15, v143
    v_cvt_pk_bf16_f32 v163, v11, v15
    buffer_store_dwordx2 v[162:163], v3, s[24:27], 0 offen offset:512
    v_cvt_pk_bf16_f32 v144, v144, v145
    v_cvt_pk_bf16_f32 v145, v146, v147
    v_lshlrev_b32 v11, 16, v144
    v_and_b32 v15, s36, v144
    v_lshlrev_b32 v146, 16, v164
    v_and_b32 v147, s36, v164
    v_add_f32 v11, v11, v146
    v_add_f32 v15, v15, v147
    v_cvt_pk_bf16_f32 v164, v11, v15
    v_lshlrev_b32 v11, 16, v145
    v_and_b32 v15, s36, v145
    v_lshlrev_b32 v146, 16, v165
    v_and_b32 v147, s36, v165
    v_add_f32 v11, v11, v146
    v_add_f32 v15, v15, v147
    v_cvt_pk_bf16_f32 v165, v11, v15
    buffer_store_dwordx2 v[164:165], v3, s[24:27], 0 offen offset:1024
    v_cvt_pk_bf16_f32 v148, v148, v149
    v_cvt_pk_bf16_f32 v149, v150, v151
    v_lshlrev_b32 v11, 16, v148
    v_and_b32 v15, s36, v148
    v_lshlrev_b32 v150, 16, v166
    v_and_b32 v151, s36, v166
    v_add_f32 v11, v11, v150
    v_add_f32 v15, v15, v151
    v_cvt_pk_bf16_f32 v166, v11, v15
    v_lshlrev_b32 v11, 16, v149
    v_and_b32 v15, s36, v149
    v_lshlrev_b32 v150, 16, v167
    v_and_b32 v151, s36, v167
    v_add_f32 v11, v11, v150
    v_add_f32 v15, v15, v151
    v_cvt_pk_bf16_f32 v167, v11, v15
    buffer_store_dwordx2 v[166:167], v3, s[24:27], 0 offen offset:1536
    v_cvt_pk_bf16_f32 v152, v152, v153
    v_cvt_pk_bf16_f32 v153, v154, v155
    v_lshlrev_b32 v11, 16, v152
    v_and_b32 v15, s36, v152
    v_lshlrev_b32 v154, 16, v168
    v_and_b32 v155, s36, v168
    v_add_f32 v11, v11, v154
    v_add_f32 v15, v15, v155
    v_cvt_pk_bf16_f32 v168, v11, v15
    v_lshlrev_b32 v11, 16, v153
    v_and_b32 v15, s36, v153
    v_lshlrev_b32 v154, 16, v169
    v_and_b32 v155, s36, v169
    v_add_f32 v11, v11, v154
    v_add_f32 v15, v15, v155
    v_cvt_pk_bf16_f32 v169, v11, v15
    buffer_store_dwordx2 v[168:169], v3, s[24:27], 0 offen offset:2048
    v_cvt_pk_bf16_f32 v156, v156, v157
    v_cvt_pk_bf16_f32 v157, v158, v159
    v_lshlrev_b32 v11, 16, v156
    v_and_b32 v15, s36, v156
    v_lshlrev_b32 v158, 16, v170
    v_and_b32 v159, s36, v170
    v_add_f32 v11, v11, v158
    v_add_f32 v15, v15, v159
    v_cvt_pk_bf16_f32 v170, v11, v15
    v_lshlrev_b32 v11, 16, v157
    v_and_b32 v15, s36, v157
    v_lshlrev_b32 v158, 16, v171
    v_and_b32 v159, s36, v171
    v_add_f32 v11, v11, v158
    v_add_f32 v15, v15, v159
    v_cvt_pk_bf16_f32 v171, v11, v15
    buffer_store_dwordx2 v[170:171], v3, s[24:27], 0 offen offset:2560
    s_mov_b32 s36, 0x3f803f80
    v_mov_b32 v88, 0
    v_mov_b32 v89, 0
    v_mov_b32 v90, 0
    v_mov_b32 v91, 0
    v_dot2_f32_bf16 v88, v160, s36, v88
    v_dot2_f32_bf16 v90, v160, v160, v90
    v_dot2_f32_bf16 v89, v161, s36, v89
    v_dot2_f32_bf16 v91, v161, v161, v91
    v_dot2_f32_bf16 v88, v162, s36, v88
    v_dot2_f32_bf16 v90, v162, v162, v90
    v_dot2_f32_bf16 v89, v163, s36, v89
    v_dot2_f32_bf16 v91, v163, v163, v91
    v_dot2_f32_bf16 v88, v164, s36, v88
    v_dot2_f32_bf16 v90, v164, v164, v90
    v_dot2_f32_bf16 v89, v165, s36, v89
    v_dot2_f32_bf16 v91, v165, v165, v91
    v_dot2_f32_bf16 v88, v166, s36, v88
    v_dot2_f32_bf16 v90, v166, v166, v90
    v_dot2_f32_bf16 v89, v167, s36, v89
    v_dot2_f32_bf16 v91, v167, v167, v91
    v_dot2_f32_bf16 v88, v168, s36, v88
    v_dot2_f32_bf16 v90, v168, v168, v90
    v_dot2_f32_bf16 v89, v169, s36, v89
    v_dot2_f32_bf16 v91, v169, v169, v91
    v_dot2_f32_bf16 v88, v170, s36, v88
    v_dot2_f32_bf16 v90, v170, v170, v90
    v_dot2_f32_bf16 v89, v171, s36, v89
    v_dot2_f32_bf16 v91, v171, v171, v91
    s_nop 3
    v_add_f32 v88, v88, v89
    v_add_f32 v89, v90, v91
    v_mov_b32 v90, v88
    v_mov_b32 v91, v89
    s_nop 1
    v_permlane32_swap_b32 v88, v90
    v_permlane32_swap_b32 v89, v91
    v_add_f32 v88, v88, v90
    v_add_f32 v89, v89, v91
    v_mov_b32 v90, v88
    v_mov_b32 v91, v89
    s_nop 1
    v_permlane16_swap_b32 v88, v90
    v_permlane16_swap_b32 v89, v91
    v_add_f32 v88, v88, v90
    v_add_f32 v89, v89, v91
    s_add_u32 s20, s4, 0x1400000
    s_addc_u32 s21, s5, 0
    s_mov_b32 s22, 0x18000
    s_mov_b32 s23, 0x00020000
    s_lshl_b32 s36, s30, 4
    v_add_u32 v3, s36, v12
    v_mul_u32_u24 v3, 48, v3
    s_lshl_b32 s36, s28, 3
    v_cmp_eq_u32 vcc, 0, v13
    s_and_saveexec_b64 s[38:39], vcc
    buffer_store_dwordx2 v[88:89], v3, s[20:23], s36 offen
    s_mov_b64 exec, -1
    s_endpgm
.Lend_59:
    s_endpgm
.section .rodata,"a"
.p2align 6
.amdhsa_kernel outa2_kernel
  .amdhsa_next_free_vgpr 200
  .amdhsa_next_free_sgpr 100
  .amdhsa_accum_offset 200
  .amdhsa_group_segment_fixed_size 0
  .amdhsa_kernarg_size 88
  .amdhsa_user_sgpr_count 2
  .amdhsa_user_sgpr_kernarg_segment_ptr 1
  .amdhsa_system_sgpr_workgroup_id_x 1
.end_amdhsa_kernel
.text
.globl qkvb2_kernel
.p2align 8
.type qkvb2_kernel,@function
qkvb2_kernel:
    s_cmp_ge_u32 s2, 256
    s_cbranch_scc1 .Lend_61
    s_load_dwordx2 s[8:9], s[0:1], 80
    s_bfe_u32 s3, s2, 0x20001
    s_lshl_b32 s3, s3, 2
    s_lshr_b32 s28, s2, 6
    s_add_u32 s3, s3, s28
    s_and_b32 s28, s2, 1
    s_lshl_b32 s28, s28, 3
    s_bfe_u32 s29, s2, 0x30003
    s_add_u32 s28, s28, s29
    v_and_b32 v1, 63, v0
    v_lshrrev_b32 v11, 6, v0
    s_nop 0
    v_readfirstlane_b32 s29, v11
    v_and_b32 v12, 15, v1
    v_lshrrev_b32 v13, 4, v1
    v_lshlrev_b32 v4, 4, v1
    s_add_u32 s30, s29, 1
    s_cmp_eq_u32 s29, 8
    s_cselect_b32 s30, 0, s30
    s_lshl_b32 s31, s3, 3
    s_add_u32 s31, s31, s30
    s_sub_u32 s31, s31, 1
    s_mul_i32 s31, s31, 18432
    v_add_u32 v2, s31, v4
    s_mov_b32 s41, 4096
    s_mov_b32 s42, 8192
    s_mov_b32 s43, 12288
    s_mov_b32 s44, 16384
    s_mov_b32 s40, 0
    s_waitcnt lgkmcnt(0)
    s_add_u32 s12, s8, 0x480000
    s_addc_u32 s13, s9, 0
    s_mov_b32 s14, 0x240000
    s_mov_b32 s15, 0x00020000
    s_add_u32 s16, s8, 0x1200000
    s_addc_u32 s17, s9, 0
    s_mov_b32 s18, 0x1f8000
    s_mov_b32 s19, 0x00020000
    s_add_u32 s20, s8, 0x900000
    s_addc_u32 s21, s9, 0
    s_mov_b32 s22, 0x240000
    s_mov_b32 s23, 0x00020000
    s_mul_i32 s33, s28, 129024
    s_lshl_b32 s34, s29, 10
    s_add_u32 s33, s33, s34
    v_cmp_ne_u32 s[46:47], 0, v12
    s_cmp_eq_u32 s29, 8
    s_cselect_b64 s[46:47], s[46:47], -1
    s_mov_b64 exec, s[46:47]
    buffer_load_dwordx4 v[16:19], v2, s[12:15], s40 offen offset:0
    buffer_load_dwordx4 v[20:23], v2, s[12:15], s40 offen offset:1024
    s_mov_b64 exec, -1
    s_add_u32 m0, s34, 0
    s_add_u32 s35, s33, 0
    buffer_load_dwordx4 v4, s[16:19], s35 offen lds
    s_add_u32 m0, s34, 9216
    s_add_u32 s35, s33, 9216
    buffer_load_dwordx4 v4, s[16:19], s35 offen lds
    s_mov_b64 exec, s[46:47]
    buffer_load_dwordx4 v[24:27], v2, s[12:15], s40 offen offset:2048
    buffer_load_dwordx4 v[28:31], v2, s[12:15], s40 offen offset:3072
    s_mov_b64 exec, -1
    s_add_u32 m0, s34, 18432
    s_add_u32 s35, s33, 18432
    buffer_load_dwordx4 v4, s[16:19], s35 offen lds
    s_add_u32 m0, s34, 27648
    s_add_u32 s35, s33, 27648
    buffer_load_dwordx4 v4, s[16:19], s35 offen lds
    s_mov_b64 exec, s[46:47]
    buffer_load_dwordx4 v[32:35], v2, s[12:15], s41 offen offset:0
    buffer_load_dwordx4 v[36:39], v2, s[12:15], s41 offen offset:1024
    s_mov_b64 exec, -1
    s_add_u32 m0, s34, 36864
    s_add_u32 s35, s33, 36864
    buffer_load_dwordx4 v4, s[16:19], s35 offen lds
    s_cmp_lg_u32 s29, 8
    s_cbranch_scc1 .Lnoone_62
    s_not_b64 exec, s[46:47]
    v_mov_b32 v16, 0x3f803f80
    v_mov_b32 v17, 0x3f803f80
    v_mov_b32 v18, 0x3f803f80
    v_mov_b32 v19, 0x3f803f80
    v_mov_b32 v20, 0x3f803f80
    v_mov_b32 v21, 0x3f803f80
    v_mov_b32 v22, 0x3f803f80
    v_mov_b32 v23, 0x3f803f80
    v_mov_b32 v24, 0x3f803f80
    v_mov_b32 v25, 0x3f803f80
    v_mov_b32 v26, 0x3f803f80
    v_mov_b32 v27, 0x3f803f80
    v_mov_b32 v28, 0x3f803f80
    v_mov_b32 v29, 0x3f803f80
    v_mov_b32 v30, 0x3f803f80
    v_mov_b32 v31, 0x3f803f80
    v_mov_b32 v32, 0x3f803f80
    v_mov_b32 v33, 0x3f803f80
    v_mov_b32 v34, 0x3f803f80
    v_mov_b32 v35, 0x3f803f80
    v_mov_b32 v36, 0x3f803f80
    v_mov_b32 v37, 0x3f803f80
    v_mov_b32 v38, 0x3f803f80
    v_mov_b32 v39, 0x3f803f80
    v_mov_b32 v40, 0x3f803f80
    v_mov_b32 v41, 0x3f803f80
    v_mov_b32 v42, 0x3f803f80
    v_mov_b32 v43, 0x3f803f80
    v_mov_b32 v44, 0x3f803f80
    v_mov_b32 v45, 0x3f803f80
    v_mov_b32 v46, 0x3f803f80
    v_mov_b32 v47, 0x3f803f80
    v_mov_b32 v48, 0x3f803f80
    v_mov_b32 v49, 0x3f803f80
    v_mov_b32 v50, 0x3f803f80
    v_mov_b32 v51, 0x3f803f80
    v_mov_b32 v52, 0x3f803f80
    v_mov_b32 v53, 0x3f803f80
    v_mov_b32 v54, 0x3f803f80
    v_mov_b32 v55, 0x3f803f80
    v_mov_b32 v56, 0x3f803f80
    v_mov_b32 v57, 0x3f803f80
    v_mov_b32 v58, 0x3f803f80
    v_mov_b32 v59, 0x3f803f80
    v_mov_b32 v60, 0x3f803f80
    v_mov_b32 v61, 0x3f803f80
    v_mov_b32 v62, 0x3f803f80
    v_mov_b32 v63, 0x3f803f80
    v_mov_b32 v64, 0x3f803f80
    v_mov_b32 v65, 0x3f803f80
    v_mov_b32 v66, 0x3f803f80
    v_mov_b32 v67, 0x3f803f80
    v_mov_b32 v68, 0x3f803f80
    v_mov_b32 v69, 0x3f803f80
    v_mov_b32 v70, 0x3f803f80
    v_mov_b32 v71, 0x3f803f80
    v_mov_b32 v72, 0x3f803f80
    v_mov_b32 v73, 0x3f803f80
    v_mov_b32 v74, 0x3f803f80
    v_mov_b32 v75, 0x3f803f80
    v_mov_b32 v76, 0x3f803f80
    v_mov_b32 v77, 0x3f803f80
    v_mov_b32 v78, 0x3f803f80
    v_mov_b32 v79, 0x3f803f80
    v_mov_b32 v80, 0x3f803f80
    v_mov_b32 v81, 0x3f803f80
    v_mov_b32 v82, 0x3f803f80
    v_mov_b32 v83, 0x3f803f80
    v_mov_b32 v84, 0x3f803f80
    v_mov_b32 v85, 0x3f803f80
    v_mov_b32 v86, 0x3f803f80
    v_mov_b32 v87, 0x3f803f80
    s_mov_b64 exec, -1
.Lnoone_62:
    v_add_u32 v5, 64512, v4
    v_mov_b32 v120, 0
    v_mov_b32 v121, 0
    v_mov_b32 v122, 0
    v_mov_b32 v123, 0
    v_mov_b32 v124, 0
    v_mov_b32 v125, 0
    v_mov_b32 v126, 0
    v_mov_b32 v127, 0
    v_mov_b32 v128, 0
    v_mov_b32 v129, 0
    v_mov_b32 v130, 0
    v_mov_b32 v131, 0
    v_mov_b32 v132, 0
    v_mov_b32 v133, 0
    v_mov_b32 v134, 0
    v_mov_b32 v135, 0
    v_mov_b32 v136, 0
    v_mov_b32 v137, 0
    v_mov_b32 v138, 0
    v_mov_b32 v139, 0
    v_mov_b32 v140, 0
    v_mov_b32 v141, 0
    v_mov_b32 v142, 0
    v_mov_b32 v143, 0
    v_mov_b32 v144, 0
    v_mov_b32 v145, 0
    v_mov_b32 v146, 0
    v_mov_b32 v147, 0
    s_waitcnt vmcnt(7)
    s_barrier
    ds_read_b128 v[88:91], v4 offset:0
    ds_read_b128 v[92:95], v4 offset:1024
    ds_read_b128 v[96:99], v4 offset:2048
    ds_read_b128 v[100:103], v4 offset:3072
    ds_read_b128 v[104:107], v4 offset:4096
    ds_read_b128 v[108:111], v4 offset:5120
    ds_read_b128 v[112:115], v4 offset:6144
    s_mov_b64 exec, s[46:47]
    buffer_load_dwordx4 v[40:43], v2, s[12:15], s41 offen offset:2048
    buffer_load_dwordx4 v[44:47], v2, s[12:15], s41 offen offset:3072
    s_mov_b64 exec, -1
    s_add_u32 m0, s34, 46080
    s_add_u32 s35, s33, 46080
    buffer_load_dwordx4 v4, s[16:19], s35 offen lds
    s_add_u32 m0, s34, 55296
    s_add_u32 s35, s33, 55296
    buffer_load_dwordx4 v4, s[16:19], s35 offen lds
    s_waitcnt lgkmcnt(3)
    v_mfma_f32_16x16x32_bf16 v[120:123], v[88:91], v[16:19], v[120:123]
    v_mfma_f32_16x16x32_bf16 v[124:127], v[92:95], v[16:19], v[124:127]
    v_mfma_f32_16x16x32_bf16 v[128:131], v[96:99], v[16:19], v[128:131]
    v_mfma_f32_16x16x32_bf16 v[132:135], v[100:103], v[16:19], v[132:135]
    ds_read_b128 v[88:91], v4 offset:7168
    ds_read_b128 v[92:95], v4 offset:8192
    ds_read_b128 v[96:99], v4 offset:9216
    ds_read_b128 v[100:103], v4 offset:10240
    s_waitcnt lgkmcnt(4)
    v_mfma_f32_16x16x32_bf16 v[136:139], v[104:107], v[16:19], v[136:139]
    v_mfma_f32_16x16x32_bf16 v[140:143], v[108:111], v[16:19], v[140:143]
    v_mfma_f32_16x16x32_bf16 v[144:147], v[112:115], v[16:19], v[144:147]
    ds_read_b128 v[104:107], v4 offset:11264
    ds_read_b128 v[108:111], v4 offset:12288
    ds_read_b128 v[112:115], v4 offset:13312
    s_waitcnt lgkmcnt(3)
    v_mfma_f32_16x16x32_bf16 v[120:123], v[88:91], v[20:23], v[120:123]
    v_mfma_f32_16x16x32_bf16 v[124:127], v[92:95], v[20:23], v[124:127]
    v_mfma_f32_16x16x32_bf16 v[128:131], v[96:99], v[20:23], v[128:131]
    v_mfma_f32_16x16x32_bf16 v[132:135], v[100:103], v[20:23], v[132:135]
    s_waitcnt lgkmcnt(0)
    s_waitcnt vmcnt(7)
    s_barrier
    ds_read_b128 v[88:91], v4 offset:14336
    ds_read_b128 v[92:95], v4 offset:15360
    ds_read_b128 v[96:99], v4 offset:16384
    ds_read_b128 v[100:103], v4 offset:17408
    v_mfma_f32_16x16x32_bf16 v[136:139], v[104:107], v[20:23], v[136:139]
    v_mfma_f32_16x16x32_bf16 v[140:143], v[108:111], v[20:23], v[140:143]
    v_mfma_f32_16x16x32_bf16 v[144:147], v[112:115], v[20:23], v[144:147]
    ds_read_b128 v[104:107], v4 offset:18432
    ds_read_b128 v[108:111], v4 offset:19456
    ds_read_b128 v[112:115], v4 offset:20480
    s_mov_b64 exec, s[46:47]
    buffer_load_dwordx4 v[48:51], v2, s[12:15], s42 offen offset:0
    buffer_load_dwordx4 v[52:55], v2, s[12:15], s42 offen offset:1024
    s_mov_b64 exec, -1
    s_add_u32 m0, s34, 64512
    s_add_u32 s35, s33, 64512
    buffer_load_dwordx4 v4, s[16:19], s35 offen lds
    s_waitcnt lgkmcnt(3)
    v_mfma_f32_16x16x32_bf16 v[120:123], v[88:91], v[24:27], v[120:123]
    v_mfma_f32_16x16x32_bf16 v[124:127], v[92:95], v[24:27], v[124:127]
    v_mfma_f32_16x16x32_bf16 v[128:131], v[96:99], v[24:27], v[128:131]
    v_mfma_f32_16x16x32_bf16 v[132:135], v[100:103], v[24:27], v[132:135]
    ds_read_b128 v[88:91], v4 offset:21504
    ds_read_b128 v[92:95], v4 offset:22528
    ds_read_b128 v[96:99], v4 offset:23552
    ds_read_b128 v[100:103], v4 offset:24576
    s_waitcnt lgkmcnt(4)
    v_mfma_f32_16x16x32_bf16 v[136:139], v[104:107], v[24:27], v[136:139]
    v_mfma_f32_16x16x32_bf16 v[140:143], v[108:111], v[24:27], v[140:143]
    v_mfma_f32_16x16x32_bf16 v[144:147], v[112:115], v[24:27], v[144:147]
    ds_read_b128 v[104:107], v4 offset:25600
    ds_read_b128 v[108:111], v4 offset:26624
    ds_read_b128 v[112:115], v4 offset:27648
    s_waitcnt lgkmcnt(3)
    v_mfma_f32_16x16x32_bf16 v[120:123], v[88:91], v[28:31], v[120:123]
    v_mfma_f32_16x16x32_bf16 v[124:127], v[92:95], v[28:31], v[124:127]
    v_mfma_f32_16x16x32_bf16 v[128:131], v[96:99], v[28:31], v[128:131]
    v_mfma_f32_16x16x32_bf16 v[132:135], v[100:103], v[28:31], v[132:135]
    s_waitcnt lgkmcnt(0)
    s_waitcnt vmcnt(7)
    s_barrier
    ds_read_b128 v[88:91], v4 offset:28672
    ds_read_b128 v[92:95], v4 offset:29696
    ds_read_b128 v[96:99], v4 offset:30720
    ds_read_b128 v[100:103], v4 offset:31744
    v_mfma_f32_16x16x32_bf16 v[136:139], v[104:107], v[28:31], v[136:139]
    v_mfma_f32_16x16x32_bf16 v[140:143], v[108:111], v[28:31], v[140:143]
    v_mfma_f32_16x16x32_bf16 v[144:147], v[112:115], v[28:31], v[144:147]
    ds_read_b128 v[104:107], v4 offset:32768
    ds_read_b128 v[108:111], v4 offset:33792
    ds_read_b128 v[112:115], v4 offset:34816
    s_mov_b64 exec, s[46:47]
    buffer_load_dwordx4 v[56:59], v2, s[12:15], s42 offen offset:2048
    buffer_load_dwordx4 v[60:63], v2, s[12:15], s42 offen offset:3072
    s_mov_b64 exec, -1
    s_add_u32 m0, s34, 73728
    s_add_u32 s35, s33, 73728
    buffer_load_dwordx4 v4, s[16:19], s35 offen lds
    s_add_u32 m0, s34, 82944
    s_add_u32 s35, s33, 82944
    buffer_load_dwordx4 v4, s[16:19], s35 offen lds
    s_waitcnt lgkmcnt(3)
    v_mfma_f32_16x16x32_bf16 v[120:123], v[88:91], v[32:35], v[120:123]
    v_mfma_f32_16x16x32_bf16 v[124:127], v[92:95], v[32:35], v[124:127]
    v_mfma_f32_16x16x32_bf16 v[128:131], v[96:99], v[32:35], v[128:131]
    v_mfma_f32_16x16x32_bf16 v[132:135], v[100:103], v[32:35], v[132:135]
    ds_read_b128 v[88:91], v4 offset:35840
    ds_read_b128 v[92:95], v4 offset:36864
    ds_read_b128 v[96:99], v4 offset:37888
    ds_read_b128 v[100:103], v4 offset:38912
    s_waitcnt lgkmcnt(4)
    v_mfma_f32_16x16x32_bf16 v[136:139], v[104:107], v[32:35], v[136:139]
    v_mfma_f32_16x16x32_bf16 v[140:143], v[108:111], v[32:35], v[140:143]
    v_mfma_f32_16x16x32_bf16 v[144:147], v[112:115], v[32:35], v[144:147]
    ds_read_b128 v[104:107], v4 offset:39936
    ds_read_b128 v[108:111], v4 offset:40960
    ds_read_b128 v[112:115], v4 offset:41984
    s_waitcnt lgkmcnt(3)
    v_mfma_f32_16x16x32_bf16 v[120:123], v[88:91], v[36:39], v[120:123]
    v_mfma_f32_16x16x32_bf16 v[124:127], v[92:95], v[36:39], v[124:127]
    v_mfma_f32_16x16x32_bf16 v[128:131], v[96:99], v[36:39], v[128:131]
    v_mfma_f32_16x16x32_bf16 v[132:135], v[100:103], v[36:39], v[132:135]
    s_waitcnt lgkmcnt(0)
    s_waitcnt vmcnt(7)
    s_barrier
    ds_read_b128 v[88:91], v4 offset:43008
    ds_read_b128 v[92:95], v4 offset:44032
    ds_read_b128 v[96:99], v4 offset:45056
    ds_read_b128 v[100:103], v4 offset:46080
    v_mfma_f32_16x16x32_bf16 v[136:139], v[104:107], v[36:39], v[136:139]
    v_mfma_f32_16x16x32_bf16 v[140:143], v[108:111], v[36:39], v[140:143]
    v_mfma_f32_16x16x32_bf16 v[144:147], v[112:115], v[36:39], v[144:147]
    ds_read_b128 v[104:107], v4 offset:47104
    ds_read_b128 v[108:111], v4 offset:48128
    ds_read_b128 v[112:115], v4 offset:49152
    s_mov_b64 exec, s[46:47]
    buffer_load_dwordx4 v[64:67], v2, s[12:15], s43 offen offset:0
    buffer_load_dwordx4 v[68:71], v2, s[12:15], s43 offen offset:1024
    s_mov_b64 exec, -1
    s_add_u32 m0, s34, 92160
    s_add_u32 s35, s33, 92160
    buffer_load_dwordx4 v4, s[16:19], s35 offen lds
    s_waitcnt lgkmcnt(3)
    v_mfma_f32_16x16x32_bf16 v[120:123], v[88:91], v[40:43], v[120:123]
    v_mfma_f32_16x16x32_bf16 v[124:127], v[92:95], v[40:43], v[124:127]
    v_mfma_f32_16x16x32_bf16 v[128:131], v[96:99], v[40:43], v[128:131]
    v_mfma_f32_16x16x32_bf16 v[132:135], v[100:103], v[40:43], v[132:135]
    ds_read_b128 v[88:91], v4 offset:50176
    ds_read_b128 v[92:95], v4 offset:51200
    ds_read_b128 v[96:99], v4 offset:52224
    ds_read_b128 v[100:103], v4 offset:53248
    s_waitcnt lgkmcnt(4)
    v_mfma_f32_16x16x32_bf16 v[136:139], v[104:107], v[40:43], v[136:139]
    v_mfma_f32_16x16x32_bf16 v[140:143], v[108:111], v[40:43], v[140:143]
    v_mfma_f32_16x16x32_bf16 v[144:147], v[112:115], v[40:43], v[144:147]
    ds_read_b128 v[104:107], v4 offset:54272
    ds_read_b128 v[108:111], v4 offset:55296
    ds_read_b128 v[112:115], v4 offset:56320
    s_waitcnt lgkmcnt(3)
    v_mfma_f32_16x16x32_bf16 v[120:123], v[88:91], v[44:47], v[120:123]
    v_mfma_f32_16x16x32_bf16 v[124:127], v[92:95], v[44:47], v[124:127]
    v_mfma_f32_16x16x32_bf16 v[128:131], v[96:99], v[44:47], v[128:131]
    v_mfma_f32_16x16x32_bf16 v[132:135], v[100:103], v[44:47], v[132:135]
    s_waitcnt lgkmcnt(0)
    s_waitcnt vmcnt(7)
    s_barrier
    ds_read_b128 v[88:91], v4 offset:57344
    ds_read_b128 v[92:95], v4 offset:58368
    ds_read_b128 v[96:99], v4 offset:59392
    ds_read_b128 v[100:103], v4 offset:60416
    v_mfma_f32_16x16x32_bf16 v[136:139], v[104:107], v[44:47], v[136:139]
    v_mfma_f32_16x16x32_bf16 v[140:143], v[108:111], v[44:47], v[140:143]
    v_mfma_f32_16x16x32_bf16 v[144:147], v[112:115], v[44:47], v[144:147]
    ds_read_b128 v[104:107], v4 offset:61440
    ds_read_b128 v[108:111], v4 offset:62464
    ds_read_b128 v[112:115], v4 offset:63488
    s_mov_b64 exec, s[46:47]
    buffer_load_dwordx4 v[72:75], v2, s[12:15], s43 offen offset:2048
    buffer_load_dwordx4 v[76:79], v2, s[12:15], s43 offen offset:3072
    s_mov_b64 exec, -1
    s_add_u32 m0, s34, 101376
    s_add_u32 s35, s33, 101376
    buffer_load_dwordx4 v4, s[16:19], s35 offen lds
    s_add_u32 m0, s34, 110592
    s_add_u32 s35, s33, 110592
    buffer_load_dwordx4 v4, s[16:19], s35 offen lds
    s_waitcnt lgkmcnt(3)
    v_mfma_f32_16x16x32_bf16 v[120:123], v[88:91], v[48:51], v[120:123]
    v_mfma_f32_16x16x32_bf16 v[124:127], v[92:95], v[48:51], v[124:127]
    v_mfma_f32_16x16x32_bf16 v[128:131], v[96:99], v[48:51], v[128:131]
    v_mfma_f32_16x16x32_bf16 v[132:135], v[100:103], v[48:51], v[132:135]
    ds_read_b128 v[88:91], v5 offset:0
    ds_read_b128 v[92:95], v5 offset:1024
    ds_read_b128 v[96:99], v5 offset:2048
    ds_read_b128 v[100:103], v5 offset:3072
    s_waitcnt lgkmcnt(4)
    v_mfma_f32_16x16x32_bf16 v[136:139], v[104:107], v[48:51], v[136:139]
    v_mfma_f32_16x16x32_bf16 v[140:143], v[108:111], v[48:51], v[140:143]
    v_mfma_f32_16x16x32_bf16 v[144:147], v[112:115], v[48:51], v[144:147]
    ds_read_b128 v[104:107], v5 offset:4096
    ds_read_b128 v[108:111], v5 offset:5120
    ds_read_b128 v[112:115], v5 offset:6144
    s_waitcnt lgkmcnt(3)
    v_mfma_f32_16x16x32_bf16 v[120:123], v[88:91], v[52:55], v[120:123]
    v_mfma_f32_16x16x32_bf16 v[124:127], v[92:95], v[52:55], v[124:127]
    v_mfma_f32_16x16x32_bf16 v[128:131], v[96:99], v[52:55], v[128:131]
    v_mfma_f32_16x16x32_bf16 v[132:135], v[100:103], v[52:55], v[132:135]
    s_waitcnt lgkmcnt(0)
    s_waitcnt vmcnt(7)
    s_barrier
    ds_read_b128 v[88:91], v5 offset:7168
    ds_read_b128 v[92:95], v5 offset:8192
    ds_read_b128 v[96:99], v5 offset:9216
    ds_read_b128 v[100:103], v5 offset:10240
    v_mfma_f32_16x16x32_bf16 v[136:139], v[104:107], v[52:55], v[136:139]
    v_mfma_f32_16x16x32_bf16 v[140:143], v[108:111], v[52:55], v[140:143]
    v_mfma_f32_16x16x32_bf16 v[144:147], v[112:115], v[52:55], v[144:147]
    ds_read_b128 v[104:107], v5 offset:11264
    ds_read_b128 v[108:111], v5 offset:12288
    ds_read_b128 v[112:115], v5 offset:13312
    s_mov_b64 exec, s[46:47]
    buffer_load_dwordx4 v[80:83], v2, s[12:15], s44 offen offset:0
    buffer_load_dwordx4 v[84:87], v2, s[12:15], s44 offen offset:1024
    s_mov_b64 exec, -1
    s_add_u32 m0, s34, 119808
    s_add_u32 s35, s33, 119808
    buffer_load_dwordx4 v4, s[16:19], s35 offen lds
    s_waitcnt lgkmcnt(3)
    v_mfma_f32_16x16x32_bf16 v[120:123], v[88:91], v[56:59], v[120:123]
    v_mfma_f32_16x16x32_bf16 v[124:127], v[92:95], v[56:59], v[124:127]
    v_mfma_f32_16x16x32_bf16 v[128:131], v[96:99], v[56:59], v[128:131]
    v_mfma_f32_16x16x32_bf16 v[132:135], v[100:103], v[56:59], v[132:135]
    ds_read_b128 v[88:91], v5 offset:14336
    ds_read_b128 v[92:95], v5 offset:15360
    ds_read_b128 v[96:99], v5 offset:16384
    ds_read_b128 v[100:103], v5 offset:17408
    s_waitcnt lgkmcnt(4)
    v_mfma_f32_16x16x32_bf16 v[136:139], v[104:107], v[56:59], v[136:139]
    v_mfma_f32_16x16x32_bf16 v[140:143], v[108:111], v[56:59], v[140:143]
    v_mfma_f32_16x16x32_bf16 v[144:147], v[112:115], v[56:59], v[144:147]
    ds_read_b128 v[104:107], v5 offset:18432
    ds_read_b128 v[108:111], v5 offset:19456
    ds_read_b128 v[112:115], v5 offset:20480
    s_waitcnt lgkmcnt(3)
    v_mfma_f32_16x16x32_bf16 v[120:123], v[88:91], v[60:63], v[120:123]
    v_mfma_f32_16x16x32_bf16 v[124:127], v[92:95], v[60:63], v[124:127]
    v_mfma_f32_16x16x32_bf16 v[128:131], v[96:99], v[60:63], v[128:131]
    v_mfma_f32_16x16x32_bf16 v[132:135], v[100:103], v[60:63], v[132:135]
    s_waitcnt lgkmcnt(0)
    s_waitcnt vmcnt(7)
    s_barrier
    ds_read_b128 v[88:91], v5 offset:21504
    ds_read_b128 v[92:95], v5 offset:22528
    ds_read_b128 v[96:99], v5 offset:23552
    ds_read_b128 v[100:103], v5 offset:24576
    v_mfma_f32_16x16x32_bf16 v[136:139], v[104:107], v[60:63], v[136:139]
    v_mfma_f32_16x16x32_bf16 v[140:143], v[108:111], v[60:63], v[140:143]
    v_mfma_f32_16x16x32_bf16 v[144:147], v[112:115], v[60:63], v[144:147]
    ds_read_b128 v[104:107], v5 offset:25600
    ds_read_b128 v[108:111], v5 offset:26624
    ds_read_b128 v[112:115], v5 offset:27648
    s_add_u32 s24, s8, 0x1400000
    s_addc_u32 s25, s9, 0
    s_mov_b32 s26, 0x18000
    s_mov_b32 s27, 0x00020000
    s_lshl_b32 s36, s3, 3
    s_add_u32 s36, s36, s30
    s_sub_u32 s36, s36, 1
    s_lshl_b32 s36, s36, 4
    v_add_u32 v3, s36, v12
    v_mul_i32_i24 v3, 48, v3
    buffer_load_dwordx4 v[148:151], v3, s[24:27], 0 offen offset:0
    buffer_load_dwordx4 v[152:155], v3, s[24:27], 0 offen offset:16
    buffer_load_dwordx4 v[156:159], v3, s[24:27], 0 offen offset:32
    s_waitcnt lgkmcnt(3)
    v_mfma_f32_16x16x32_bf16 v[120:123], v[88:91], v[64:67], v[120:123]
    v_mfma_f32_16x16x32_bf16 v[124:127], v[92:95], v[64:67], v[124:127]
    v_mfma_f32_16x16x32_bf16 v[128:131], v[96:99], v[64:67], v[128:131]
    v_mfma_f32_16x16x32_bf16 v[132:135], v[100:103], v[64:67], v[132:135]
    ds_read_b128 v[88:91], v5 offset:28672
    ds_read_b128 v[92:95], v5 offset:29696
    ds_read_b128 v[96:99], v5 offset:30720
    ds_read_b128 v[100:103], v5 offset:31744
    s_waitcnt lgkmcnt(4)
    v_mfma_f32_16x16x32_bf16 v[136:139], v[104:107], v[64:67], v[136:139]
    v_mfma_f32_16x16x32_bf16 v[140:143], v[108:111], v[64:67], v[140:143]
    v_mfma_f32_16x16x32_bf16 v[144:147], v[112:115], v[64:67], v[144:147]
    ds_read_b128 v[104:107], v5 offset:32768
    ds_read_b128 v[108:111], v5 offset:33792
    ds_read_b128 v[112:115], v5 offset:34816
    s_waitcnt lgkmcnt(3)
    v_mfma_f32_16x16x32_bf16 v[120:123], v[88:91], v[68:71], v[120:123]
    v_mfma_f32_16x16x32_bf16 v[124:127], v[92:95], v[68:71], v[124:127]
    v_mfma_f32_16x16x32_bf16 v[128:131], v[96:99], v[68:71], v[128:131]
    v_mfma_f32_16x16x32_bf16 v[132:135], v[100:103], v[68:71], v[132:135]
    s_waitcnt lgkmcnt(0)
    s_waitcnt vmcnt(6)
    s_barrier
    ds_read_b128 v[88:91], v5 offset:35840
    ds_read_b128 v[92:95], v5 offset:36864
    ds_read_b128 v[96:99], v5 offset:37888
    ds_read_b128 v[100:103], v5 offset:38912
    v_mfma_f32_16x16x32_bf16 v[136:139], v[104:107], v[68:71], v[136:139]
    v_mfma_f32_16x16x32_bf16 v[140:143], v[108:111], v[68:71], v[140:143]
    v_mfma_f32_16x16x32_bf16 v[144:147], v[112:115], v[68:71], v[144:147]
    ds_read_b128 v[104:107], v5 offset:39936
    ds_read_b128 v[108:111], v5 offset:40960
    ds_read_b128 v[112:115], v5 offset:41984
    s_waitcnt lgkmcnt(3)
    v_mfma_f32_16x16x32_bf16 v[120:123], v[88:91], v[72:75], v[120:123]
    v_mfma_f32_16x16x32_bf16 v[124:127], v[92:95], v[72:75], v[124:127]
    v_mfma_f32_16x16x32_bf16 v[128:131], v[96:99], v[72:75], v[128:131]
    v_mfma_f32_16x16x32_bf16 v[132:135], v[100:103], v[72:75], v[132:135]
    ds_read_b128 v[88:91], v5 offset:43008
    ds_read_b128 v[92:95], v5 offset:44032
    ds_read_b128 v[96:99], v5 offset:45056
    ds_read_b128 v[100:103], v5 offset:46080
    s_waitcnt lgkmcnt(4)
    v_mfma_f32_16x16x32_bf16 v[136:139], v[104:107], v[72:75], v[136:139]
    v_mfma_f32_16x16x32_bf16 v[140:143], v[108:111], v[72:75], v[140:143]
    v_mfma_f32_16x16x32_bf16 v[144:147], v[112:115], v[72:75], v[144:147]
    ds_read_b128 v[104:107], v5 offset:47104
    ds_read_b128 v[108:111], v5 offset:48128
    ds_read_b128 v[112:115], v5 offset:49152
    s_waitcnt lgkmcnt(3)
    v_mfma_f32_16x16x32_bf16 v[120:123], v[88:91], v[76:79], v[120:123]
    v_mfma_f32_16x16x32_bf16 v[124:127], v[92:95], v[76:79], v[124:127]
    v_mfma_f32_16x16x32_bf16 v[128:131], v[96:99], v[76:79], v[128:131]
    v_mfma_f32_16x16x32_bf16 v[132:135], v[100:103], v[76:79], v[132:135]
    s_waitcnt lgkmcnt(0)
    s_waitcnt vmcnt(3)
    s_barrier
    ds_read_b128 v[88:91], v5 offset:50176
    ds_read_b128 v[92:95], v5 offset:51200
    ds_read_b128 v[96:99], v5 offset:52224
    ds_read_b128 v[100:103], v5 offset:53248
    v_mfma_f32_16x16x32_bf16 v[136:139], v[104:107], v[76:79], v[136:139]
    v_mfma_f32_16x16x32_bf16 v[140:143], v[108:111], v[76:79], v[140:143]
    v_mfma_f32_16x16x32_bf16 v[144:147], v[112:115], v[76:79], v[144:147]
    ds_read_b128 v[104:107], v5 offset:54272
    ds_read_b128 v[108:111], v5 offset:55296
    ds_read_b128 v[112:115], v5 offset:56320
    s_waitcnt lgkmcnt(3)
    v_mfma_f32_16x16x32_bf16 v[120:123], v[88:91], v[80:83], v[120:123]
    v_mfma_f32_16x16x32_bf16 v[124:127], v[92:95], v[80:83], v[124:127]
    v_mfma_f32_16x16x32_bf16 v[128:131], v[96:99], v[80:83], v[128:131]
    v_mfma_f32_16x16x32_bf16 v[132:135], v[100:103], v[80:83], v[132:135]
    ds_read_b128 v[88:91], v5 offset:57344
    ds_read_b128 v[92:95], v5 offset:58368
    ds_read_b128 v[96:99], v5 offset:59392
    ds_read_b128 v[100:103], v5 offset:60416
    s_waitcnt lgkmcnt(4)
    v_mfma_f32_16x16x32_bf16 v[136:139], v[104:107], v[80:83], v[136:139]
    v_mfma_f32_16x16x32_bf16 v[140:143], v[108:111], v[80:83], v[140:143]
    v_mfma_f32_16x16x32_bf16 v[144:147], v[112:115], v[80:83], v[144:147]
    ds_read_b128 v[104:107], v5 offset:61440
    ds_read_b128 v[108:111], v5 offset:62464
    ds_read_b128 v[112:115], v5 offset:63488
    s_waitcnt lgkmcnt(3)
    v_mfma_f32_16x16x32_bf16 v[120:123], v[88:91], v[84:87], v[120:123]
    v_mfma_f32_16x16x32_bf16 v[124:127], v[92:95], v[84:87], v[124:127]
    v_mfma_f32_16x16x32_bf16 v[128:131], v[96:99], v[84:87], v[128:131]
    v_mfma_f32_16x16x32_bf16 v[132:135], v[100:103], v[84:87], v[132:135]
    s_waitcnt lgkmcnt(0)
    v_mfma_f32_16x16x32_bf16 v[136:139], v[104:107], v[84:87], v[136:139]
    v_mfma_f32_16x16x32_bf16 v[140:143], v[108:111], v[84:87], v[140:143]
    v_mfma_f32_16x16x32_bf16 v[144:147], v[112:115], v[84:87], v[144:147]
    s_nop 7
    s_cmp_lg_u32 s29, 8
    s_cbranch_scc1 .Lnocs_63
    v_lshlrev_b32 v3, 4, v13
    v_add_u32 v3, 129024, v3
    v_cmp_eq_u32 vcc, 0, v12
    s_and_saveexec_b64 s[38:39], vcc
    ds_write_b128 v3, v[120:123] offset:0
    ds_write_b128 v3, v[124:127] offset:64
    ds_write_b128 v3, v[128:131] offset:128
    ds_write_b128 v3, v[132:135] offset:192
    ds_write_b128 v3, v[136:139] offset:256
    ds_write_b128 v3, v[140:143] offset:320
    ds_write_b128 v3, v[144:147] offset:384
    s_mov_b64 exec, -1
    s_waitcnt lgkmcnt(0)
.Lnocs_63:
    s_barrier
    v_lshlrev_b32 v3, 4, v13
    v_add_u32 v3, 129024, v3
    ds_read_b128 v[32:35], v3 offset:0
    ds_read_b128 v[36:39], v3 offset:64
    ds_read_b128 v[40:43], v3 offset:128
    ds_read_b128 v[44:47], v3 offset:192
    ds_read_b128 v[48:51], v3 offset:256
    ds_read_b128 v[52:55], v3 offset:320
    ds_read_b128 v[56:59], v3 offset:384
    s_waitcnt vmcnt(0)
    v_add_f32 v148, v148, v150
    v_add_f32 v149, v149, v151
    v_add_f32 v148, v148, v152
    v_add_f32 v149, v149, v153
    v_add_f32 v148, v148, v154
    v_add_f32 v149, v149, v155
    v_add_f32 v148, v148, v156
    v_add_f32 v149, v149, v157
    v_add_f32 v148, v148, v158
    v_add_f32 v149, v149, v159
    s_mov_b32 s36, 0x3ae38e39
    v_mul_f32 v148, s36, v148
    v_mul_f32 v149, s36, v149
    v_fma_f32 v149, -v148, v148, v149
    v_max_f32 v149, 0, v149
    v_cvt_pk_bf16_f32 v150, v148, v149
    v_lshlrev_b32 v148, 16, v150
    v_and_b32 v149, 0xffff0000, v150
    v_add_f32 v149, 0x3727c5ac, v149
    v_cvt_pk_bf16_f32 v149, v149, v149
    v_lshlrev_b32 v149, 16, v149
    v_sqrt_f32 v149, v149
    s_nop 0
    v_cvt_pk_bf16_f32 v149, v149, v149
    v_lshlrev_b32 v149, 16, v149
    v_rcp_f32 v149, v149
    s_nop 0
    s_waitcnt lgkmcnt(0)
    v_fma_f32 v120, -v148, v32, v120
    v_mul_f32 v120, v149, v120
    v_fma_f32 v121, -v148, v33, v121
    v_mul_f32 v121, v149, v121
    v_fma_f32 v122, -v148, v34, v122
    v_mul_f32 v122, v149, v122
    v_fma_f32 v123, -v148, v35, v123
    v_mul_f32 v123, v149, v123
    v_fma_f32 v124, -v148, v36, v124
    v_mul_f32 v124, v149, v124
    v_fma_f32 v125, -v148, v37, v125
    v_mul_f32 v125, v149, v125
    v_fma_f32 v126, -v148, v38, v126
    v_mul_f32 v126, v149, v126
    v_fma_f32 v127, -v148, v39, v127
    v_mul_f32 v127, v149, v127
    v_fma_f32 v128, -v148, v40, v128
    v_mul_f32 v128, v149, v128
    v_fma_f32 v129, -v148, v41, v129
    v_mul_f32 v129, v149, v129
    v_fma_f32 v130, -v148, v42, v130
    v_mul_f32 v130, v149, v130
    v_fma_f32 v131, -v148, v43, v131
    v_mul_f32 v131, v149, v131
    v_fma_f32 v132, -v148, v44, v132
    v_mul_f32 v132, v149, v132
    v_fma_f32 v133, -v148, v45, v133
    v_mul_f32 v133, v149, v133
    v_fma_f32 v134, -v148, v46, v134
    v_mul_f32 v134, v149, v134
    v_fma_f32 v135, -v148, v47, v135
    v_mul_f32 v135, v149, v135
    v_fma_f32 v136, -v148, v48, v136
    v_mul_f32 v136, v149, v136
    v_fma_f32 v137, -v148, v49, v137
    v_mul_f32 v137, v149, v137
    v_fma_f32 v138, -v148, v50, v138
    v_mul_f32 v138, v149, v138
    v_fma_f32 v139, -v148, v51, v139
    v_mul_f32 v139, v149, v139
    v_fma_f32 v140, -v148, v52, v140
    v_mul_f32 v140, v149, v140
    v_fma_f32 v141, -v148, v53, v141
    v_mul_f32 v141, v149, v141
    v_fma_f32 v142, -v148, v54, v142
    v_mul_f32 v142, v149, v142
    v_fma_f32 v143, -v148, v55, v143
    v_mul_f32 v143, v149, v143
    v_fma_f32 v144, -v148, v56, v144
    v_mul_f32 v144, v149, v144
    v_fma_f32 v145, -v148, v57, v145
    v_mul_f32 v145, v149, v145
    v_fma_f32 v146, -v148, v58, v146
    v_mul_f32 v146, v149, v146
    v_fma_f32 v147, -v148, v59, v147
    v_mul_f32 v147, v149, v147
    s_lshl_b32 s32, s30, 4
    v_add_u32 v5, s32, v12
    v_mul_u32_u24 v5, 232, v5
    v_lshl_add_u32 v5, v13, 3, v5
    v_cvt_pk_bf16_f32 v120, v120, v121
    v_cvt_pk_bf16_f32 v121, v122, v123
    ds_write_b64 v5, v[120:121] offset:0
    v_cvt_pk_bf16_f32 v124, v124, v125
    v_cvt_pk_bf16_f32 v125, v126, v127
    ds_write_b64 v5, v[124:125] offset:32
    v_cvt_pk_bf16_f32 v128, v128, v129
    v_cvt_pk_bf16_f32 v129, v130, v131
    ds_write_b64 v5, v[128:129] offset:64
    v_cvt_pk_bf16_f32 v132, v132, v133
    v_cvt_pk_bf16_f32 v133, v134, v135
    ds_write_b64 v5, v[132:133] offset:96
    v_cvt_pk_bf16_f32 v136, v136, v137
    v_cvt_pk_bf16_f32 v137, v138, v139
    ds_write_b64 v5, v[136:137] offset:128
    v_cvt_pk_bf16_f32 v140, v140, v141
    v_cvt_pk_bf16_f32 v141, v142, v143
    ds_write_b64 v5, v[140:141] offset:160
    v_cvt_pk_bf16_f32 v144, v144, v145
    v_cvt_pk_bf16_f32 v145, v146, v147
    ds_write_b64 v5, v[144:145] offset:192
    s_waitcnt lgkmcnt(0)
    s_barrier
    s_cmp_eq_u32 s29, 8
    s_cbranch_scc1 .Lend_61
    v_and_b32 v2, 1, v1
    v_bfe_u32 v3, v1, 1, 1
    v_lshrrev_b32 v4, 2, v1
    s_lshl_b32 s32, s29, 4
    v_add_u32 v4, s32, v4
    v_add_u32 v5, 16, v4
    v_mul_u32_u24 v5, 232, v5
    v_mul_u32_u24 v6, 36, v3
    v_add_u32 v5, v5, v6
    v_mul_u32_u24 v6, 1856, v2
    v_sub_u32 v6, v5, v6
    v_subrev_u32 v8, 0, v6
    v_subrev_u32 v9, 464, v6
    v_subrev_u32 v10, 928, v6
    v_subrev_u32 v11, 1392, v6
    ds_read2_b32 v[16:17], v5 offset0:0 offset1:1
    ds_read2_b32 v[18:19], v5 offset0:2 offset1:3
    ds_read2_b32 v[20:21], v5 offset0:4 offset1:5
    ds_read2_b32 v[22:23], v5 offset0:6 offset1:7
    ds_read_b32 v24, v5 offset:32
    ds_read2_b32 v[32:33], v8 offset0:18 offset1:19
    ds_read2_b32 v[34:35], v8 offset0:20 offset1:21
    ds_read2_b32 v[36:37], v8 offset0:22 offset1:23
    ds_read2_b32 v[38:39], v8 offset0:24 offset1:25
    ds_read_b32 v40, v8 offset:104
    ds_read2_b32 v[42:43], v9 offset0:18 offset1:19
    ds_read2_b32 v[44:45], v9 offset0:20 offset1:21
    ds_read2_b32 v[46:47], v9 offset0:22 offset1:23
    ds_read2_b32 v[48:49], v9 offset0:24 offset1:25
    ds_read_b32 v50, v9 offset:104
    ds_read2_b32 v[52:53], v10 offset0:18 offset1:19
    ds_read2_b32 v[54:55], v10 offset0:20 offset1:21
    ds_read2_b32 v[56:57], v10 offset0:22 offset1:23
    ds_read2_b32 v[58:59], v10 offset0:24 offset1:25
    ds_read_b32 v60, v10 offset:104
    ds_read2_b32 v[62:63], v11 offset0:18 offset1:19
    ds_read2_b32 v[64:65], v11 offset0:20 offset1:21
    ds_read2_b32 v[66:67], v11 offset0:22 offset1:23
    ds_read2_b32 v[68:69], v11 offset0:24 offset1:25
    ds_read_b32 v70, v11 offset:104
    s_waitcnt lgkmcnt(0)
    ds_read2_b32 v[72:73], v8 offset0:36 offset1:37
    ds_read2_b32 v[74:75], v8 offset0:38 offset1:39
    ds_read2_b32 v[76:77], v8 offset0:40 offset1:41
    ds_read2_b32 v[78:79], v8 offset0:42 offset1:43
    ds_read_b32 v80, v8 offset:176
    ds_read2_b32 v[82:83], v9 offset0:36 offset1:37
    ds_read2_b32 v[84:85], v9 offset0:38 offset1:39
    ds_read2_b32 v[86:87], v9 offset0:40 offset1:41
    ds_read2_b32 v[88:89], v9 offset0:42 offset1:43
    ds_read_b32 v90, v9 offset:176
    ds_read2_b32 v[92:93], v10 offset0:36 offset1:37
    ds_read2_b32 v[94:95], v10 offset0:38 offset1:39
    ds_read2_b32 v[96:97], v10 offset0:40 offset1:41
    ds_read2_b32 v[98:99], v10 offset0:42 offset1:43
    ds_read_b32 v100, v10 offset:176
    ds_read2_b32 v[102:103], v11 offset0:36 offset1:37
    ds_read2_b32 v[104:105], v11 offset0:38 offset1:39
    ds_read2_b32 v[106:107], v11 offset0:40 offset1:41
    ds_read2_b32 v[108:109], v11 offset0:42 offset1:43
    ds_read_b32 v110, v11 offset:176
    v_mov_b32 v132, 0
    v_mov_b32 v133, 0
    v_mov_b32 v134, 0
    v_mov_b32 v135, 0
    v_dot2_f32_bf16 v132, v16, v32, v132
    v_dot2_f32_bf16 v133, v16, v42, v133
    v_dot2_f32_bf16 v134, v16, v52, v134
    v_dot2_f32_bf16 v135, v16, v62, v135
    v_dot2_f32_bf16 v132, v17, v33, v132
    v_dot2_f32_bf16 v133, v17, v43, v133
    v_dot2_f32_bf16 v134, v17, v53, v134
    v_dot2_f32_bf16 v135, v17, v63, v135
    v_dot2_f32_bf16 v132, v18, v34, v132
    v_dot2_f32_bf16 v133, v18, v44, v133
    v_dot2_f32_bf16 v134, v18, v54, v134
    v_dot2_f32_bf16 v135, v18, v64, v135
    v_dot2_f32_bf16 v132, v19, v35, v132
    v_dot2_f32_bf16 v133, v19, v45, v133
    v_dot2_f32_bf16 v134, v19, v55, v134
    v_dot2_f32_bf16 v135, v19, v65, v135
    v_dot2_f32_bf16 v132, v20, v36, v132
    v_dot2_f32_bf16 v133, v20, v46, v133
    v_dot2_f32_bf16 v134, v20, v56, v134
    v_dot2_f32_bf16 v135, v20, v66, v135
    v_dot2_f32_bf16 v132, v21, v37, v132
    v_dot2_f32_bf16 v133, v21, v47, v133
    v_dot2_f32_bf16 v134, v21, v57, v134
    v_dot2_f32_bf16 v135, v21, v67, v135
    v_dot2_f32_bf16 v132, v22, v38, v132
    v_dot2_f32_bf16 v133, v22, v48, v133
    v_dot2_f32_bf16 v134, v22, v58, v134
    v_dot2_f32_bf16 v135, v22, v68, v135
    v_dot2_f32_bf16 v132, v23, v39, v132
    v_dot2_f32_bf16 v133, v23, v49, v133
    v_dot2_f32_bf16 v134, v23, v59, v134
    v_dot2_f32_bf16 v135, v23, v69, v135
    v_dot2_f32_bf16 v132, v24, v40, v132
    v_dot2_f32_bf16 v133, v24, v50, v133
    v_dot2_f32_bf16 v134, v24, v60, v134
    v_dot2_f32_bf16 v135, v24, v70, v135
    s_nop 3
    s_mov_b32 s35, 0x3e715bef
    s_lshl_b32 s36, s3, 7
    v_add_u32 v7, s36, v4
    v_lshlrev_b32 v13, 3, v2
    v_mov_b32 v14, 0xce6e6b28
    v_cvt_pk_bf16_f32 v132, v132, v132
    v_lshlrev_b32 v132, 16, v132
    v_mul_f32 v132, s35, v132
    v_cvt_pk_bf16_f32 v132, v132, v132
    v_lshlrev_b32 v132, 16, v132
    v_add_u32 v12, 0, v13
    v_cmp_ge_u32 vcc, v7, v12
    s_nop 1
    v_cndmask_b32 v132, v14, v132, vcc
    v_cvt_pk_bf16_f32 v133, v133, v133
    v_lshlrev_b32 v133, 16, v133
    v_mul_f32 v133, s35, v133
    v_cvt_pk_bf16_f32 v133, v133, v133
    v_lshlrev_b32 v133, 16, v133
    v_add_u32 v12, 2, v13
    v_cmp_ge_u32 vcc, v7, v12
    s_nop 1
    v_cndmask_b32 v133, v14, v133, vcc
    v_cvt_pk_bf16_f32 v134, v134, v134
    v_lshlrev_b32 v134, 16, v134
    v_mul_f32 v134, s35, v134
    v_cvt_pk_bf16_f32 v134, v134, v134
    v_lshlrev_b32 v134, 16, v134
    v_add_u32 v12, 4, v13
    v_cmp_ge_u32 vcc, v7, v12
    s_nop 1
    v_cndmask_b32 v134, v14, v134, vcc
    v_cvt_pk_bf16_f32 v135, v135, v135
    v_lshlrev_b32 v135, 16, v135
    v_mul_f32 v135, s35, v135
    v_cvt_pk_bf16_f32 v135, v135, v135
    v_lshlrev_b32 v135, 16, v135
    v_add_u32 v12, 6, v13
    v_cmp_ge_u32 vcc, v7, v12
    s_nop 1
    v_cndmask_b32 v135, v14, v135, vcc
    v_max3_f32 v12, v132, v133, v134
    v_max_f32 v12, v12, v135
    s_nop 1
    v_max_f32_dpp v12, v12, v12 quad_perm:[1,0,3,2] row_mask:0xf bank_mask:0xf
    s_mov_b32 s35, 0x3fb8aa3b
    v_sub_f32 v132, v132, v12
    v_mul_f32 v132, s35, v132
    v_exp_f32 v132, v132
    v_sub_f32 v133, v133, v12
    v_mul_f32 v133, s35, v133
    v_exp_f32 v133, v133
    v_sub_f32 v134, v134, v12
    v_mul_f32 v134, s35, v134
    v_exp_f32 v134, v134
    v_sub_f32 v135, v135, v12
    v_mul_f32 v135, s35, v135
    v_exp_f32 v135, v135
    s_nop 0
    v_add_f32 v13, v132, v133
    v_add_f32 v14, v134, v135
    v_add_f32 v13, v13, v14
    s_nop 1
    v_add_f32_dpp v13, v13, v13 quad_perm:[1,0,3,2] row_mask:0xf bank_mask:0xf
    v_rcp_f32 v13, v13
    s_nop 0
    v_mul_f32 v132, v132, v13
    v_cvt_pk_bf16_f32 v132, v132, v132
    v_lshlrev_b32 v132, 16, v132
    v_mul_f32 v133, v133, v13
    v_cvt_pk_bf16_f32 v133, v133, v133
    v_lshlrev_b32 v133, 16, v133
    v_mul_f32 v134, v134, v13
    v_cvt_pk_bf16_f32 v134, v134, v134
    v_lshlrev_b32 v134, 16, v134
    v_mul_f32 v135, v135, v13
    v_cvt_pk_bf16_f32 v135, v135, v135
    v_lshlrev_b32 v135, 16, v135
    s_mov_b32 s35, 0xffff0000
    s_waitcnt lgkmcnt(0)
    v_lshlrev_b32 v12, 16, v72
    v_and_b32 v13, s35, v72
    v_mul_f32 v112, v12, v132
    v_mul_f32 v113, v13, v132
    v_lshlrev_b32 v12, 16, v73
    v_and_b32 v13, s35, v73
    v_mul_f32 v114, v12, v132
    v_mul_f32 v115, v13, v132
    v_lshlrev_b32 v12, 16, v74
    v_and_b32 v13, s35, v74
    v_mul_f32 v116, v12, v132
    v_mul_f32 v117, v13, v132
    v_lshlrev_b32 v12, 16, v75
    v_and_b32 v13, s35, v75
    v_mul_f32 v118, v12, v132
    v_mul_f32 v119, v13, v132
    v_lshlrev_b32 v12, 16, v76
    v_and_b32 v13, s35, v76
    v_mul_f32 v120, v12, v132
    v_mul_f32 v121, v13, v132
    v_lshlrev_b32 v12, 16, v77
    v_and_b32 v13, s35, v77
    v_mul_f32 v122, v12, v132
    v_mul_f32 v123, v13, v132
    v_lshlrev_b32 v12, 16, v78
    v_and_b32 v13, s35, v78
    v_mul_f32 v124, v12, v132
    v_mul_f32 v125, v13, v132
    v_lshlrev_b32 v12, 16, v79
    v_and_b32 v13, s35, v79
    v_mul_f32 v126, v12, v132
    v_mul_f32 v127, v13, v132
    v_lshlrev_b32 v12, 16, v80
    v_and_b32 v13, s35, v80
    v_mul_f32 v128, v12, v132
    v_mul_f32 v129, v13, v132
    v_lshlrev_b32 v12, 16, v82
    v_and_b32 v13, s35, v82
    v_fmac_f32 v112, v12, v133
    v_fmac_f32 v113, v13, v133
    v_lshlrev_b32 v12, 16, v83
    v_and_b32 v13, s35, v83
    v_fmac_f32 v114, v12, v133
    v_fmac_f32 v115, v13, v133
    v_lshlrev_b32 v12, 16, v84
    v_and_b32 v13, s35, v84
    v_fmac_f32 v116, v12, v133
    v_fmac_f32 v117, v13, v133
    v_lshlrev_b32 v12, 16, v85
    v_and_b32 v13, s35, v85
    v_fmac_f32 v118, v12, v133
    v_fmac_f32 v119, v13, v133
    v_lshlrev_b32 v12, 16, v86
    v_and_b32 v13, s35, v86
    v_fmac_f32 v120, v12, v133
    v_fmac_f32 v121, v13, v133
    v_lshlrev_b32 v12, 16, v87
    v_and_b32 v13, s35, v87
    v_fmac_f32 v122, v12, v133
    v_fmac_f32 v123, v13, v133
    v_lshlrev_b32 v12, 16, v88
    v_and_b32 v13, s35, v88
    v_fmac_f32 v124, v12, v133
    v_fmac_f32 v125, v13, v133
    v_lshlrev_b32 v12, 16, v89
    v_and_b32 v13, s35, v89
    v_fmac_f32 v126, v12, v133
    v_fmac_f32 v127, v13, v133
    v_lshlrev_b32 v12, 16, v90
    v_and_b32 v13, s35, v90
    v_fmac_f32 v128, v12, v133
    v_fmac_f32 v129, v13, v133
    v_lshlrev_b32 v12, 16, v92
    v_and_b32 v13, s35, v92
    v_fmac_f32 v112, v12, v134
    v_fmac_f32 v113, v13, v134
    v_lshlrev_b32 v12, 16, v93
    v_and_b32 v13, s35, v93
    v_fmac_f32 v114, v12, v134
    v_fmac_f32 v115, v13, v134
    v_lshlrev_b32 v12, 16, v94
    v_and_b32 v13, s35, v94
    v_fmac_f32 v116, v12, v134
    v_fmac_f32 v117, v13, v134
    v_lshlrev_b32 v12, 16, v95
    v_and_b32 v13, s35, v95
    v_fmac_f32 v118, v12, v134
    v_fmac_f32 v119, v13, v134
    v_lshlrev_b32 v12, 16, v96
    v_and_b32 v13, s35, v96
    v_fmac_f32 v120, v12, v134
    v_fmac_f32 v121, v13, v134
    v_lshlrev_b32 v12, 16, v97
    v_and_b32 v13, s35, v97
    v_fmac_f32 v122, v12, v134
    v_fmac_f32 v123, v13, v134
    v_lshlrev_b32 v12, 16, v98
    v_and_b32 v13, s35, v98
    v_fmac_f32 v124, v12, v134
    v_fmac_f32 v125, v13, v134
    v_lshlrev_b32 v12, 16, v99
    v_and_b32 v13, s35, v99
    v_fmac_f32 v126, v12, v134
    v_fmac_f32 v127, v13, v134
    v_lshlrev_b32 v12, 16, v100
    v_and_b32 v13, s35, v100
    v_fmac_f32 v128, v12, v134
    v_fmac_f32 v129, v13, v134
    v_lshlrev_b32 v12, 16, v102
    v_and_b32 v13, s35, v102
    v_fmac_f32 v112, v12, v135
    v_fmac_f32 v113, v13, v135
    v_lshlrev_b32 v12, 16, v103
    v_and_b32 v13, s35, v103
    v_fmac_f32 v114, v12, v135
    v_fmac_f32 v115, v13, v135
    v_lshlrev_b32 v12, 16, v104
    v_and_b32 v13, s35, v104
    v_fmac_f32 v116, v12, v135
    v_fmac_f32 v117, v13, v135
    v_lshlrev_b32 v12, 16, v105
    v_and_b32 v13, s35, v105
    v_fmac_f32 v118, v12, v135
    v_fmac_f32 v119, v13, v135
    v_lshlrev_b32 v12, 16, v106
    v_and_b32 v13, s35, v106
    v_fmac_f32 v120, v12, v135
    v_fmac_f32 v121, v13, v135
    v_lshlrev_b32 v12, 16, v107
    v_and_b32 v13, s35, v107
    v_fmac_f32 v122, v12, v135
    v_fmac_f32 v123, v13, v135
    v_lshlrev_b32 v12, 16, v108
    v_and_b32 v13, s35, v108
    v_fmac_f32 v124, v12, v135
    v_fmac_f32 v125, v13, v135
    v_lshlrev_b32 v12, 16, v109
    v_and_b32 v13, s35, v109
    v_fmac_f32 v126, v12, v135
    v_fmac_f32 v127, v13, v135
    v_lshlrev_b32 v12, 16, v110
    v_and_b32 v13, s35, v110
    v_fmac_f32 v128, v12, v135
    v_fmac_f32 v129, v13, v135
    s_nop 1
    v_add_f32_dpp v112, v112, v112 quad_perm:[1,0,3,2] row_mask:0xf bank_mask:0xf
    v_add_f32_dpp v113, v113, v113 quad_perm:[1,0,3,2] row_mask:0xf bank_mask:0xf
    v_add_f32_dpp v114, v114, v114 quad_perm:[1,0,3,2] row_mask:0xf bank_mask:0xf
    v_add_f32_dpp v115, v115, v115 quad_perm:[1,0,3,2] row_mask:0xf bank_mask:0xf
    v_add_f32_dpp v116, v116, v116 quad_perm:[1,0,3,2] row_mask:0xf bank_mask:0xf
    v_add_f32_dpp v117, v117, v117 quad_perm:[1,0,3,2] row_mask:0xf bank_mask:0xf
    v_add_f32_dpp v118, v118, v118 quad_perm:[1,0,3,2] row_mask:0xf bank_mask:0xf
    v_add_f32_dpp v119, v119, v119 quad_perm:[1,0,3,2] row_mask:0xf bank_mask:0xf
    v_add_f32_dpp v120, v120, v120 quad_perm:[1,0,3,2] row_mask:0xf bank_mask:0xf
    v_add_f32_dpp v121, v121, v121 quad_perm:[1,0,3,2] row_mask:0xf bank_mask:0xf
    v_add_f32_dpp v122, v122, v122 quad_perm:[1,0,3,2] row_mask:0xf bank_mask:0xf
    v_add_f32_dpp v123, v123, v123 quad_perm:[1,0,3,2] row_mask:0xf bank_mask:0xf
    v_add_f32_dpp v124, v124, v124 quad_perm:[1,0,3,2] row_mask:0xf bank_mask:0xf
    v_add_f32_dpp v125, v125, v125 quad_perm:[1,0,3,2] row_mask:0xf bank_mask:0xf
    v_add_f32_dpp v126, v126, v126 quad_perm:[1,0,3,2] row_mask:0xf bank_mask:0xf
    v_add_f32_dpp v127, v127, v127 quad_perm:[1,0,3,2] row_mask:0xf bank_mask:0xf
    v_add_f32_dpp v128, v128, v128 quad_perm:[1,0,3,2] row_mask:0xf bank_mask:0xf
    v_add_f32_dpp v129, v129, v129 quad_perm:[1,0,3,2] row_mask:0xf bank_mask:0xf
    v_cvt_pk_bf16_f32 v16, v112, v113
    v_cvt_pk_bf16_f32 v17, v114, v115
    v_cvt_pk_bf16_f32 v18, v116, v117
    v_cvt_pk_bf16_f32 v19, v118, v119
    v_cvt_pk_bf16_f32 v20, v120, v121
    v_cvt_pk_bf16_f32 v21, v122, v123
    v_cvt_pk_bf16_f32 v22, v124, v125
    v_cvt_pk_bf16_f32 v23, v126, v127
    v_cvt_pk_bf16_f32 v24, v128, v129
    v_lshrrev_b32 v12, 4, v7
    v_mul_u32_u24 v12, 18432, v12
    v_and_b32 v13, 15, v7
    v_lshl_add_u32 v12, v13, 4, v12
    s_mul_i32 s33, s28, 36
    v_mul_u32_u24 v13, 18, v3
    v_add_u32 v13, s33, v13
    v_cmp_eq_u32 vcc, 0, v2
    s_and_saveexec_b64 s[38:39], vcc
    v_add_u32 v14, 0, v13
    v_lshrrev_b32 v15, 3, v14
    v_and_b32 v14, 7, v14
    v_lshl_add_u32 v14, v14, 1, v12
    v_lshl_add_u32 v14, v15, 8, v14
    buffer_store_dword v16, v14, s[20:23], 0 offen
    v_add_u32 v14, 2, v13
    v_lshrrev_b32 v15, 3, v14
    v_and_b32 v14, 7, v14
    v_lshl_add_u32 v14, v14, 1, v12
    v_lshl_add_u32 v14, v15, 8, v14
    buffer_store_dword v17, v14, s[20:23], 0 offen
    v_add_u32 v14, 4, v13
    v_lshrrev_b32 v15, 3, v14
    v_and_b32 v14, 7, v14
    v_lshl_add_u32 v14, v14, 1, v12
    v_lshl_add_u32 v14, v15, 8, v14
    buffer_store_dword v18, v14, s[20:23], 0 offen
    v_add_u32 v14, 6, v13
    v_lshrrev_b32 v15, 3, v14
    v_and_b32 v14, 7, v14
    v_lshl_add_u32 v14, v14, 1, v12
    v_lshl_add_u32 v14, v15, 8, v14
    buffer_store_dword v19, v14, s[20:23], 0 offen
    v_add_u32 v14, 8, v13
    v_lshrrev_b32 v15, 3, v14
    v_and_b32 v14, 7, v14
    v_lshl_add_u32 v14, v14, 1, v12
    v_lshl_add_u32 v14, v15, 8, v14
    buffer_store_dword v20, v14, s[20:23], 0 offen
    v_add_u32 v14, 10, v13
    v_lshrrev_b32 v15, 3, v14
    v_and_b32 v14, 7, v14
    v_lshl_add_u32 v14, v14, 1, v12
    v_lshl_add_u32 v14, v15, 8, v14
    buffer_store_dword v21, v14, s[20:23], 0 offen
    v_add_u32 v14, 12, v13
    v_lshrrev_b32 v15, 3, v14
    v_and_b32 v14, 7, v14
    v_lshl_add_u32 v14, v14, 1, v12
    v_lshl_add_u32 v14, v15, 8, v14
    buffer_store_dword v22, v14, s[20:23], 0 offen
    v_add_u32 v14, 14, v13
    v_lshrrev_b32 v15, 3, v14
    v_and_b32 v14, 7, v14
    v_lshl_add_u32 v14, v14, 1, v12
    v_lshl_add_u32 v14, v15, 8, v14
    buffer_store_dword v23, v14, s[20:23], 0 offen
    v_add_u32 v14, 16, v13
    v_lshrrev_b32 v15, 3, v14
    v_and_b32 v14, 7, v14
    v_lshl_add_u32 v14, v14, 1, v12
    v_lshl_add_u32 v14, v15, 8, v14
    buffer_store_dword v24, v14, s[20:23], 0 offen
    s_mov_b64 exec, -1
.Lend_61:
    s_endpgm
.section .rodata,"a"
.p2align 6
.amdhsa_kernel qkvb2_kernel
  .amdhsa_next_free_vgpr 160
  .amdhsa_next_free_sgpr 100
  .amdhsa_accum_offset 160
  .amdhsa_group_segment_fixed_size 0
  .amdhsa_kernarg_size 88
  .amdhsa_user_sgpr_count 2
  .amdhsa_user_sgpr_kernarg_segment_ptr 1
  .amdhsa_system_sgpr_workgroup_id_x 1
.end_amdhsa_kernel
.text
.globl outb2_kernel
.p2align 8
.type outb2_kernel,@function
outb2_kernel:
    s_cmp_ge_u32 s2, 192
    s_cbranch_scc1 .Lend_64
    s_load_dwordx2 s[4:5], s[0:1], 80
    s_load_dwordx2 s[10:11], s[0:1], 64
    s_lshr_b32 s28, s2, 3
    s_mul_i32 s3, s28, 43691
    s_lshr_b32 s3, s3, 18
    s_mul_i32 s29, s3, 6
    s_sub_u32 s28, s28, s29
    s_and_b32 s29, s2, 7
    s_lshl_b32 s29, s29, 2
    s_add_u32 s3, s3, s29
    v_and_b32 v1, 63, v0
    v_lshrrev_b32 v11, 6, v0
    s_nop 0
    v_readfirstlane_b32 s29, v11
    v_and_b32 v12, 15, v1
    v_lshrrev_b32 v13, 4, v1
    v_lshlrev_b32 v4, 4, v1
    s_lshl_b32 s30, s3, 2
    s_add_u32 s30, s30, s29
    s_mul_i32 s31, s30, 18432
    v_add_u32 v2, s31, v4
    s_mov_b32 s41, 4096
    s_mov_b32 s42, 8192
    s_mov_b32 s43, 12288
    s_mov_b32 s44, 16384
    s_mov_b32 s40, 0
    s_waitcnt lgkmcnt(0)
    s_add_u32 s12, s4, 0x900000
    s_addc_u32 s13, s5, 0
    s_mov_b32 s14, 0x240000
    s_mov_b32 s15, 0x00020000
    s_lshl_b32 s34, s29, 10
    s_add_u32 s16, s4, 0x1144000
    s_addc_u32 s17, s5, 0
    s_mov_b32 s18, 0xa2000
    s_mov_b32 s19, 0x00020000
    s_mul_i32 s33, s28, 110592
    s_add_u32 s33, s33, s34
    buffer_load_dwordx4 v[16:19], v2, s[12:15], s40 offen offset:0
    buffer_load_dwordx4 v[20:23], v2, s[12:15], s40 offen offset:1024
    s_add_u32 m0, s34, 0
    s_add_u32 s35, s33, 0
    buffer_load_dwordx4 v4, s[16:19], s35 offen lds
    s_add_u32 m0, s34, 4096
    s_add_u32 s35, s33, 4096
    buffer_load_dwordx4 v4, s[16:19], s35 offen lds
    s_add_u32 m0, s34, 8192
    s_add_u32 s35, s33, 8192
    buffer_load_dwordx4 v4, s[16:19], s35 offen lds
    buffer_load_dwordx4 v[24:27], v2, s[12:15], s40 offen offset:2048
    buffer_load_dwordx4 v[28:31], v2, s[12:15], s40 offen offset:3072
    s_add_u32 m0, s34, 12288
    s_add_u32 s35, s33, 12288
    buffer_load_dwordx4 v4, s[16:19], s35 offen lds
    s_add_u32 m0, s34, 16384
    s_add_u32 s35, s33, 16384
    buffer_load_dwordx4 v4, s[16:19], s35 offen lds
    s_add_u32 m0, s34, 20480
    s_add_u32 s35, s33, 20480
    buffer_load_dwordx4 v4, s[16:19], s35 offen lds
    buffer_load_dwordx4 v[32:35], v2, s[12:15], s41 offen offset:0
    buffer_load_dwordx4 v[36:39], v2, s[12:15], s41 offen offset:1024
    s_add_u32 m0, s34, 24576
    s_add_u32 s35, s33, 24576
    buffer_load_dwordx4 v4, s[16:19], s35 offen lds
    s_add_u32 m0, s34, 28672
    s_add_u32 s35, s33, 28672
    buffer_load_dwordx4 v4, s[16:19], s35 offen lds
    s_add_u32 m0, s34, 32768
    s_add_u32 s35, s33, 32768
    buffer_load_dwordx4 v4, s[16:19], s35 offen lds
    v_add_u32 v5, 55296, v4
    v_mov_b32 v136, 0
    v_mov_b32 v137, 0
    v_mov_b32 v138, 0
    v_mov_b32 v139, 0
    v_mov_b32 v140, 0
    v_mov_b32 v141, 0
    v_mov_b32 v142, 0
    v_mov_b32 v143, 0
    v_mov_b32 v144, 0
    v_mov_b32 v145, 0
    v_mov_b32 v146, 0
    v_mov_b32 v147, 0
    v_mov_b32 v148, 0
    v_mov_b32 v149, 0
    v_mov_b32 v150, 0
    v_mov_b32 v151, 0
    v_mov_b32 v152, 0
    v_mov_b32 v153, 0
    v_mov_b32 v154, 0
    v_mov_b32 v155, 0
    v_mov_b32 v156, 0
    v_mov_b32 v157, 0
    v_mov_b32 v158, 0
    v_mov_b32 v159, 0
    s_waitcnt vmcnt(10)
    s_barrier
    ds_read_b128 v[88:91], v4 offset:0
    ds_read_b128 v[92:95], v4 offset:1024
    ds_read_b128 v[96:99], v4 offset:2048
    ds_read_b128 v[100:103], v4 offset:3072
    ds_read_b128 v[104:107], v4 offset:4096
    ds_read_b128 v[108:111], v4 offset:5120
    ds_read_b128 v[112:115], v4 offset:6144
    ds_read_b128 v[116:119], v4 offset:7168
    ds_read_b128 v[120:123], v4 offset:8192
    ds_read_b128 v[124:127], v4 offset:9216
    ds_read_b128 v[128:131], v4 offset:10240
    ds_read_b128 v[132:135], v4 offset:11264
    buffer_load_dwordx4 v[40:43], v2, s[12:15], s41 offen offset:2048
    buffer_load_dwordx4 v[44:47], v2, s[12:15], s41 offen offset:3072
    s_add_u32 m0, s34, 36864
    s_add_u32 s35, s33, 36864
    buffer_load_dwordx4 v4, s[16:19], s35 offen lds
    s_add_u32 m0, s34, 40960
    s_add_u32 s35, s33, 40960
    buffer_load_dwordx4 v4, s[16:19], s35 offen lds
    s_add_u32 m0, s34, 45056
    s_add_u32 s35, s33, 45056
    buffer_load_dwordx4 v4, s[16:19], s35 offen lds
    s_waitcnt lgkmcnt(6)
    v_mfma_f32_16x16x32_bf16 v[136:139], v[88:91], v[16:19], v[136:139]
    v_mfma_f32_16x16x32_bf16 v[140:143], v[92:95], v[16:19], v[140:143]
    v_mfma_f32_16x16x32_bf16 v[144:147], v[96:99], v[16:19], v[144:147]
    v_mfma_f32_16x16x32_bf16 v[148:151], v[100:103], v[16:19], v[148:151]
    v_mfma_f32_16x16x32_bf16 v[152:155], v[104:107], v[16:19], v[152:155]
    v_mfma_f32_16x16x32_bf16 v[156:159], v[108:111], v[16:19], v[156:159]
    s_waitcnt lgkmcnt(0)
    s_waitcnt vmcnt(10)
    s_barrier
    ds_read_b128 v[88:91], v4 offset:12288
    ds_read_b128 v[92:95], v4 offset:13312
    ds_read_b128 v[96:99], v4 offset:14336
    ds_read_b128 v[100:103], v4 offset:15360
    ds_read_b128 v[104:107], v4 offset:16384
    ds_read_b128 v[108:111], v4 offset:17408
    v_mfma_f32_16x16x32_bf16 v[136:139], v[112:115], v[20:23], v[136:139]
    v_mfma_f32_16x16x32_bf16 v[140:143], v[116:119], v[20:23], v[140:143]
    v_mfma_f32_16x16x32_bf16 v[144:147], v[120:123], v[20:23], v[144:147]
    v_mfma_f32_16x16x32_bf16 v[148:151], v[124:127], v[20:23], v[148:151]
    v_mfma_f32_16x16x32_bf16 v[152:155], v[128:131], v[20:23], v[152:155]
    v_mfma_f32_16x16x32_bf16 v[156:159], v[132:135], v[20:23], v[156:159]
    ds_read_b128 v[112:115], v4 offset:18432
    ds_read_b128 v[116:119], v4 offset:19456
    ds_read_b128 v[120:123], v4 offset:20480
    ds_read_b128 v[124:127], v4 offset:21504
    ds_read_b128 v[128:131], v4 offset:22528
    ds_read_b128 v[132:135], v4 offset:23552
    buffer_load_dwordx4 v[48:51], v2, s[12:15], s42 offen offset:0
    buffer_load_dwordx4 v[52:55], v2, s[12:15], s42 offen offset:1024
    s_add_u32 m0, s34, 49152
    s_add_u32 s35, s33, 49152
    buffer_load_dwordx4 v4, s[16:19], s35 offen lds
    s_add_u32 m0, s34, 53248
    s_add_u32 s35, s33, 53248
    buffer_load_dwordx4 v4, s[16:19], s35 offen lds
    s_add_u32 m0, s34, 57344
    s_add_u32 s35, s33, 57344
    buffer_load_dwordx4 v4, s[16:19], s35 offen lds
    s_waitcnt lgkmcnt(6)
    v_mfma_f32_16x16x32_bf16 v[136:139], v[88:91], v[24:27], v[136:139]
    v_mfma_f32_16x16x32_bf16 v[140:143], v[92:95], v[24:27], v[140:143]
    v_mfma_f32_16x16x32_bf16 v[144:147], v[96:99], v[24:27], v[144:147]
    v_mfma_f32_16x16x32_bf16 v[148:151], v[100:103], v[24:27], v[148:151]
    v_mfma_f32_16x16x32_bf16 v[152:155], v[104:107], v[24:27], v[152:155]
    v_mfma_f32_16x16x32_bf16 v[156:159], v[108:111], v[24:27], v[156:159]
    s_waitcnt lgkmcnt(0)
    s_waitcnt vmcnt(10)
    s_barrier
    ds_read_b128 v[88:91], v4 offset:24576
    ds_read_b128 v[92:95], v4 offset:25600
    ds_read_b128 v[96:99], v4 offset:26624
    ds_read_b128 v[100:103], v4 offset:27648
    ds_read_b128 v[104:107], v4 offset:28672
    ds_read_b128 v[108:111], v4 offset:29696
    v_mfma_f32_16x16x32_bf16 v[136:139], v[112:115], v[28:31], v[136:139]
    v_mfma_f32_16x16x32_bf16 v[140:143], v[116:119], v[28:31], v[140:143]
    v_mfma_f32_16x16x32_bf16 v[144:147], v[120:123], v[28:31], v[144:147]
    v_mfma_f32_16x16x32_bf16 v[148:151], v[124:127], v[28:31], v[148:151]
    v_mfma_f32_16x16x32_bf16 v[152:155], v[128:131], v[28:31], v[152:155]
    v_mfma_f32_16x16x32_bf16 v[156:159], v[132:135], v[28:31], v[156:159]
    ds_read_b128 v[112:115], v4 offset:30720
    ds_read_b128 v[116:119], v4 offset:31744
    ds_read_b128 v[120:123], v4 offset:32768
    ds_read_b128 v[124:127], v4 offset:33792
    ds_read_b128 v[128:131], v4 offset:34816
    ds_read_b128 v[132:135], v4 offset:35840
    buffer_load_dwordx4 v[56:59], v2, s[12:15], s42 offen offset:2048
    buffer_load_dwordx4 v[60:63], v2, s[12:15], s42 offen offset:3072
    s_add_u32 m0, s34, 61440
    s_add_u32 s35, s33, 61440
    buffer_load_dwordx4 v4, s[16:19], s35 offen lds
    s_add_u32 m0, s34, 65536
    s_add_u32 s35, s33, 65536
    buffer_load_dwordx4 v4, s[16:19], s35 offen lds
    s_add_u32 m0, s34, 69632
    s_add_u32 s35, s33, 69632
    buffer_load_dwordx4 v4, s[16:19], s35 offen lds
    s_waitcnt lgkmcnt(6)
    v_mfma_f32_16x16x32_bf16 v[136:139], v[88:91], v[32:35], v[136:139]
    v_mfma_f32_16x16x32_bf16 v[140:143], v[92:95], v[32:35], v[140:143]
    v_mfma_f32_16x16x32_bf16 v[144:147], v[96:99], v[32:35], v[144:147]
    v_mfma_f32_16x16x32_bf16 v[148:151], v[100:103], v[32:35], v[148:151]
    v_mfma_f32_16x16x32_bf16 v[152:155], v[104:107], v[32:35], v[152:155]
    v_mfma_f32_16x16x32_bf16 v[156:159], v[108:111], v[32:35], v[156:159]
    s_waitcnt lgkmcnt(0)
    s_waitcnt vmcnt(10)
    s_barrier
    ds_read_b128 v[88:91], v4 offset:36864
    ds_read_b128 v[92:95], v4 offset:37888
    ds_read_b128 v[96:99], v4 offset:38912
    ds_read_b128 v[100:103], v4 offset:39936
    ds_read_b128 v[104:107], v4 offset:40960
    ds_read_b128 v[108:111], v4 offset:41984
    v_mfma_f32_16x16x32_bf16 v[136:139], v[112:115], v[36:39], v[136:139]
    v_mfma_f32_16x16x32_bf16 v[140:143], v[116:119], v[36:39], v[140:143]
    v_mfma_f32_16x16x32_bf16 v[144:147], v[120:123], v[36:39], v[144:147]
    v_mfma_f32_16x16x32_bf16 v[148:151], v[124:127], v[36:39], v[148:151]
    v_mfma_f32_16x16x32_bf16 v[152:155], v[128:131], v[36:39], v[152:155]
    v_mfma_f32_16x16x32_bf16 v[156:159], v[132:135], v[36:39], v[156:159]
    ds_read_b128 v[112:115], v4 offset:43008
    ds_read_b128 v[116:119], v4 offset:44032
    ds_read_b128 v[120:123], v4 offset:45056
    ds_read_b128 v[124:127], v4 offset:46080
    ds_read_b128 v[128:131], v4 offset:47104
    ds_read_b128 v[132:135], v4 offset:48128
    buffer_load_dwordx4 v[64:67], v2, s[12:15], s43 offen offset:0
    buffer_load_dwordx4 v[68:71], v2, s[12:15], s43 offen offset:1024
    s_add_u32 m0, s34, 73728
    s_add_u32 s35, s33, 73728
    buffer_load_dwordx4 v4, s[16:19], s35 offen lds
    s_add_u32 m0, s34, 77824
    s_add_u32 s35, s33, 77824
    buffer_load_dwordx4 v4, s[16:19], s35 offen lds
    s_add_u32 m0, s34, 81920
    s_add_u32 s35, s33, 81920
    buffer_load_dwordx4 v4, s[16:19], s35 offen lds
    s_waitcnt lgkmcnt(6)
    v_mfma_f32_16x16x32_bf16 v[136:139], v[88:91], v[40:43], v[136:139]
    v_mfma_f32_16x16x32_bf16 v[140:143], v[92:95], v[40:43], v[140:143]
    v_mfma_f32_16x16x32_bf16 v[144:147], v[96:99], v[40:43], v[144:147]
    v_mfma_f32_16x16x32_bf16 v[148:151], v[100:103], v[40:43], v[148:151]
    v_mfma_f32_16x16x32_bf16 v[152:155], v[104:107], v[40:43], v[152:155]
    v_mfma_f32_16x16x32_bf16 v[156:159], v[108:111], v[40:43], v[156:159]
    s_waitcnt lgkmcnt(0)
    s_waitcnt vmcnt(10)
    s_barrier
    ds_read_b128 v[88:91], v4 offset:49152
    ds_read_b128 v[92:95], v4 offset:50176
    ds_read_b128 v[96:99], v4 offset:51200
    ds_read_b128 v[100:103], v4 offset:52224
    ds_read_b128 v[104:107], v4 offset:53248
    ds_read_b128 v[108:111], v4 offset:54272
    v_mfma_f32_16x16x32_bf16 v[136:139], v[112:115], v[44:47], v[136:139]
    v_mfma_f32_16x16x32_bf16 v[140:143], v[116:119], v[44:47], v[140:143]
    v_mfma_f32_16x16x32_bf16 v[144:147], v[120:123], v[44:47], v[144:147]
    v_mfma_f32_16x16x32_bf16 v[148:151], v[124:127], v[44:47], v[148:151]
    v_mfma_f32_16x16x32_bf16 v[152:155], v[128:131], v[44:47], v[152:155]
    v_mfma_f32_16x16x32_bf16 v[156:159], v[132:135], v[44:47], v[156:159]
    ds_read_b128 v[112:115], v5 offset:0
    ds_read_b128 v[116:119], v5 offset:1024
    ds_read_b128 v[120:123], v5 offset:2048
    ds_read_b128 v[124:127], v5 offset:3072
    ds_read_b128 v[128:131], v5 offset:4096
    ds_read_b128 v[132:135], v5 offset:5120
    buffer_load_dwordx4 v[72:75], v2, s[12:15], s43 offen offset:2048
    buffer_load_dwordx4 v[76:79], v2, s[12:15], s43 offen offset:3072
    s_add_u32 m0, s34, 86016
    s_add_u32 s35, s33, 86016
    buffer_load_dwordx4 v4, s[16:19], s35 offen lds
    s_add_u32 m0, s34, 90112
    s_add_u32 s35, s33, 90112
    buffer_load_dwordx4 v4, s[16:19], s35 offen lds
    s_add_u32 m0, s34, 94208
    s_add_u32 s35, s33, 94208
    buffer_load_dwordx4 v4, s[16:19], s35 offen lds
    s_waitcnt lgkmcnt(6)
    v_mfma_f32_16x16x32_bf16 v[136:139], v[88:91], v[48:51], v[136:139]
    v_mfma_f32_16x16x32_bf16 v[140:143], v[92:95], v[48:51], v[140:143]
    v_mfma_f32_16x16x32_bf16 v[144:147], v[96:99], v[48:51], v[144:147]
    v_mfma_f32_16x16x32_bf16 v[148:151], v[100:103], v[48:51], v[148:151]
    v_mfma_f32_16x16x32_bf16 v[152:155], v[104:107], v[48:51], v[152:155]
    v_mfma_f32_16x16x32_bf16 v[156:159], v[108:111], v[48:51], v[156:159]
    s_waitcnt lgkmcnt(0)
    s_waitcnt vmcnt(10)
    s_barrier
    ds_read_b128 v[88:91], v5 offset:6144
    ds_read_b128 v[92:95], v5 offset:7168
    ds_read_b128 v[96:99], v5 offset:8192
    ds_read_b128 v[100:103], v5 offset:9216
    ds_read_b128 v[104:107], v5 offset:10240
    ds_read_b128 v[108:111], v5 offset:11264
    v_mfma_f32_16x16x32_bf16 v[136:139], v[112:115], v[52:55], v[136:139]
    v_mfma_f32_16x16x32_bf16 v[140:143], v[116:119], v[52:55], v[140:143]
    v_mfma_f32_16x16x32_bf16 v[144:147], v[120:123], v[52:55], v[144:147]
    v_mfma_f32_16x16x32_bf16 v[148:151], v[124:127], v[52:55], v[148:151]
    v_mfma_f32_16x16x32_bf16 v[152:155], v[128:131], v[52:55], v[152:155]
    v_mfma_f32_16x16x32_bf16 v[156:159], v[132:135], v[52:55], v[156:159]
    ds_read_b128 v[112:115], v5 offset:12288
    ds_read_b128 v[116:119], v5 offset:13312
    ds_read_b128 v[120:123], v5 offset:14336
    ds_read_b128 v[124:127], v5 offset:15360
    ds_read_b128 v[128:131], v5 offset:16384
    ds_read_b128 v[132:135], v5 offset:17408
    buffer_load_dwordx4 v[80:83], v2, s[12:15], s44 offen offset:0
    buffer_load_dwordx4 v[84:87], v2, s[12:15], s44 offen offset:1024
    s_add_u32 m0, s34, 98304
    s_add_u32 s35, s33, 98304
    buffer_load_dwordx4 v4, s[16:19], s35 offen lds
    s_add_u32 m0, s34, 102400
    s_add_u32 s35, s33, 102400
    buffer_load_dwordx4 v4, s[16:19], s35 offen lds
    s_add_u32 m0, s34, 106496
    s_add_u32 s35, s33, 106496
    buffer_load_dwordx4 v4, s[16:19], s35 offen lds
    s_waitcnt lgkmcnt(6)
    v_mfma_f32_16x16x32_bf16 v[136:139], v[88:91], v[56:59], v[136:139]
    v_mfma_f32_16x16x32_bf16 v[140:143], v[92:95], v[56:59], v[140:143]
    v_mfma_f32_16x16x32_bf16 v[144:147], v[96:99], v[56:59], v[144:147]
    v_mfma_f32_16x16x32_bf16 v[148:151], v[100:103], v[56:59], v[148:151]
    v_mfma_f32_16x16x32_bf16 v[152:155], v[104:107], v[56:59], v[152:155]
    v_mfma_f32_16x16x32_bf16 v[156:159], v[108:111], v[56:59], v[156:159]
    s_waitcnt lgkmcnt(0)
    s_waitcnt vmcnt(10)
    s_barrier
    ds_read_b128 v[88:91], v5 offset:18432
    ds_read_b128 v[92:95], v5 offset:19456
    ds_read_b128 v[96:99], v5 offset:20480
    ds_read_b128 v[100:103], v5 offset:21504
    ds_read_b128 v[104:107], v5 offset:22528
    ds_read_b128 v[108:111], v5 offset:23552
    v_mfma_f32_16x16x32_bf16 v[136:139], v[112:115], v[60:63], v[136:139]
    v_mfma_f32_16x16x32_bf16 v[140:143], v[116:119], v[60:63], v[140:143]
    v_mfma_f32_16x16x32_bf16 v[144:147], v[120:123], v[60:63], v[144:147]
    v_mfma_f32_16x16x32_bf16 v[148:151], v[124:127], v[60:63], v[148:151]
    v_mfma_f32_16x16x32_bf16 v[152:155], v[128:131], v[60:63], v[152:155]
    v_mfma_f32_16x16x32_bf16 v[156:159], v[132:135], v[60:63], v[156:159]
    ds_read_b128 v[112:115], v5 offset:24576
    ds_read_b128 v[116:119], v5 offset:25600
    ds_read_b128 v[120:123], v5 offset:26624
    ds_read_b128 v[124:127], v5 offset:27648
    ds_read_b128 v[128:131], v5 offset:28672
    ds_read_b128 v[132:135], v5 offset:29696
    s_add_u32 s20, s4, 0x480000
    s_addc_u32 s21, s5, 0
    s_mov_b32 s22, 0x240000
    s_mov_b32 s23, 0x00020000
    v_lshrrev_b32 v3, 1, v13
    v_lshlrev_b32 v3, 8, v3
    v_lshl_add_u32 v3, v12, 4, v3
    v_and_b32 v11, 1, v13
    v_lshl_add_u32 v3, v11, 3, v3
    s_mul_i32 s36, s28, 3072
    s_add_u32 s36, s36, s31
    v_add_u32 v3, s36, v3
    buffer_load_dwordx2 v[160:161], v3, s[20:23], 0 offen offset:0
    buffer_load_dwordx2 v[162:163], v3, s[20:23], 0 offen offset:512
    buffer_load_dwordx2 v[164:165], v3, s[20:23], 0 offen offset:1024
    buffer_load_dwordx2 v[166:167], v3, s[20:23], 0 offen offset:1536
    buffer_load_dwordx2 v[168:169], v3, s[20:23], 0 offen offset:2048
    buffer_load_dwordx2 v[170:171], v3, s[20:23], 0 offen offset:2560
    s_waitcnt lgkmcnt(6)
    v_mfma_f32_16x16x32_bf16 v[136:139], v[88:91], v[64:67], v[136:139]
    v_mfma_f32_16x16x32_bf16 v[140:143], v[92:95], v[64:67], v[140:143]
    v_mfma_f32_16x16x32_bf16 v[144:147], v[96:99], v[64:67], v[144:147]
    v_mfma_f32_16x16x32_bf16 v[148:151], v[100:103], v[64:67], v[148:151]
    v_mfma_f32_16x16x32_bf16 v[152:155], v[104:107], v[64:67], v[152:155]
    v_mfma_f32_16x16x32_bf16 v[156:159], v[108:111], v[64:67], v[156:159]
    s_waitcnt lgkmcnt(0)
    s_waitcnt vmcnt(11)
    s_barrier
    ds_read_b128 v[88:91], v5 offset:30720
    ds_read_b128 v[92:95], v5 offset:31744
    ds_read_b128 v[96:99], v5 offset:32768
    ds_read_b128 v[100:103], v5 offset:33792
    ds_read_b128 v[104:107], v5 offset:34816
    ds_read_b128 v[108:111], v5 offset:35840
    v_mfma_f32_16x16x32_bf16 v[136:139], v[112:115], v[68:71], v[136:139]
    v_mfma_f32_16x16x32_bf16 v[140:143], v[116:119], v[68:71], v[140:143]
    v_mfma_f32_16x16x32_bf16 v[144:147], v[120:123], v[68:71], v[144:147]
    v_mfma_f32_16x16x32_bf16 v[148:151], v[124:127], v[68:71], v[148:151]
    v_mfma_f32_16x16x32_bf16 v[152:155], v[128:131], v[68:71], v[152:155]
    v_mfma_f32_16x16x32_bf16 v[156:159], v[132:135], v[68:71], v[156:159]
    ds_read_b128 v[112:115], v5 offset:36864
    ds_read_b128 v[116:119], v5 offset:37888
    ds_read_b128 v[120:123], v5 offset:38912
    ds_read_b128 v[124:127], v5 offset:39936
    ds_read_b128 v[128:131], v5 offset:40960
    ds_read_b128 v[132:135], v5 offset:41984
    s_waitcnt lgkmcnt(6)
    v_mfma_f32_16x16x32_bf16 v[136:139], v[88:91], v[72:75], v[136:139]
    v_mfma_f32_16x16x32_bf16 v[140:143], v[92:95], v[72:75], v[140:143]
    v_mfma_f32_16x16x32_bf16 v[144:147], v[96:99], v[72:75], v[144:147]
    v_mfma_f32_16x16x32_bf16 v[148:151], v[100:103], v[72:75], v[148:151]
    v_mfma_f32_16x16x32_bf16 v[152:155], v[104:107], v[72:75], v[152:155]
    v_mfma_f32_16x16x32_bf16 v[156:159], v[108:111], v[72:75], v[156:159]
    s_waitcnt lgkmcnt(0)
    s_waitcnt vmcnt(6)
    s_barrier
    ds_read_b128 v[88:91], v5 offset:43008
    ds_read_b128 v[92:95], v5 offset:44032
    ds_read_b128 v[96:99], v5 offset:45056
    ds_read_b128 v[100:103], v5 offset:46080
    ds_read_b128 v[104:107], v5 offset:47104
    ds_read_b128 v[108:111], v5 offset:48128
    v_mfma_f32_16x16x32_bf16 v[136:139], v[112:115], v[76:79], v[136:139]
    v_mfma_f32_16x16x32_bf16 v[140:143], v[116:119], v[76:79], v[140:143]
    v_mfma_f32_16x16x32_bf16 v[144:147], v[120:123], v[76:79], v[144:147]
    v_mfma_f32_16x16x32_bf16 v[148:151], v[124:127], v[76:79], v[148:151]
    v_mfma_f32_16x16x32_bf16 v[152:155], v[128:131], v[76:79], v[152:155]
    v_mfma_f32_16x16x32_bf16 v[156:159], v[132:135], v[76:79], v[156:159]
    ds_read_b128 v[112:115], v5 offset:49152
    ds_read_b128 v[116:119], v5 offset:50176
    ds_read_b128 v[120:123], v5 offset:51200
    ds_read_b128 v[124:127], v5 offset:52224
    ds_read_b128 v[128:131], v5 offset:53248
    ds_read_b128 v[132:135], v5 offset:54272
    s_waitcnt lgkmcnt(6)
    v_mfma_f32_16x16x32_bf16 v[136:139], v[88:91], v[80:83], v[136:139]
    v_mfma_f32_16x16x32_bf16 v[140:143], v[92:95], v[80:83], v[140:143]
    v_mfma_f32_16x16x32_bf16 v[144:147], v[96:99], v[80:83], v[144:147]
    v_mfma_f32_16x16x32_bf16 v[148:151], v[100:103], v[80:83], v[148:151]
    v_mfma_f32_16x16x32_bf16 v[152:155], v[104:107], v[80:83], v[152:155]
    v_mfma_f32_16x16x32_bf16 v[156:159], v[108:111], v[80:83], v[156:159]
    s_waitcnt lgkmcnt(0)
    v_mfma_f32_16x16x32_bf16 v[136:139], v[112:115], v[84:87], v[136:139]
    v_mfma_f32_16x16x32_bf16 v[140:143], v[116:119], v[84:87], v[140:143]
    v_mfma_f32_16x16x32_bf16 v[144:147], v[120:123], v[84:87], v[144:147]
    v_mfma_f32_16x16x32_bf16 v[148:151], v[124:127], v[84:87], v[148:151]
    v_mfma_f32_16x16x32_bf16 v[152:155], v[128:131], v[84:87], v[152:155]
    v_mfma_f32_16x16x32_bf16 v[156:159], v[132:135], v[84:87], v[156:159]
    s_nop 7
    s_mov_b32 s24, s10
    s_mov_b32 s25, s11
    s_mov_b32 s26, 0x240000
    s_mov_b32 s27, 0x00020000
    s_lshl_b32 s36, s30, 4
    v_add_u32 v6, s36, v12
    v_mul_u32_u24 v6, 1152, v6
    v_lshl_add_u32 v6, v13, 3, v6
    s_mul_i32 s36, s28, 192
    v_add_u32 v6, s36, v6
    s_mov_b32 s36, 0xffff0000
    s_waitcnt vmcnt(0)
    v_cvt_pk_bf16_f32 v136, v136, v137
    v_cvt_pk_bf16_f32 v137, v138, v139
    v_lshlrev_b32 v11, 16, v136
    v_and_b32 v15, s36, v136
    v_lshlrev_b32 v138, 16, v160
    v_and_b32 v139, s36, v160
    v_add_f32 v11, v11, v138
    v_add_f32 v15, v15, v139
    v_cvt_pk_bf16_f32 v160, v11, v15
    v_lshlrev_b32 v11, 16, v137
    v_and_b32 v15, s36, v137
    v_lshlrev_b32 v138, 16, v161
    v_and_b32 v139, s36, v161
    v_add_f32 v11, v11, v138
    v_add_f32 v15, v15, v139
    v_cvt_pk_bf16_f32 v161, v11, v15
    buffer_store_dwordx2 v[160:161], v6, s[24:27], 0 offen offset:0
    v_cvt_pk_bf16_f32 v140, v140, v141
    v_cvt_pk_bf16_f32 v141, v142, v143
    v_lshlrev_b32 v11, 16, v140
    v_and_b32 v15, s36, v140
    v_lshlrev_b32 v142, 16, v162
    v_and_b32 v143, s36, v162
    v_add_f32 v11, v11, v142
    v_add_f32 v15, v15, v143
    v_cvt_pk_bf16_f32 v162, v11, v15
    v_lshlrev_b32 v11, 16, v141
    v_and_b32 v15, s36, v141
    v_lshlrev_b32 v142, 16, v163
    v_and_b32 v143, s36, v163
    v_add_f32 v11, v11, v142
    v_add_f32 v15, v15, v143
    v_cvt_pk_bf16_f32 v163, v11, v15
    buffer_store_dwordx2 v[162:163], v6, s[24:27], 0 offen offset:32
    v_cvt_pk_bf16_f32 v144, v144, v145
    v_cvt_pk_bf16_f32 v145, v146, v147
    v_lshlrev_b32 v11, 16, v144
    v_and_b32 v15, s36, v144
    v_lshlrev_b32 v146, 16, v164
    v_and_b32 v147, s36, v164
    v_add_f32 v11, v11, v146
    v_add_f32 v15, v15, v147
    v_cvt_pk_bf16_f32 v164, v11, v15
    v_lshlrev_b32 v11, 16, v145
    v_and_b32 v15, s36, v145
    v_lshlrev_b32 v146, 16, v165
    v_and_b32 v147, s36, v165
    v_add_f32 v11, v11, v146
    v_add_f32 v15, v15, v147
    v_cvt_pk_bf16_f32 v165, v11, v15
    buffer_store_dwordx2 v[164:165], v6, s[24:27], 0 offen offset:64
    v_cvt_pk_bf16_f32 v148, v148, v149
    v_cvt_pk_bf16_f32 v149, v150, v151
    v_lshlrev_b32 v11, 16, v148
    v_and_b32 v15, s36, v148
    v_lshlrev_b32 v150, 16, v166
    v_and_b32 v151, s36, v166
    v_add_f32 v11, v11, v150
    v_add_f32 v15, v15, v151
    v_cvt_pk_bf16_f32 v166, v11, v15
    v_lshlrev_b32 v11, 16, v149
    v_and_b32 v15, s36, v149
    v_lshlrev_b32 v150, 16, v167
    v_and_b32 v151, s36, v167
    v_add_f32 v11, v11, v150
    v_add_f32 v15, v15, v151
    v_cvt_pk_bf16_f32 v167, v11, v15
    buffer_store_dwordx2 v[166:167], v6, s[24:27], 0 offen offset:96
    v_cvt_pk_bf16_f32 v152, v152, v153
    v_cvt_pk_bf16_f32 v153, v154, v155
    v_lshlrev_b32 v11, 16, v152
    v_and_b32 v15, s36, v152
    v_lshlrev_b32 v154, 16, v168
    v_and_b32 v155, s36, v168
    v_add_f32 v11, v11, v154
    v_add_f32 v15, v15, v155
    v_cvt_pk_bf16_f32 v168, v11, v15
    v_lshlrev_b32 v11, 16, v153
    v_and_b32 v15, s36, v153
    v_lshlrev_b32 v154, 16, v169
    v_and_b32 v155, s36, v169
    v_add_f32 v11, v11, v154
    v_add_f32 v15, v15, v155
    v_cvt_pk_bf16_f32 v169, v11, v15
    buffer_store_dwordx2 v[168:169], v6, s[24:27], 0 offen offset:128
    v_cvt_pk_bf16_f32 v156, v156, v157
    v_cvt_pk_bf16_f32 v157, v158, v159
    v_lshlrev_b32 v11, 16, v156
    v_and_b32 v15, s36, v156
    v_lshlrev_b32 v158, 16, v170
    v_and_b32 v159, s36, v170
    v_add_f32 v11, v11, v158
    v_add_f32 v15, v15, v159
    v_cvt_pk_bf16_f32 v170, v11, v15
    v_lshlrev_b32 v11, 16, v157
    v_and_b32 v15, s36, v157
    v_lshlrev_b32 v158, 16, v171
    v_and_b32 v159, s36, v171
    v_add_f32 v11, v11, v158
    v_add_f32 v15, v15, v159
    v_cvt_pk_bf16_f32 v171, v11, v15
    buffer_store_dwordx2 v[170:171], v6, s[24:27], 0 offen offset:160
    s_endpgm
.Lend_64:
    s_endpgm
.section .rodata,"a"
.p2align 6
.amdhsa_kernel outb2_kernel
  .amdhsa_next_free_vgpr 200
  .amdhsa_next_free_sgpr 100
  .amdhsa_accum_offset 200
  .amdhsa_group_segment_fixed_size 0
  .amdhsa_kernarg_size 88
  .amdhsa_user_sgpr_count 2
  .amdhsa_user_sgpr_kernarg_segment_ptr 1
  .amdhsa_system_sgpr_workgroup_id_x 1
.end_amdhsa_kernel
.text
```
